```python
import torch

def _softmax(x, axis=-1):
    return torch.softmax(x, dim=axis)
def _gelu(x):
    return torch.nn.functional.gelu(x, approximate="tanh")
def _silu(x):
    return torch.nn.functional.silu(x)
def _sigmoid(x):
    return torch.sigmoid(x)
def _layernorm(x, axis=-1, eps=1e-5):
    m = x.mean(dim=axis, keepdim=True)
    v = x.var(dim=axis, keepdim=True, unbiased=False)
    return (x - m) / torch.sqrt(v + eps)
def _scatter_add(tgt, idx, src, axis=0):
    return tgt.clone().index_add_(axis, idx, src)
def _segment_sum(src, seg, n):
    out = torch.zeros((n,) + src.shape[1:], dtype=src.dtype)
    return out.index_add_(0, seg, src)
def _pad(x, pw):
    flat = tuple(v for pair in reversed(pw) for v in pair)
    return torch.nn.functional.pad(x, flat)

kernel_name = 'sequential_preLN__mha_block_cached__dense_activation_silu__decode'

def setup_inputs():

    _w = (lambda a: (lambda t: t.to(torch.bfloat16) if t.is_floating_point() else t)(torch.as_tensor(a)))
    def _A_setup():
        B, Sq, D = 2, 1, 640
        H, Sk, Dh = 32, 8192, 192
        return {
            "x": _w((lambda *s: torch.randn(*s, dtype=torch.bfloat16) * 0.05)(B, Sq, D)),
            "k_cache": _w((lambda *s: torch.randn(*s, dtype=torch.bfloat16) * 3.2)(B, H, Sk, Dh)),
            "v_cache": _w((lambda *s: torch.randn(*s, dtype=torch.bfloat16) * 0.8)(B, H, Sk, Dh)),
            "wq": _w((lambda *s: torch.randn(*s, dtype=torch.bfloat16) * 3.2)(D, H * Dh) * (D ** -0.5)),
            "wo": _w((lambda *s: torch.randn(*s, dtype=torch.bfloat16) * 0.8)(H * Dh, D) * ((H * Dh) ** -0.5)),
        }
    _A_in = _A_setup()

    def _B_setup():
        B, S, D, F = 2, 1, 640, 1536
        return {
            "x": _w((lambda *s: torch.randn(*s, dtype=torch.bfloat16) * 0.05)(B, S, D)),
            "w1": _w((lambda *s: torch.randn(*s, dtype=torch.bfloat16) * 3.2)(D, F) * (D ** -0.5)),
            "w2": _w((lambda *s: torch.randn(*s, dtype=torch.bfloat16) * 0.8)(F, D) * (F ** -0.5)),
        }
    _B_in = _B_setup()

    return {
        "A_x": _A_in["x"],
        "A_k_cache": _A_in["k_cache"],
        "A_v_cache": _A_in["v_cache"],
        "A_wq": _A_in["wq"],
        "A_wo": _A_in["wo"],
        "B_x": _B_in["x"],
        "B_w1": _B_in["w1"],
        "B_w2": _B_in["w2"],
    }

def reference(A_x, A_k_cache, A_v_cache, A_wq, A_wo, B_x, B_w1, B_w2):
    def _A_ref(x, k_cache, v_cache, wq, wo):
        B, Sq, D = x.shape
        H, Dh = 32, 192
        q = (lambda x, *d: x.permute(*d))((x @ wq).reshape(B, Sq, H, Dh), 0, 2, 1, 3)
        scores = torch.einsum("bhqd,bhkd->bhqk", q, k_cache) * (Dh ** -0.5)
        p = _softmax(scores, axis=-1)
        o = torch.einsum("bhqk,bhkd->bhqd", p, v_cache)
        return (lambda x, *d: x.permute(*d))(o, 0, 2, 1, 3).reshape(B, Sq, H * Dh) @ wo

    def _B_ref(x, w1, w2):
        h = torch.einsum("bsd,df->bsf", x, w1)
        h = _silu(h)
        out = torch.einsum("bsf,fd->bsd", h, w2)
        return out

    x = A_x
    h = x + _A_ref(_layernorm(x, axis=-1), A_k_cache, A_v_cache, A_wq, A_wo)
    h2 = h + _B_ref(_layernorm(h, axis=-1), B_w1, B_w2)
    return h2
```

```asm
; @launch grid=(256,1,1) block=(512,1,1) lds=76288
.amdgcn_target "amdgcn-amd-amdhsa--gfx950"
.text
.globl sequential_preLN__mha_block_cached__dense_activation_silu__decode_kernel
.p2align 8
.type sequential_preLN__mha_block_cached__dense_activation_silu__decode_kernel,@function
sequential_preLN__mha_block_cached__dense_activation_silu__decode_kernel:
    s_cmp_ge_u32 s2, 256
    s_cbranch_scc1 L_end
    s_load_dwordx16 s[4:19], s[0:1], 0
    s_load_dwordx4 s[20:23], s[0:1], 64
    s_load_dwordx2 s[24:25], s[0:1], 80
    v_lshrrev_b32 v4, 6, v0
    v_and_b32 v1, 63, v0
    v_readfirstlane_b32 s60, v4
    v_lshrrev_b32 v20, 3, v1
    v_and_b32 v21, 7, v1
    v_mov_b32 v3, 0
    v_lshlrev_b32 v5, 4, v1
    v_cmp_gt_u32 vcc, 2, v1
    v_mov_b32 v8, -1
    s_nop 0
    v_cndmask_b32 v8, v8, v3, vcc
    v_mov_b32 v9, v8
    v_mov_b32 v10, v8
    v_mov_b32 v11, v8
    ds_write_b128 v5, v[8:11]
    s_and_b32 s78, s2, 7
    s_lshr_b32 s71, s2, 3
    s_lshr_b32 s72, s71, 3
    s_lshl_b32 s61, s78, 2
    s_add_u32 s61, s61, s72
    s_and_b32 s64, s71, 7
    s_lshr_b32 s62, s64, 2
    s_and_b32 s63, s64, 3
    s_mul_i32 s79, s72, 5
    s_add_u32 s79, s79, s64
    s_lshl_b32 s3, s61, 3
    s_add_u32 s3, s3, s64
    s_mov_b32 s67, 0xffff0000
    s_mov_b32 s100, 1048576
    s_mov_b32 s26, 0
    s_mov_b32 s27, 0
    s_mul_i32 s65, s61, 3145728
    s_lshl_b32 s70, s64, 2
    s_and_b32 s71, s60, 3
    s_add_u32 s70, s70, s71
    s_mul_i32 s70, s70, 3072
    s_add_u32 s65, s65, s70
    v_mul_u32_u24 v2, 384, v20
    v_lshl_add_u32 v2, v21, 4, v2
    s_mov_b32 s34, 201326592
    s_mov_b32 s35, 0x20000
    s_mov_b32 s30, 2560
    s_mov_b32 s31, 0x20000
    s_mov_b32 s42, 7864320
    s_mov_b32 s43, 0x20000
    s_mov_b32 s58, 4194304
    s_mov_b32 s59, 0x20000
    s_mov_b32 s38, 201326592
    s_mov_b32 s39, 0x20000
    s_mov_b32 s50, 2560
    s_mov_b32 s51, 0x20000
    s_mov_b32 s54, 256
    s_mov_b32 s55, 0x20000
    s_cmp_lt_u32 s60, 4
    s_cbranch_scc1 L_helper
    s_mul_i32 s79, s61, 9
    s_add_u32 s75, s65, 100663296
    s_waitcnt lgkmcnt(0)
    s_mov_b32 s32, s6
    s_mov_b32 s33, s7
    s_add_u32 s66, s79, 0
    s_and_b32 s66, s66, 31
    s_mul_i32 s66, s66, 98304
    s_add_u32 s66, s66, s65
    buffer_load_dwordx4 v[36:39], v2, s[32:35], s66 offen offset:0 nt
    buffer_load_dwordx4 v[40:43], v2, s[32:35], s66 offen offset:128 nt
    buffer_load_dwordx4 v[44:47], v2, s[32:35], s66 offen offset:256 nt
    s_add_u32 s66, s79, 1
    s_and_b32 s66, s66, 31
    s_mul_i32 s66, s66, 98304
    s_add_u32 s66, s66, s65
    buffer_load_dwordx4 v[48:51], v2, s[32:35], s66 offen offset:0 nt
    buffer_load_dwordx4 v[52:55], v2, s[32:35], s66 offen offset:128 nt
    buffer_load_dwordx4 v[56:59], v2, s[32:35], s66 offen offset:256 nt
    s_mov_b32 s36, s8
    s_mov_b32 s37, s9
    s_mov_b32 s56, s24
    s_mov_b32 s57, s25
    s_barrier
    s_mov_b32 s101, 1
    s_mov_b32 s20, 0
    s_mov_b32 s76, 0
    s_mov_b32 s68, 0
    s_lshr_b32 s70, s2, 7
    s_lshl_b32 s70, s70, 3
    s_add_u32 s70, s70, s78
    s_lshl_b32 s70, s70, 2
    s_bfe_u32 s71, s2, 0x40003
    s_cmp_eq_u32 s71, 3
    s_cselect_b32 s70, s70, 4194304
    s_cmp_eq_u32 s60, 4
    s_cselect_b32 s70, s70, 4194304
    v_mov_b32 v253, s70
    v_mov_b32 v6, 4194304
    v_cmp_eq_u32 vcc, 0, v1
    s_nop 1
    v_cndmask_b32 v253, v6, v253, vcc
    v_mul_u32_u24 v252, 96, v21
    v_mul_u32_u24 v6, 12, v20
    v_add_u32 v252, v252, v6
    s_and_b32 s63, s60, 3
    s_mul_i32 s69, s63, 768
    v_add_u32 v252, s69, v252
    v_lshlrev_b32 v18, 4, v1
    v_cmp_gt_u32 vcc, 48, v1
    v_mov_b32 v19, 4194304
    s_nop 0
    v_cndmask_b32 v19, v19, v18, vcc
    v_mov_b32 v17, 1
    s_cmp_ge_u32 s101, 3
    s_cbranch_scc1 L_go1
    s_waitcnt vmcnt(6)
    s_cmp_ge_u32 s101, 2
    s_cbranch_scc1 L_go1
    s_waitcnt vmcnt(5)
    s_cmp_ge_u32 s101, 1
    s_cbranch_scc1 L_go1
    s_waitcnt vmcnt(4)
L_go1:
    s_add_u32 s66, s79, 2
    s_and_b32 s66, s66, 31
    s_mul_i32 s66, s66, 98304
    s_add_u32 s66, s66, s65
    buffer_load_dwordx4 v[68:71], v2, s[32:35], s66 offen offset:0 nt
    s_cmp_ge_u32 s101, 3
    s_cbranch_scc1 L_go2
    s_waitcnt vmcnt(6)
    s_cmp_ge_u32 s101, 2
    s_cbranch_scc1 L_go2
    s_waitcnt vmcnt(5)
    s_cmp_ge_u32 s101, 1
    s_cbranch_scc1 L_go2
    s_waitcnt vmcnt(4)
L_go2:
    buffer_load_dwordx4 v[72:75], v2, s[32:35], s66 offen offset:128 nt
    s_waitcnt vmcnt(7)
    s_cmp_ge_u32 s101, 3
    s_cbranch_scc1 L_go3
    s_waitcnt vmcnt(6)
    s_cmp_ge_u32 s101, 2
    s_cbranch_scc1 L_go3
    s_waitcnt vmcnt(5)
    s_cmp_ge_u32 s101, 1
    s_cbranch_scc1 L_go3
    s_waitcnt vmcnt(4)
L_go3:
    buffer_load_dwordx4 v[76:79], v2, s[32:35], s66 offen offset:256 nt
    s_waitcnt vmcnt(7)
    s_cmp_ge_u32 s101, 3
    s_cbranch_scc1 L_go4
    s_waitcnt vmcnt(6)
    s_cmp_ge_u32 s101, 2
    s_cbranch_scc1 L_go4
    s_waitcnt vmcnt(5)
    s_cmp_ge_u32 s101, 1
    s_cbranch_scc1 L_go4
    s_waitcnt vmcnt(4)
L_go4:
    s_add_u32 s66, s79, 3
    s_and_b32 s66, s66, 31
    s_mul_i32 s66, s66, 98304
    s_add_u32 s66, s66, s65
    buffer_load_dwordx4 v[80:83], v2, s[32:35], s66 offen offset:0 nt
    s_waitcnt vmcnt(7)
    s_cmp_ge_u32 s101, 3
    s_cbranch_scc1 L_go5
    s_waitcnt vmcnt(6)
    s_cmp_ge_u32 s101, 2
    s_cbranch_scc1 L_go5
    s_waitcnt vmcnt(5)
    s_cmp_ge_u32 s101, 1
    s_cbranch_scc1 L_go5
    s_waitcnt vmcnt(4)
L_go5:
    buffer_load_dwordx4 v[84:87], v2, s[32:35], s66 offen offset:128 nt
    s_waitcnt vmcnt(7)
    s_cmp_ge_u32 s101, 3
    s_cbranch_scc1 L_go6
    s_waitcnt vmcnt(6)
    s_cmp_ge_u32 s101, 2
    s_cbranch_scc1 L_go6
    s_waitcnt vmcnt(5)
    s_cmp_ge_u32 s101, 1
    s_cbranch_scc1 L_go6
    s_waitcnt vmcnt(4)
L_go6:
    buffer_load_dwordx4 v[88:91], v2, s[32:35], s66 offen offset:256 nt
    s_waitcnt vmcnt(7)
    s_cmp_ge_u32 s101, 3
    s_cbranch_scc1 L_go7
    s_waitcnt vmcnt(6)
    s_cmp_ge_u32 s101, 2
    s_cbranch_scc1 L_go7
    s_waitcnt vmcnt(5)
    s_cmp_ge_u32 s101, 1
    s_cbranch_scc1 L_go7
    s_waitcnt vmcnt(4)
L_go7:
    s_add_u32 s66, s79, 4
    s_and_b32 s66, s66, 31
    s_mul_i32 s66, s66, 98304
    s_add_u32 s66, s66, s65
    buffer_load_dwordx4 v[92:95], v2, s[32:35], s66 offen offset:0 nt
    s_waitcnt vmcnt(7)
    s_cmp_ge_u32 s101, 3
    s_cbranch_scc1 L_go8
    s_waitcnt vmcnt(6)
    s_cmp_ge_u32 s101, 2
    s_cbranch_scc1 L_go8
    s_waitcnt vmcnt(5)
    s_cmp_ge_u32 s101, 1
    s_cbranch_scc1 L_go8
    s_waitcnt vmcnt(4)
L_go8:
    buffer_load_dwordx4 v[96:99], v2, s[32:35], s66 offen offset:128 nt
    s_waitcnt vmcnt(7)
    s_cmp_ge_u32 s101, 3
    s_cbranch_scc1 L_go9
    s_waitcnt vmcnt(6)
    s_cmp_ge_u32 s101, 2
    s_cbranch_scc1 L_go9
    s_waitcnt vmcnt(5)
    s_cmp_ge_u32 s101, 1
    s_cbranch_scc1 L_go9
    s_waitcnt vmcnt(4)
L_go9:
    buffer_load_dwordx4 v[100:103], v2, s[32:35], s66 offen offset:256 nt
    s_waitcnt vmcnt(7)
    s_cmp_ge_u32 s101, 3
    s_cbranch_scc1 L_go10
    s_waitcnt vmcnt(6)
    s_cmp_ge_u32 s101, 2
    s_cbranch_scc1 L_go10
    s_waitcnt vmcnt(5)
    s_cmp_ge_u32 s101, 1
    s_cbranch_scc1 L_go10
    s_waitcnt vmcnt(4)
L_go10:
    s_add_u32 s66, s79, 5
    s_and_b32 s66, s66, 31
    s_mul_i32 s66, s66, 98304
    s_add_u32 s66, s66, s65
    buffer_load_dwordx4 v[104:107], v2, s[32:35], s66 offen offset:0 nt
    s_waitcnt vmcnt(7)
    s_cmp_ge_u32 s101, 3
    s_cbranch_scc1 L_go11
    s_waitcnt vmcnt(6)
    s_cmp_ge_u32 s101, 2
    s_cbranch_scc1 L_go11
    s_waitcnt vmcnt(5)
    s_cmp_ge_u32 s101, 1
    s_cbranch_scc1 L_go11
    s_waitcnt vmcnt(4)
L_go11:
    buffer_load_dwordx4 v[108:111], v2, s[32:35], s66 offen offset:128 nt
    s_waitcnt vmcnt(7)
    s_cmp_ge_u32 s101, 3
    s_cbranch_scc1 L_go12
    s_waitcnt vmcnt(6)
    s_cmp_ge_u32 s101, 2
    s_cbranch_scc1 L_go12
    s_waitcnt vmcnt(5)
    s_cmp_ge_u32 s101, 1
    s_cbranch_scc1 L_go12
    s_waitcnt vmcnt(4)
L_go12:
    buffer_load_dwordx4 v[112:115], v2, s[32:35], s66 offen offset:256 nt
    s_waitcnt vmcnt(7)
    s_cmp_ge_u32 s101, 3
    s_cbranch_scc1 L_go13
    s_waitcnt vmcnt(6)
    s_cmp_ge_u32 s101, 2
    s_cbranch_scc1 L_go13
    s_waitcnt vmcnt(5)
    s_cmp_ge_u32 s101, 1
    s_cbranch_scc1 L_go13
    s_waitcnt vmcnt(4)
L_go13:
    s_add_u32 s66, s79, 6
    s_and_b32 s66, s66, 31
    s_mul_i32 s66, s66, 98304
    s_add_u32 s66, s66, s65
    buffer_load_dwordx4 v[116:119], v2, s[32:35], s66 offen offset:0 nt
    s_waitcnt vmcnt(7)
    s_cmp_ge_u32 s101, 3
    s_cbranch_scc1 L_go14
    s_waitcnt vmcnt(6)
    s_cmp_ge_u32 s101, 2
    s_cbranch_scc1 L_go14
    s_waitcnt vmcnt(5)
    s_cmp_ge_u32 s101, 1
    s_cbranch_scc1 L_go14
    s_waitcnt vmcnt(4)
L_go14:
    buffer_load_dwordx4 v[120:123], v2, s[32:35], s66 offen offset:128 nt
    s_waitcnt vmcnt(7)
    s_cmp_ge_u32 s101, 3
    s_cbranch_scc1 L_go15
    s_waitcnt vmcnt(6)
    s_cmp_ge_u32 s101, 2
    s_cbranch_scc1 L_go15
    s_waitcnt vmcnt(5)
    s_cmp_ge_u32 s101, 1
    s_cbranch_scc1 L_go15
    s_waitcnt vmcnt(4)
L_go15:
    buffer_load_dwordx4 v[124:127], v2, s[32:35], s66 offen offset:256 nt
    s_waitcnt vmcnt(7)
    s_cmp_ge_u32 s101, 3
    s_cbranch_scc1 L_go16
    s_waitcnt vmcnt(6)
    s_cmp_ge_u32 s101, 2
    s_cbranch_scc1 L_go16
    s_waitcnt vmcnt(5)
    s_cmp_ge_u32 s101, 1
    s_cbranch_scc1 L_go16
    s_waitcnt vmcnt(4)
L_go16:
    s_add_u32 s66, s79, 7
    s_and_b32 s66, s66, 31
    s_mul_i32 s66, s66, 98304
    s_add_u32 s66, s66, s65
    buffer_load_dwordx4 v[128:131], v2, s[32:35], s66 offen offset:0 nt
    s_waitcnt vmcnt(7)
    s_cmp_ge_u32 s101, 3
    s_cbranch_scc1 L_go17
    s_waitcnt vmcnt(6)
    s_cmp_ge_u32 s101, 2
    s_cbranch_scc1 L_go17
    s_waitcnt vmcnt(5)
    s_cmp_ge_u32 s101, 1
    s_cbranch_scc1 L_go17
    s_waitcnt vmcnt(4)
L_go17:
    buffer_load_dwordx4 v[132:135], v2, s[32:35], s66 offen offset:128 nt
    s_waitcnt vmcnt(7)
    s_cmp_ge_u32 s101, 3
    s_cbranch_scc1 L_go18
    s_waitcnt vmcnt(6)
    s_cmp_ge_u32 s101, 2
    s_cbranch_scc1 L_go18
    s_waitcnt vmcnt(5)
    s_cmp_ge_u32 s101, 1
    s_cbranch_scc1 L_go18
    s_waitcnt vmcnt(4)
L_go18:
    buffer_load_dwordx4 v[136:139], v2, s[32:35], s66 offen offset:256 nt
    s_waitcnt vmcnt(7)
    s_cmp_ge_u32 s101, 3
    s_cbranch_scc1 L_go19
    s_waitcnt vmcnt(6)
    s_cmp_ge_u32 s101, 2
    s_cbranch_scc1 L_go19
    s_waitcnt vmcnt(5)
    s_cmp_ge_u32 s101, 1
    s_cbranch_scc1 L_go19
    s_waitcnt vmcnt(4)
L_go19:
    s_add_u32 s66, s79, 8
    s_and_b32 s66, s66, 31
    s_mul_i32 s66, s66, 98304
    s_add_u32 s66, s66, s65
    buffer_load_dwordx4 v[140:143], v2, s[32:35], s66 offen offset:0 nt
    s_waitcnt vmcnt(7)
    s_cmp_ge_u32 s101, 3
    s_cbranch_scc1 L_go20
    s_waitcnt vmcnt(6)
    s_cmp_ge_u32 s101, 2
    s_cbranch_scc1 L_go20
    s_waitcnt vmcnt(5)
    s_cmp_ge_u32 s101, 1
    s_cbranch_scc1 L_go20
    s_waitcnt vmcnt(4)
L_go20:
    buffer_load_dwordx4 v[144:147], v2, s[32:35], s66 offen offset:128 nt
    s_waitcnt vmcnt(7)
    s_cmp_ge_u32 s101, 3
    s_cbranch_scc1 L_go21
    s_waitcnt vmcnt(6)
    s_cmp_ge_u32 s101, 2
    s_cbranch_scc1 L_go21
    s_waitcnt vmcnt(5)
    s_cmp_ge_u32 s101, 1
    s_cbranch_scc1 L_go21
    s_waitcnt vmcnt(4)
L_go21:
    buffer_load_dwordx4 v[148:151], v2, s[32:35], s66 offen offset:256 nt
    s_waitcnt vmcnt(7)
    s_cmp_ge_u32 s101, 3
    s_cbranch_scc1 L_go22
    s_waitcnt vmcnt(6)
    s_cmp_ge_u32 s101, 2
    s_cbranch_scc1 L_go22
    s_waitcnt vmcnt(5)
    s_cmp_ge_u32 s101, 1
    s_cbranch_scc1 L_go22
    s_waitcnt vmcnt(4)
L_go22:
    s_add_u32 s66, s79, 9
    s_and_b32 s66, s66, 31
    s_mul_i32 s66, s66, 98304
    s_add_u32 s66, s66, s65
    buffer_load_dwordx4 v[152:155], v2, s[32:35], s66 offen offset:0 nt
    s_waitcnt vmcnt(7)
    s_cmp_ge_u32 s101, 3
    s_cbranch_scc1 L_go23
    s_waitcnt vmcnt(6)
    s_cmp_ge_u32 s101, 2
    s_cbranch_scc1 L_go23
    s_waitcnt vmcnt(5)
    s_cmp_ge_u32 s101, 1
    s_cbranch_scc1 L_go23
    s_waitcnt vmcnt(4)
L_go23:
    buffer_load_dwordx4 v[156:159], v2, s[32:35], s66 offen offset:128 nt
    s_waitcnt vmcnt(7)
    s_cmp_ge_u32 s101, 3
    s_cbranch_scc1 L_go24
    s_waitcnt vmcnt(6)
    s_cmp_ge_u32 s101, 2
    s_cbranch_scc1 L_go24
    s_waitcnt vmcnt(5)
    s_cmp_ge_u32 s101, 1
    s_cbranch_scc1 L_go24
    s_waitcnt vmcnt(4)
L_go24:
    buffer_load_dwordx4 v[160:163], v2, s[32:35], s66 offen offset:256 nt
    s_waitcnt vmcnt(7)
    s_cmp_ge_u32 s101, 3
    s_cbranch_scc1 L_go25
    s_waitcnt vmcnt(6)
    s_cmp_ge_u32 s101, 2
    s_cbranch_scc1 L_go25
    s_waitcnt vmcnt(5)
    s_cmp_ge_u32 s101, 1
    s_cbranch_scc1 L_go25
    s_waitcnt vmcnt(4)
L_go25:
    s_add_u32 s66, s79, 10
    s_and_b32 s66, s66, 31
    s_mul_i32 s66, s66, 98304
    s_add_u32 s66, s66, s65
    buffer_load_dwordx4 v[164:167], v2, s[32:35], s66 offen offset:0 nt
    s_waitcnt vmcnt(7)
    s_cmp_ge_u32 s101, 3
    s_cbranch_scc1 L_go26
    s_waitcnt vmcnt(6)
    s_cmp_ge_u32 s101, 2
    s_cbranch_scc1 L_go26
    s_waitcnt vmcnt(5)
    s_cmp_ge_u32 s101, 1
    s_cbranch_scc1 L_go26
    s_waitcnt vmcnt(4)
L_go26:
    buffer_load_dwordx4 v[168:171], v2, s[32:35], s66 offen offset:128 nt
    s_waitcnt vmcnt(7)
    s_cmp_ge_u32 s101, 3
    s_cbranch_scc1 L_go27
    s_waitcnt vmcnt(6)
    s_cmp_ge_u32 s101, 2
    s_cbranch_scc1 L_go27
    s_waitcnt vmcnt(5)
    s_cmp_ge_u32 s101, 1
    s_cbranch_scc1 L_go27
    s_waitcnt vmcnt(4)
L_go27:
    buffer_load_dwordx4 v[172:175], v2, s[32:35], s66 offen offset:256 nt
    s_waitcnt vmcnt(7)
    s_cmp_ge_u32 s101, 3
    s_cbranch_scc1 L_go28
    s_waitcnt vmcnt(6)
    s_cmp_ge_u32 s101, 2
    s_cbranch_scc1 L_go28
    s_waitcnt vmcnt(5)
    s_cmp_ge_u32 s101, 1
    s_cbranch_scc1 L_go28
    s_waitcnt vmcnt(4)
L_go28:
    s_add_u32 s66, s79, 11
    s_and_b32 s66, s66, 31
    s_mul_i32 s66, s66, 98304
    s_add_u32 s66, s66, s65
    buffer_load_dwordx4 v[176:179], v2, s[32:35], s66 offen offset:0 nt
    s_waitcnt vmcnt(7)
    s_cmp_ge_u32 s101, 3
    s_cbranch_scc1 L_go29
    s_waitcnt vmcnt(6)
    s_cmp_ge_u32 s101, 2
    s_cbranch_scc1 L_go29
    s_waitcnt vmcnt(5)
    s_cmp_ge_u32 s101, 1
    s_cbranch_scc1 L_go29
    s_waitcnt vmcnt(4)
L_go29:
    buffer_load_dwordx4 v[180:183], v2, s[32:35], s66 offen offset:128 nt
    s_waitcnt vmcnt(7)
    s_cmp_ge_u32 s101, 3
    s_cbranch_scc1 L_go30
    s_waitcnt vmcnt(6)
    s_cmp_ge_u32 s101, 2
    s_cbranch_scc1 L_go30
    s_waitcnt vmcnt(5)
    s_cmp_ge_u32 s101, 1
    s_cbranch_scc1 L_go30
    s_waitcnt vmcnt(4)
L_go30:
    buffer_load_dwordx4 v[184:187], v2, s[32:35], s66 offen offset:256 nt
    s_waitcnt vmcnt(7)
    s_cmp_ge_u32 s101, 3
    s_cbranch_scc1 L_go31
    s_waitcnt vmcnt(6)
    s_cmp_ge_u32 s101, 2
    s_cbranch_scc1 L_go31
    s_waitcnt vmcnt(5)
    s_cmp_ge_u32 s101, 1
    s_cbranch_scc1 L_go31
    s_waitcnt vmcnt(4)
L_go31:
    s_add_u32 s66, s79, 12
    s_and_b32 s66, s66, 31
    s_mul_i32 s66, s66, 98304
    s_add_u32 s66, s66, s65
    buffer_load_dwordx4 v[188:191], v2, s[32:35], s66 offen offset:0 nt
    s_waitcnt vmcnt(7)
    s_cmp_ge_u32 s101, 3
    s_cbranch_scc1 L_go32
    s_waitcnt vmcnt(6)
    s_cmp_ge_u32 s101, 2
    s_cbranch_scc1 L_go32
    s_waitcnt vmcnt(5)
    s_cmp_ge_u32 s101, 1
    s_cbranch_scc1 L_go32
    s_waitcnt vmcnt(4)
L_go32:
    buffer_load_dwordx4 v[192:195], v2, s[32:35], s66 offen offset:128 nt
    s_waitcnt vmcnt(7)
    s_cmp_ge_u32 s101, 3
    s_cbranch_scc1 L_go33
    s_waitcnt vmcnt(6)
    s_cmp_ge_u32 s101, 2
    s_cbranch_scc1 L_go33
    s_waitcnt vmcnt(5)
    s_cmp_ge_u32 s101, 1
    s_cbranch_scc1 L_go33
    s_waitcnt vmcnt(4)
L_go33:
    buffer_load_dwordx4 v[196:199], v2, s[32:35], s66 offen offset:256 nt
    s_waitcnt vmcnt(7)
    s_cmp_ge_u32 s101, 3
    s_cbranch_scc1 L_go34
    s_waitcnt vmcnt(6)
    s_cmp_ge_u32 s101, 2
    s_cbranch_scc1 L_go34
    s_waitcnt vmcnt(5)
    s_cmp_ge_u32 s101, 1
    s_cbranch_scc1 L_go34
    s_waitcnt vmcnt(4)
L_go34:
    s_add_u32 s66, s79, 13
    s_and_b32 s66, s66, 31
    s_mul_i32 s66, s66, 98304
    s_add_u32 s66, s66, s65
    buffer_load_dwordx4 v[200:203], v2, s[32:35], s66 offen offset:0 nt
    s_waitcnt vmcnt(7)
    s_cmp_ge_u32 s101, 3
    s_cbranch_scc1 L_go35
    s_waitcnt vmcnt(6)
    s_cmp_ge_u32 s101, 2
    s_cbranch_scc1 L_go35
    s_waitcnt vmcnt(5)
    s_cmp_ge_u32 s101, 1
    s_cbranch_scc1 L_go35
    s_waitcnt vmcnt(4)
L_go35:
    buffer_load_dwordx4 v[204:207], v2, s[32:35], s66 offen offset:128 nt
    s_waitcnt vmcnt(7)
    s_cmp_ge_u32 s101, 3
    s_cbranch_scc1 L_go36
    s_waitcnt vmcnt(6)
    s_cmp_ge_u32 s101, 2
    s_cbranch_scc1 L_go36
    s_waitcnt vmcnt(5)
    s_cmp_ge_u32 s101, 1
    s_cbranch_scc1 L_go36
    s_waitcnt vmcnt(4)
L_go36:
    buffer_load_dwordx4 v[208:211], v2, s[32:35], s66 offen offset:256 nt
    s_waitcnt vmcnt(7)
    s_cmp_ge_u32 s101, 3
    s_cbranch_scc1 L_go37
    s_waitcnt vmcnt(6)
    s_cmp_ge_u32 s101, 2
    s_cbranch_scc1 L_go37
    s_waitcnt vmcnt(5)
    s_cmp_ge_u32 s101, 1
    s_cbranch_scc1 L_go37
    s_waitcnt vmcnt(4)
L_go37:
    s_add_u32 s66, s79, 14
    s_and_b32 s66, s66, 31
    s_mul_i32 s66, s66, 98304
    s_add_u32 s66, s66, s65
    buffer_load_dwordx4 v[212:215], v2, s[32:35], s66 offen offset:0 nt
    s_waitcnt vmcnt(7)
    s_cmp_ge_u32 s101, 3
    s_cbranch_scc1 L_go38
    s_waitcnt vmcnt(6)
    s_cmp_ge_u32 s101, 2
    s_cbranch_scc1 L_go38
    s_waitcnt vmcnt(5)
    s_cmp_ge_u32 s101, 1
    s_cbranch_scc1 L_go38
    s_waitcnt vmcnt(4)
L_go38:
    buffer_load_dwordx4 v[216:219], v2, s[32:35], s66 offen offset:128 nt
    s_waitcnt vmcnt(7)
    s_cmp_ge_u32 s101, 3
    s_cbranch_scc1 L_go39
    s_waitcnt vmcnt(6)
    s_cmp_ge_u32 s101, 2
    s_cbranch_scc1 L_go39
    s_waitcnt vmcnt(5)
    s_cmp_ge_u32 s101, 1
    s_cbranch_scc1 L_go39
    s_waitcnt vmcnt(4)
L_go39:
    buffer_load_dwordx4 v[220:223], v2, s[32:35], s66 offen offset:256 nt
    s_waitcnt vmcnt(7)
    s_cmp_ge_u32 s101, 3
    s_cbranch_scc1 L_go40
    s_waitcnt vmcnt(6)
    s_cmp_ge_u32 s101, 2
    s_cbranch_scc1 L_go40
    s_waitcnt vmcnt(5)
    s_cmp_ge_u32 s101, 1
    s_cbranch_scc1 L_go40
    s_waitcnt vmcnt(4)
L_go40:
    s_add_u32 s66, s79, 15
    s_and_b32 s66, s66, 31
    s_mul_i32 s66, s66, 98304
    s_add_u32 s66, s66, s65
    buffer_load_dwordx4 v[224:227], v2, s[32:35], s66 offen offset:0 nt
    s_waitcnt vmcnt(7)
    s_cmp_ge_u32 s101, 3
    s_cbranch_scc1 L_go41
    s_waitcnt vmcnt(6)
    s_cmp_ge_u32 s101, 2
    s_cbranch_scc1 L_go41
    s_waitcnt vmcnt(5)
    s_cmp_ge_u32 s101, 1
    s_cbranch_scc1 L_go41
    s_waitcnt vmcnt(4)
L_go41:
    buffer_load_dwordx4 v[228:231], v2, s[32:35], s66 offen offset:128 nt
    s_waitcnt vmcnt(7)
    s_cmp_ge_u32 s101, 3
    s_cbranch_scc1 L_go42
    s_waitcnt vmcnt(6)
    s_cmp_ge_u32 s101, 2
    s_cbranch_scc1 L_go42
    s_waitcnt vmcnt(5)
    s_cmp_ge_u32 s101, 1
    s_cbranch_scc1 L_go42
    s_waitcnt vmcnt(4)
L_go42:
    buffer_load_dwordx4 v[232:235], v2, s[32:35], s66 offen offset:256 nt
    s_waitcnt vmcnt(7)
    s_cmp_ge_u32 s101, 3
    s_cbranch_scc1 L_go43
    s_waitcnt vmcnt(6)
    s_cmp_ge_u32 s101, 2
    s_cbranch_scc1 L_go43
    s_waitcnt vmcnt(5)
    s_cmp_ge_u32 s101, 1
    s_cbranch_scc1 L_go43
    s_waitcnt vmcnt(4)
L_go43:
    s_add_u32 s66, s79, 16
    s_and_b32 s66, s66, 31
    s_mul_i32 s66, s66, 98304
    s_add_u32 s66, s66, s65
    buffer_load_dwordx4 v[236:239], v2, s[32:35], s66 offen offset:0 nt
    s_waitcnt vmcnt(7)
    s_cmp_ge_u32 s101, 3
    s_cbranch_scc1 L_go44
    s_waitcnt vmcnt(6)
    s_cmp_ge_u32 s101, 2
    s_cbranch_scc1 L_go44
    s_waitcnt vmcnt(5)
    s_cmp_ge_u32 s101, 1
    s_cbranch_scc1 L_go44
    s_waitcnt vmcnt(4)
L_go44:
    buffer_load_dwordx4 v[240:243], v2, s[32:35], s66 offen offset:128 nt
    s_waitcnt vmcnt(7)
    s_cmp_ge_u32 s101, 3
    s_cbranch_scc1 L_go45
    s_waitcnt vmcnt(6)
    s_cmp_ge_u32 s101, 2
    s_cbranch_scc1 L_go45
    s_waitcnt vmcnt(5)
    s_cmp_ge_u32 s101, 1
    s_cbranch_scc1 L_go45
    s_waitcnt vmcnt(4)
L_go45:
    buffer_load_dwordx4 v[244:247], v2, s[32:35], s66 offen offset:256 nt
    s_mov_b32 s101, 1
    v_lshlrev_b32 v12, 4, v21
    s_mov_b32 s74, 0
L_ql0_spin:
    ds_read_b128 v[24:27], v12 offset:128
    ds_read_b128 v[28:31], v12 offset:256
    ds_read_b128 v[32:35], v12 offset:384
    s_waitcnt lgkmcnt(0)
    v_max3_u32 v13, v24, v25, v26
    v_max3_u32 v13, v13, v27, v28
    v_max3_u32 v13, v13, v29, v30
    v_max3_u32 v13, v13, v31, v32
    v_max3_u32 v13, v13, v33, v34
    v_max_u32 v13, v13, v35
    v_cmp_eq_u32 vcc, -1, v13
    s_cbranch_vccz L_ql0_done
    s_add_u32 s74, s74, 1
    s_cmp_ge_u32 s74, s100
    s_cbranch_scc1 L_ql0_done
    s_sleep 1
    s_branch L_ql0_spin
L_ql0_done:
    v_dot2_f32_bf16 v4, v36, v24, 0
    v_dot2_f32_bf16 v4, v37, v25, v4
    v_dot2_f32_bf16 v4, v38, v26, v4
    v_dot2_f32_bf16 v4, v39, v27, v4
    v_dot2_f32_bf16 v5, v40, v28, 0
    v_dot2_f32_bf16 v5, v41, v29, v5
    v_dot2_f32_bf16 v5, v42, v30, v5
    v_dot2_f32_bf16 v5, v43, v31, v5
    s_waitcnt vmcnt(7)
    s_cmp_ge_u32 s101, 3
    s_cbranch_scc1 L_go46
    s_waitcnt vmcnt(6)
    s_cmp_ge_u32 s101, 2
    s_cbranch_scc1 L_go46
    s_waitcnt vmcnt(5)
    s_cmp_ge_u32 s101, 1
    s_cbranch_scc1 L_go46
    s_waitcnt vmcnt(4)
L_go46:
    s_add_u32 s66, s79, 17
    s_and_b32 s66, s66, 31
    s_mul_i32 s66, s66, 98304
    s_add_u32 s66, s66, s65
    buffer_load_dwordx4 v[248:251], v2, s[32:35], s66 offen offset:0 nt
    v_dot2_f32_bf16 v6, v44, v32, 0
    v_dot2_f32_bf16 v6, v45, v33, v6
    v_dot2_f32_bf16 v6, v46, v34, v6
    v_dot2_f32_bf16 v6, v47, v35, v6
    v_add_f32 v60, v4, v5
    s_nop 1
    v_add_f32 v60, v60, v6
    s_nop 1
    v_add_f32_dpp v60, v60, v60 quad_perm:[1,0,3,2] row_mask:0xf bank_mask:0xf
    s_nop 1
    v_add_f32_dpp v60, v60, v60 quad_perm:[2,3,0,1] row_mask:0xf bank_mask:0xf
    s_nop 1
    v_add_f32_dpp v60, v60, v60 row_half_mirror row_mask:0xf bank_mask:0xf
    v_cvt_pk_bf16_f32 v60, v60, v60
    v_lshlrev_b32 v60, 16, v60
    v_mul_f32 v60, 0x3d93cd3a, v60
    v_cvt_pk_bf16_f32 v60, v60, v60
    v_lshlrev_b32 v60, 16, v60
    v_mov_b32 v22, v60
    v_dot2_f32_bf16 v4, v48, v24, 0
    v_dot2_f32_bf16 v4, v49, v25, v4
    v_dot2_f32_bf16 v4, v50, v26, v4
    v_dot2_f32_bf16 v4, v51, v27, v4
    v_dot2_f32_bf16 v5, v52, v28, 0
    v_dot2_f32_bf16 v5, v53, v29, v5
    v_dot2_f32_bf16 v5, v54, v30, v5
    v_dot2_f32_bf16 v5, v55, v31, v5
    v_dot2_f32_bf16 v6, v56, v32, 0
    v_dot2_f32_bf16 v6, v57, v33, v6
    v_dot2_f32_bf16 v6, v58, v34, v6
    v_dot2_f32_bf16 v6, v59, v35, v6
    v_add_f32 v61, v4, v5
    s_nop 1
    v_add_f32 v61, v61, v6
    s_nop 1
    v_add_f32_dpp v61, v61, v61 quad_perm:[1,0,3,2] row_mask:0xf bank_mask:0xf
    s_nop 1
    v_add_f32_dpp v61, v61, v61 quad_perm:[2,3,0,1] row_mask:0xf bank_mask:0xf
    s_nop 1
    v_add_f32_dpp v61, v61, v61 row_half_mirror row_mask:0xf bank_mask:0xf
    v_cvt_pk_bf16_f32 v61, v61, v61
    v_lshlrev_b32 v61, 16, v61
    v_mul_f32 v61, 0x3d93cd3a, v61
    v_cvt_pk_bf16_f32 v61, v61, v61
    v_lshlrev_b32 v61, 16, v61
    v_max_f32 v22, v22, v61
    v_dot2_f32_bf16 v4, v68, v24, 0
    v_dot2_f32_bf16 v4, v69, v25, v4
    v_dot2_f32_bf16 v4, v70, v26, v4
    v_dot2_f32_bf16 v4, v71, v27, v4
    v_dot2_f32_bf16 v5, v72, v28, 0
    v_dot2_f32_bf16 v5, v73, v29, v5
    v_dot2_f32_bf16 v5, v74, v30, v5
    v_dot2_f32_bf16 v5, v75, v31, v5
    v_dot2_f32_bf16 v6, v76, v32, 0
    v_dot2_f32_bf16 v6, v77, v33, v6
    v_dot2_f32_bf16 v6, v78, v34, v6
    v_dot2_f32_bf16 v6, v79, v35, v6
    v_add_f32 v62, v4, v5
    s_nop 1
    v_add_f32 v62, v62, v6
    s_nop 1
    v_add_f32_dpp v62, v62, v62 quad_perm:[1,0,3,2] row_mask:0xf bank_mask:0xf
    s_nop 1
    v_add_f32_dpp v62, v62, v62 quad_perm:[2,3,0,1] row_mask:0xf bank_mask:0xf
    s_nop 1
    v_add_f32_dpp v62, v62, v62 row_half_mirror row_mask:0xf bank_mask:0xf
    v_cvt_pk_bf16_f32 v62, v62, v62
    v_lshlrev_b32 v62, 16, v62
    v_mul_f32 v62, 0x3d93cd3a, v62
    v_cvt_pk_bf16_f32 v62, v62, v62
    v_lshlrev_b32 v62, 16, v62
    v_max_f32 v22, v22, v62
    v_dot2_f32_bf16 v4, v80, v24, 0
    v_dot2_f32_bf16 v4, v81, v25, v4
    v_dot2_f32_bf16 v4, v82, v26, v4
    v_dot2_f32_bf16 v4, v83, v27, v4
    v_dot2_f32_bf16 v5, v84, v28, 0
    v_dot2_f32_bf16 v5, v85, v29, v5
    v_dot2_f32_bf16 v5, v86, v30, v5
    v_dot2_f32_bf16 v5, v87, v31, v5
    v_dot2_f32_bf16 v6, v88, v32, 0
    v_dot2_f32_bf16 v6, v89, v33, v6
    v_dot2_f32_bf16 v6, v90, v34, v6
    v_dot2_f32_bf16 v6, v91, v35, v6
    v_add_f32 v63, v4, v5
    s_nop 1
    v_add_f32 v63, v63, v6
    s_nop 1
    v_add_f32_dpp v63, v63, v63 quad_perm:[1,0,3,2] row_mask:0xf bank_mask:0xf
    s_nop 1
    v_add_f32_dpp v63, v63, v63 quad_perm:[2,3,0,1] row_mask:0xf bank_mask:0xf
    s_nop 1
    v_add_f32_dpp v63, v63, v63 row_half_mirror row_mask:0xf bank_mask:0xf
    v_cvt_pk_bf16_f32 v63, v63, v63
    v_lshlrev_b32 v63, 16, v63
    v_mul_f32 v63, 0x3d93cd3a, v63
    v_cvt_pk_bf16_f32 v63, v63, v63
    v_lshlrev_b32 v63, 16, v63
    v_max_f32 v22, v22, v63
    v_dot2_f32_bf16 v4, v92, v24, 0
    v_dot2_f32_bf16 v4, v93, v25, v4
    v_dot2_f32_bf16 v4, v94, v26, v4
    v_dot2_f32_bf16 v4, v95, v27, v4
    v_dot2_f32_bf16 v5, v96, v28, 0
    v_dot2_f32_bf16 v5, v97, v29, v5
    v_dot2_f32_bf16 v5, v98, v30, v5
    v_dot2_f32_bf16 v5, v99, v31, v5
    s_waitcnt vmcnt(7)
    s_cmp_ge_u32 s101, 3
    s_cbranch_scc1 L_go47
    s_waitcnt vmcnt(6)
    s_cmp_ge_u32 s101, 2
    s_cbranch_scc1 L_go47
    s_waitcnt vmcnt(5)
    s_cmp_ge_u32 s101, 1
    s_cbranch_scc1 L_go47
    s_waitcnt vmcnt(4)
L_go47:
    buffer_load_dwordx4 v[92:95], v2, s[32:35], s66 offen offset:128 nt
    v_dot2_f32_bf16 v6, v100, v32, 0
    v_dot2_f32_bf16 v6, v101, v33, v6
    v_dot2_f32_bf16 v6, v102, v34, v6
    v_dot2_f32_bf16 v6, v103, v35, v6
    v_add_f32 v64, v4, v5
    s_nop 1
    v_add_f32 v64, v64, v6
    s_nop 1
    v_add_f32_dpp v64, v64, v64 quad_perm:[1,0,3,2] row_mask:0xf bank_mask:0xf
    s_nop 1
    v_add_f32_dpp v64, v64, v64 quad_perm:[2,3,0,1] row_mask:0xf bank_mask:0xf
    s_nop 1
    v_add_f32_dpp v64, v64, v64 row_half_mirror row_mask:0xf bank_mask:0xf
    v_cvt_pk_bf16_f32 v64, v64, v64
    v_lshlrev_b32 v64, 16, v64
    v_mul_f32 v64, 0x3d93cd3a, v64
    v_cvt_pk_bf16_f32 v64, v64, v64
    v_lshlrev_b32 v64, 16, v64
    v_max_f32 v22, v22, v64
    v_dot2_f32_bf16 v4, v104, v24, 0
    v_dot2_f32_bf16 v4, v105, v25, v4
    v_dot2_f32_bf16 v4, v106, v26, v4
    v_dot2_f32_bf16 v4, v107, v27, v4
    v_dot2_f32_bf16 v5, v108, v28, 0
    v_dot2_f32_bf16 v5, v109, v29, v5
    v_dot2_f32_bf16 v5, v110, v30, v5
    v_dot2_f32_bf16 v5, v111, v31, v5
    s_waitcnt vmcnt(7)
    s_cmp_ge_u32 s101, 3
    s_cbranch_scc1 L_go48
    s_waitcnt vmcnt(6)
    s_cmp_ge_u32 s101, 2
    s_cbranch_scc1 L_go48
    s_waitcnt vmcnt(5)
    s_cmp_ge_u32 s101, 1
    s_cbranch_scc1 L_go48
    s_waitcnt vmcnt(4)
L_go48:
    buffer_load_dwordx4 v[96:99], v2, s[32:35], s66 offen offset:256 nt
    v_dot2_f32_bf16 v6, v112, v32, 0
    v_dot2_f32_bf16 v6, v113, v33, v6
    v_dot2_f32_bf16 v6, v114, v34, v6
    v_dot2_f32_bf16 v6, v115, v35, v6
    v_add_f32 v65, v4, v5
    s_nop 1
    v_add_f32 v65, v65, v6
    s_nop 1
    v_add_f32_dpp v65, v65, v65 quad_perm:[1,0,3,2] row_mask:0xf bank_mask:0xf
    s_nop 1
    v_add_f32_dpp v65, v65, v65 quad_perm:[2,3,0,1] row_mask:0xf bank_mask:0xf
    s_nop 1
    v_add_f32_dpp v65, v65, v65 row_half_mirror row_mask:0xf bank_mask:0xf
    v_cvt_pk_bf16_f32 v65, v65, v65
    v_lshlrev_b32 v65, 16, v65
    v_mul_f32 v65, 0x3d93cd3a, v65
    v_cvt_pk_bf16_f32 v65, v65, v65
    v_lshlrev_b32 v65, 16, v65
    v_max_f32 v22, v22, v65
    v_dot2_f32_bf16 v4, v116, v24, 0
    v_dot2_f32_bf16 v4, v117, v25, v4
    v_dot2_f32_bf16 v4, v118, v26, v4
    v_dot2_f32_bf16 v4, v119, v27, v4
    v_dot2_f32_bf16 v5, v120, v28, 0
    v_dot2_f32_bf16 v5, v121, v29, v5
    v_dot2_f32_bf16 v5, v122, v30, v5
    v_dot2_f32_bf16 v5, v123, v31, v5
    s_waitcnt vmcnt(7)
    s_cmp_ge_u32 s101, 3
    s_cbranch_scc1 L_go49
    s_waitcnt vmcnt(6)
    s_cmp_ge_u32 s101, 2
    s_cbranch_scc1 L_go49
    s_waitcnt vmcnt(5)
    s_cmp_ge_u32 s101, 1
    s_cbranch_scc1 L_go49
    s_waitcnt vmcnt(4)
L_go49:
    s_add_u32 s66, s79, 18
    s_and_b32 s66, s66, 31
    s_mul_i32 s66, s66, 98304
    s_add_u32 s66, s66, s65
    buffer_load_dwordx4 v[100:103], v2, s[32:35], s66 offen offset:0 nt
    v_dot2_f32_bf16 v6, v124, v32, 0
    v_dot2_f32_bf16 v6, v125, v33, v6
    v_dot2_f32_bf16 v6, v126, v34, v6
    v_dot2_f32_bf16 v6, v127, v35, v6
    v_add_f32 v66, v4, v5
    s_nop 1
    v_add_f32 v66, v66, v6
    s_nop 1
    v_add_f32_dpp v66, v66, v66 quad_perm:[1,0,3,2] row_mask:0xf bank_mask:0xf
    s_nop 1
    v_add_f32_dpp v66, v66, v66 quad_perm:[2,3,0,1] row_mask:0xf bank_mask:0xf
    s_nop 1
    v_add_f32_dpp v66, v66, v66 row_half_mirror row_mask:0xf bank_mask:0xf
    v_cvt_pk_bf16_f32 v66, v66, v66
    v_lshlrev_b32 v66, 16, v66
    v_mul_f32 v66, 0x3d93cd3a, v66
    v_cvt_pk_bf16_f32 v66, v66, v66
    v_lshlrev_b32 v66, 16, v66
    v_max_f32 v22, v22, v66
    v_dot2_f32_bf16 v4, v128, v24, 0
    v_dot2_f32_bf16 v4, v129, v25, v4
    v_dot2_f32_bf16 v4, v130, v26, v4
    v_dot2_f32_bf16 v4, v131, v27, v4
    v_dot2_f32_bf16 v5, v132, v28, 0
    v_dot2_f32_bf16 v5, v133, v29, v5
    v_dot2_f32_bf16 v5, v134, v30, v5
    v_dot2_f32_bf16 v5, v135, v31, v5
    s_waitcnt vmcnt(7)
    s_cmp_ge_u32 s101, 3
    s_cbranch_scc1 L_go50
    s_waitcnt vmcnt(6)
    s_cmp_ge_u32 s101, 2
    s_cbranch_scc1 L_go50
    s_waitcnt vmcnt(5)
    s_cmp_ge_u32 s101, 1
    s_cbranch_scc1 L_go50
    s_waitcnt vmcnt(4)
L_go50:
    buffer_load_dwordx4 v[104:107], v2, s[32:35], s66 offen offset:128 nt
    v_dot2_f32_bf16 v6, v136, v32, 0
    v_dot2_f32_bf16 v6, v137, v33, v6
    v_dot2_f32_bf16 v6, v138, v34, v6
    v_dot2_f32_bf16 v6, v139, v35, v6
    v_add_f32 v67, v4, v5
    s_nop 1
    v_add_f32 v67, v67, v6
    s_nop 1
    v_add_f32_dpp v67, v67, v67 quad_perm:[1,0,3,2] row_mask:0xf bank_mask:0xf
    s_nop 1
    v_add_f32_dpp v67, v67, v67 quad_perm:[2,3,0,1] row_mask:0xf bank_mask:0xf
    s_nop 1
    v_add_f32_dpp v67, v67, v67 row_half_mirror row_mask:0xf bank_mask:0xf
    v_cvt_pk_bf16_f32 v67, v67, v67
    v_lshlrev_b32 v67, 16, v67
    v_mul_f32 v67, 0x3d93cd3a, v67
    v_cvt_pk_bf16_f32 v67, v67, v67
    v_lshlrev_b32 v67, 16, v67
    v_max_f32 v22, v22, v67
    v_dot2_f32_bf16 v4, v140, v24, 0
    v_dot2_f32_bf16 v4, v141, v25, v4
    v_dot2_f32_bf16 v4, v142, v26, v4
    v_dot2_f32_bf16 v4, v143, v27, v4
    v_dot2_f32_bf16 v5, v144, v28, 0
    v_dot2_f32_bf16 v5, v145, v29, v5
    v_dot2_f32_bf16 v5, v146, v30, v5
    v_dot2_f32_bf16 v5, v147, v31, v5
    s_waitcnt vmcnt(7)
    s_cmp_ge_u32 s101, 3
    s_cbranch_scc1 L_go51
    s_waitcnt vmcnt(6)
    s_cmp_ge_u32 s101, 2
    s_cbranch_scc1 L_go51
    s_waitcnt vmcnt(5)
    s_cmp_ge_u32 s101, 1
    s_cbranch_scc1 L_go51
    s_waitcnt vmcnt(4)
L_go51:
    buffer_load_dwordx4 v[108:111], v2, s[32:35], s66 offen offset:256 nt
    v_dot2_f32_bf16 v6, v148, v32, 0
    v_dot2_f32_bf16 v6, v149, v33, v6
    v_dot2_f32_bf16 v6, v150, v34, v6
    v_dot2_f32_bf16 v6, v151, v35, v6
    v_add_f32 v68, v4, v5
    s_nop 1
    v_add_f32 v68, v68, v6
    s_nop 1
    v_add_f32_dpp v68, v68, v68 quad_perm:[1,0,3,2] row_mask:0xf bank_mask:0xf
    s_nop 1
    v_add_f32_dpp v68, v68, v68 quad_perm:[2,3,0,1] row_mask:0xf bank_mask:0xf
    s_nop 1
    v_add_f32_dpp v68, v68, v68 row_half_mirror row_mask:0xf bank_mask:0xf
    v_cvt_pk_bf16_f32 v68, v68, v68
    v_lshlrev_b32 v68, 16, v68
    v_mul_f32 v68, 0x3d93cd3a, v68
    v_cvt_pk_bf16_f32 v68, v68, v68
    v_lshlrev_b32 v68, 16, v68
    v_max_f32 v22, v22, v68
    v_dot2_f32_bf16 v4, v152, v24, 0
    v_dot2_f32_bf16 v4, v153, v25, v4
    v_dot2_f32_bf16 v4, v154, v26, v4
    v_dot2_f32_bf16 v4, v155, v27, v4
    v_dot2_f32_bf16 v5, v156, v28, 0
    v_dot2_f32_bf16 v5, v157, v29, v5
    v_dot2_f32_bf16 v5, v158, v30, v5
    v_dot2_f32_bf16 v5, v159, v31, v5
    s_waitcnt vmcnt(7)
    s_cmp_ge_u32 s101, 3
    s_cbranch_scc1 L_go52
    s_waitcnt vmcnt(6)
    s_cmp_ge_u32 s101, 2
    s_cbranch_scc1 L_go52
    s_waitcnt vmcnt(5)
    s_cmp_ge_u32 s101, 1
    s_cbranch_scc1 L_go52
    s_waitcnt vmcnt(4)
L_go52:
    s_add_u32 s66, s79, 19
    s_and_b32 s66, s66, 31
    s_mul_i32 s66, s66, 98304
    s_add_u32 s66, s66, s65
    buffer_load_dwordx4 v[112:115], v2, s[32:35], s66 offen offset:0 nt
    v_dot2_f32_bf16 v6, v160, v32, 0
    v_dot2_f32_bf16 v6, v161, v33, v6
    v_dot2_f32_bf16 v6, v162, v34, v6
    v_dot2_f32_bf16 v6, v163, v35, v6
    v_add_f32 v69, v4, v5
    s_nop 1
    v_add_f32 v69, v69, v6
    s_nop 1
    v_add_f32_dpp v69, v69, v69 quad_perm:[1,0,3,2] row_mask:0xf bank_mask:0xf
    s_nop 1
    v_add_f32_dpp v69, v69, v69 quad_perm:[2,3,0,1] row_mask:0xf bank_mask:0xf
    s_nop 1
    v_add_f32_dpp v69, v69, v69 row_half_mirror row_mask:0xf bank_mask:0xf
    v_cvt_pk_bf16_f32 v69, v69, v69
    v_lshlrev_b32 v69, 16, v69
    v_mul_f32 v69, 0x3d93cd3a, v69
    v_cvt_pk_bf16_f32 v69, v69, v69
    v_lshlrev_b32 v69, 16, v69
    v_max_f32 v22, v22, v69
    v_dot2_f32_bf16 v4, v164, v24, 0
    v_dot2_f32_bf16 v4, v165, v25, v4
    v_dot2_f32_bf16 v4, v166, v26, v4
    v_dot2_f32_bf16 v4, v167, v27, v4
    v_dot2_f32_bf16 v5, v168, v28, 0
    v_dot2_f32_bf16 v5, v169, v29, v5
    v_dot2_f32_bf16 v5, v170, v30, v5
    v_dot2_f32_bf16 v5, v171, v31, v5
    s_waitcnt vmcnt(7)
    s_cmp_ge_u32 s101, 3
    s_cbranch_scc1 L_go53
    s_waitcnt vmcnt(6)
    s_cmp_ge_u32 s101, 2
    s_cbranch_scc1 L_go53
    s_waitcnt vmcnt(5)
    s_cmp_ge_u32 s101, 1
    s_cbranch_scc1 L_go53
    s_waitcnt vmcnt(4)
L_go53:
    buffer_load_dwordx4 v[116:119], v2, s[32:35], s66 offen offset:128 nt
    v_dot2_f32_bf16 v6, v172, v32, 0
    v_dot2_f32_bf16 v6, v173, v33, v6
    v_dot2_f32_bf16 v6, v174, v34, v6
    v_dot2_f32_bf16 v6, v175, v35, v6
    v_add_f32 v70, v4, v5
    s_nop 1
    v_add_f32 v70, v70, v6
    s_nop 1
    v_add_f32_dpp v70, v70, v70 quad_perm:[1,0,3,2] row_mask:0xf bank_mask:0xf
    s_nop 1
    v_add_f32_dpp v70, v70, v70 quad_perm:[2,3,0,1] row_mask:0xf bank_mask:0xf
    s_nop 1
    v_add_f32_dpp v70, v70, v70 row_half_mirror row_mask:0xf bank_mask:0xf
    v_cvt_pk_bf16_f32 v70, v70, v70
    v_lshlrev_b32 v70, 16, v70
    v_mul_f32 v70, 0x3d93cd3a, v70
    v_cvt_pk_bf16_f32 v70, v70, v70
    v_lshlrev_b32 v70, 16, v70
    v_max_f32 v22, v22, v70
    v_dot2_f32_bf16 v4, v176, v24, 0
    v_dot2_f32_bf16 v4, v177, v25, v4
    v_dot2_f32_bf16 v4, v178, v26, v4
    v_dot2_f32_bf16 v4, v179, v27, v4
    v_dot2_f32_bf16 v5, v180, v28, 0
    v_dot2_f32_bf16 v5, v181, v29, v5
    v_dot2_f32_bf16 v5, v182, v30, v5
    v_dot2_f32_bf16 v5, v183, v31, v5
    s_waitcnt vmcnt(7)
    s_cmp_ge_u32 s101, 3
    s_cbranch_scc1 L_go54
    s_waitcnt vmcnt(6)
    s_cmp_ge_u32 s101, 2
    s_cbranch_scc1 L_go54
    s_waitcnt vmcnt(5)
    s_cmp_ge_u32 s101, 1
    s_cbranch_scc1 L_go54
    s_waitcnt vmcnt(4)
L_go54:
    buffer_load_dwordx4 v[120:123], v2, s[32:35], s66 offen offset:256 nt
    v_dot2_f32_bf16 v6, v184, v32, 0
    v_dot2_f32_bf16 v6, v185, v33, v6
    v_dot2_f32_bf16 v6, v186, v34, v6
    v_dot2_f32_bf16 v6, v187, v35, v6
    v_add_f32 v71, v4, v5
    s_nop 1
    v_add_f32 v71, v71, v6
    s_nop 1
    v_add_f32_dpp v71, v71, v71 quad_perm:[1,0,3,2] row_mask:0xf bank_mask:0xf
    s_nop 1
    v_add_f32_dpp v71, v71, v71 quad_perm:[2,3,0,1] row_mask:0xf bank_mask:0xf
    s_nop 1
    v_add_f32_dpp v71, v71, v71 row_half_mirror row_mask:0xf bank_mask:0xf
    v_cvt_pk_bf16_f32 v71, v71, v71
    v_lshlrev_b32 v71, 16, v71
    v_mul_f32 v71, 0x3d93cd3a, v71
    v_cvt_pk_bf16_f32 v71, v71, v71
    v_lshlrev_b32 v71, 16, v71
    v_max_f32 v22, v22, v71
    v_dot2_f32_bf16 v4, v188, v24, 0
    v_dot2_f32_bf16 v4, v189, v25, v4
    v_dot2_f32_bf16 v4, v190, v26, v4
    v_dot2_f32_bf16 v4, v191, v27, v4
    v_dot2_f32_bf16 v5, v192, v28, 0
    v_dot2_f32_bf16 v5, v193, v29, v5
    v_dot2_f32_bf16 v5, v194, v30, v5
    v_dot2_f32_bf16 v5, v195, v31, v5
    s_waitcnt vmcnt(7)
    s_cmp_ge_u32 s101, 3
    s_cbranch_scc1 L_go55
    s_waitcnt vmcnt(6)
    s_cmp_ge_u32 s101, 2
    s_cbranch_scc1 L_go55
    s_waitcnt vmcnt(5)
    s_cmp_ge_u32 s101, 1
    s_cbranch_scc1 L_go55
    s_waitcnt vmcnt(4)
L_go55:
    s_add_u32 s66, s79, 20
    s_and_b32 s66, s66, 31
    s_mul_i32 s66, s66, 98304
    s_add_u32 s66, s66, s65
    buffer_load_dwordx4 v[124:127], v2, s[32:35], s66 offen offset:0 nt
    v_dot2_f32_bf16 v6, v196, v32, 0
    v_dot2_f32_bf16 v6, v197, v33, v6
    v_dot2_f32_bf16 v6, v198, v34, v6
    v_dot2_f32_bf16 v6, v199, v35, v6
    v_add_f32 v72, v4, v5
    s_nop 1
    v_add_f32 v72, v72, v6
    s_nop 1
    v_add_f32_dpp v72, v72, v72 quad_perm:[1,0,3,2] row_mask:0xf bank_mask:0xf
    s_nop 1
    v_add_f32_dpp v72, v72, v72 quad_perm:[2,3,0,1] row_mask:0xf bank_mask:0xf
    s_nop 1
    v_add_f32_dpp v72, v72, v72 row_half_mirror row_mask:0xf bank_mask:0xf
    v_cvt_pk_bf16_f32 v72, v72, v72
    v_lshlrev_b32 v72, 16, v72
    v_mul_f32 v72, 0x3d93cd3a, v72
    v_cvt_pk_bf16_f32 v72, v72, v72
    v_lshlrev_b32 v72, 16, v72
    v_max_f32 v22, v22, v72
    v_dot2_f32_bf16 v4, v200, v24, 0
    v_dot2_f32_bf16 v4, v201, v25, v4
    v_dot2_f32_bf16 v4, v202, v26, v4
    v_dot2_f32_bf16 v4, v203, v27, v4
    v_dot2_f32_bf16 v5, v204, v28, 0
    v_dot2_f32_bf16 v5, v205, v29, v5
    v_dot2_f32_bf16 v5, v206, v30, v5
    v_dot2_f32_bf16 v5, v207, v31, v5
    s_waitcnt vmcnt(7)
    s_cmp_ge_u32 s101, 3
    s_cbranch_scc1 L_go56
    s_waitcnt vmcnt(6)
    s_cmp_ge_u32 s101, 2
    s_cbranch_scc1 L_go56
    s_waitcnt vmcnt(5)
    s_cmp_ge_u32 s101, 1
    s_cbranch_scc1 L_go56
    s_waitcnt vmcnt(4)
L_go56:
    buffer_load_dwordx4 v[128:131], v2, s[32:35], s66 offen offset:128 nt
    v_dot2_f32_bf16 v6, v208, v32, 0
    v_dot2_f32_bf16 v6, v209, v33, v6
    v_dot2_f32_bf16 v6, v210, v34, v6
    v_dot2_f32_bf16 v6, v211, v35, v6
    v_add_f32 v73, v4, v5
    s_nop 1
    v_add_f32 v73, v73, v6
    s_nop 1
    v_add_f32_dpp v73, v73, v73 quad_perm:[1,0,3,2] row_mask:0xf bank_mask:0xf
    s_nop 1
    v_add_f32_dpp v73, v73, v73 quad_perm:[2,3,0,1] row_mask:0xf bank_mask:0xf
    s_nop 1
    v_add_f32_dpp v73, v73, v73 row_half_mirror row_mask:0xf bank_mask:0xf
    v_cvt_pk_bf16_f32 v73, v73, v73
    v_lshlrev_b32 v73, 16, v73
    v_mul_f32 v73, 0x3d93cd3a, v73
    v_cvt_pk_bf16_f32 v73, v73, v73
    v_lshlrev_b32 v73, 16, v73
    v_max_f32 v22, v22, v73
    v_dot2_f32_bf16 v4, v212, v24, 0
    v_dot2_f32_bf16 v4, v213, v25, v4
    v_dot2_f32_bf16 v4, v214, v26, v4
    v_dot2_f32_bf16 v4, v215, v27, v4
    v_dot2_f32_bf16 v5, v216, v28, 0
    v_dot2_f32_bf16 v5, v217, v29, v5
    v_dot2_f32_bf16 v5, v218, v30, v5
    v_dot2_f32_bf16 v5, v219, v31, v5
    s_waitcnt vmcnt(7)
    s_cmp_ge_u32 s101, 3
    s_cbranch_scc1 L_go57
    s_waitcnt vmcnt(6)
    s_cmp_ge_u32 s101, 2
    s_cbranch_scc1 L_go57
    s_waitcnt vmcnt(5)
    s_cmp_ge_u32 s101, 1
    s_cbranch_scc1 L_go57
    s_waitcnt vmcnt(4)
L_go57:
    buffer_load_dwordx4 v[132:135], v2, s[32:35], s66 offen offset:256 nt
    v_dot2_f32_bf16 v6, v220, v32, 0
    v_dot2_f32_bf16 v6, v221, v33, v6
    v_dot2_f32_bf16 v6, v222, v34, v6
    v_dot2_f32_bf16 v6, v223, v35, v6
    v_add_f32 v74, v4, v5
    s_nop 1
    v_add_f32 v74, v74, v6
    s_nop 1
    v_add_f32_dpp v74, v74, v74 quad_perm:[1,0,3,2] row_mask:0xf bank_mask:0xf
    s_nop 1
    v_add_f32_dpp v74, v74, v74 quad_perm:[2,3,0,1] row_mask:0xf bank_mask:0xf
    s_nop 1
    v_add_f32_dpp v74, v74, v74 row_half_mirror row_mask:0xf bank_mask:0xf
    v_cvt_pk_bf16_f32 v74, v74, v74
    v_lshlrev_b32 v74, 16, v74
    v_mul_f32 v74, 0x3d93cd3a, v74
    v_cvt_pk_bf16_f32 v74, v74, v74
    v_lshlrev_b32 v74, 16, v74
    v_max_f32 v22, v22, v74
    v_dot2_f32_bf16 v4, v224, v24, 0
    v_dot2_f32_bf16 v4, v225, v25, v4
    v_dot2_f32_bf16 v4, v226, v26, v4
    v_dot2_f32_bf16 v4, v227, v27, v4
    v_dot2_f32_bf16 v5, v228, v28, 0
    v_dot2_f32_bf16 v5, v229, v29, v5
    v_dot2_f32_bf16 v5, v230, v30, v5
    v_dot2_f32_bf16 v5, v231, v31, v5
    s_waitcnt vmcnt(7)
    s_cmp_ge_u32 s101, 3
    s_cbranch_scc1 L_go58
    s_waitcnt vmcnt(6)
    s_cmp_ge_u32 s101, 2
    s_cbranch_scc1 L_go58
    s_waitcnt vmcnt(5)
    s_cmp_ge_u32 s101, 1
    s_cbranch_scc1 L_go58
    s_waitcnt vmcnt(4)
L_go58:
    s_add_u32 s66, s79, 21
    s_and_b32 s66, s66, 31
    s_mul_i32 s66, s66, 98304
    s_add_u32 s66, s66, s65
    buffer_load_dwordx4 v[136:139], v2, s[32:35], s66 offen offset:0 nt
    v_dot2_f32_bf16 v6, v232, v32, 0
    v_dot2_f32_bf16 v6, v233, v33, v6
    v_dot2_f32_bf16 v6, v234, v34, v6
    v_dot2_f32_bf16 v6, v235, v35, v6
    v_add_f32 v75, v4, v5
    s_nop 1
    v_add_f32 v75, v75, v6
    s_nop 1
    v_add_f32_dpp v75, v75, v75 quad_perm:[1,0,3,2] row_mask:0xf bank_mask:0xf
    s_nop 1
    v_add_f32_dpp v75, v75, v75 quad_perm:[2,3,0,1] row_mask:0xf bank_mask:0xf
    s_nop 1
    v_add_f32_dpp v75, v75, v75 row_half_mirror row_mask:0xf bank_mask:0xf
    v_cvt_pk_bf16_f32 v75, v75, v75
    v_lshlrev_b32 v75, 16, v75
    v_mul_f32 v75, 0x3d93cd3a, v75
    v_cvt_pk_bf16_f32 v75, v75, v75
    v_lshlrev_b32 v75, 16, v75
    v_max_f32 v22, v22, v75
    v_dot2_f32_bf16 v4, v236, v24, 0
    v_dot2_f32_bf16 v4, v237, v25, v4
    v_dot2_f32_bf16 v4, v238, v26, v4
    v_dot2_f32_bf16 v4, v239, v27, v4
    v_dot2_f32_bf16 v5, v240, v28, 0
    v_dot2_f32_bf16 v5, v241, v29, v5
    v_dot2_f32_bf16 v5, v242, v30, v5
    v_dot2_f32_bf16 v5, v243, v31, v5
    s_waitcnt vmcnt(7)
    s_cmp_ge_u32 s101, 3
    s_cbranch_scc1 L_go59
    s_waitcnt vmcnt(6)
    s_cmp_ge_u32 s101, 2
    s_cbranch_scc1 L_go59
    s_waitcnt vmcnt(5)
    s_cmp_ge_u32 s101, 1
    s_cbranch_scc1 L_go59
    s_waitcnt vmcnt(4)
L_go59:
    buffer_load_dwordx4 v[140:143], v2, s[32:35], s66 offen offset:128 nt
    v_dot2_f32_bf16 v6, v244, v32, 0
    v_dot2_f32_bf16 v6, v245, v33, v6
    v_dot2_f32_bf16 v6, v246, v34, v6
    v_dot2_f32_bf16 v6, v247, v35, v6
    v_add_f32 v76, v4, v5
    s_nop 1
    v_add_f32 v76, v76, v6
    s_nop 1
    v_add_f32_dpp v76, v76, v76 quad_perm:[1,0,3,2] row_mask:0xf bank_mask:0xf
    s_nop 1
    v_add_f32_dpp v76, v76, v76 quad_perm:[2,3,0,1] row_mask:0xf bank_mask:0xf
    s_nop 1
    v_add_f32_dpp v76, v76, v76 row_half_mirror row_mask:0xf bank_mask:0xf
    v_cvt_pk_bf16_f32 v76, v76, v76
    v_lshlrev_b32 v76, 16, v76
    v_mul_f32 v76, 0x3d93cd3a, v76
    v_cvt_pk_bf16_f32 v76, v76, v76
    v_lshlrev_b32 v76, 16, v76
    v_max_f32 v22, v22, v76
    v_dot2_f32_bf16 v4, v248, v24, 0
    v_dot2_f32_bf16 v4, v249, v25, v4
    v_dot2_f32_bf16 v4, v250, v26, v4
    v_dot2_f32_bf16 v4, v251, v27, v4
    v_dot2_f32_bf16 v5, v92, v28, 0
    v_dot2_f32_bf16 v5, v93, v29, v5
    v_dot2_f32_bf16 v5, v94, v30, v5
    v_dot2_f32_bf16 v5, v95, v31, v5
    s_waitcnt vmcnt(7)
    s_cmp_ge_u32 s101, 3
    s_cbranch_scc1 L_go60
    s_waitcnt vmcnt(6)
    s_cmp_ge_u32 s101, 2
    s_cbranch_scc1 L_go60
    s_waitcnt vmcnt(5)
    s_cmp_ge_u32 s101, 1
    s_cbranch_scc1 L_go60
    s_waitcnt vmcnt(4)
L_go60:
    buffer_load_dwordx4 v[144:147], v2, s[32:35], s66 offen offset:256 nt
    v_dot2_f32_bf16 v6, v96, v32, 0
    v_dot2_f32_bf16 v6, v97, v33, v6
    v_dot2_f32_bf16 v6, v98, v34, v6
    v_dot2_f32_bf16 v6, v99, v35, v6
    v_add_f32 v77, v4, v5
    s_nop 1
    v_add_f32 v77, v77, v6
    s_nop 1
    v_add_f32_dpp v77, v77, v77 quad_perm:[1,0,3,2] row_mask:0xf bank_mask:0xf
    s_nop 1
    v_add_f32_dpp v77, v77, v77 quad_perm:[2,3,0,1] row_mask:0xf bank_mask:0xf
    s_nop 1
    v_add_f32_dpp v77, v77, v77 row_half_mirror row_mask:0xf bank_mask:0xf
    v_cvt_pk_bf16_f32 v77, v77, v77
    v_lshlrev_b32 v77, 16, v77
    v_mul_f32 v77, 0x3d93cd3a, v77
    v_cvt_pk_bf16_f32 v77, v77, v77
    v_lshlrev_b32 v77, 16, v77
    v_max_f32 v22, v22, v77
    v_dot2_f32_bf16 v4, v100, v24, 0
    v_dot2_f32_bf16 v4, v101, v25, v4
    v_dot2_f32_bf16 v4, v102, v26, v4
    v_dot2_f32_bf16 v4, v103, v27, v4
    v_dot2_f32_bf16 v5, v104, v28, 0
    v_dot2_f32_bf16 v5, v105, v29, v5
    v_dot2_f32_bf16 v5, v106, v30, v5
    v_dot2_f32_bf16 v5, v107, v31, v5
    s_waitcnt vmcnt(7)
    s_cmp_ge_u32 s101, 3
    s_cbranch_scc1 L_go61
    s_waitcnt vmcnt(6)
    s_cmp_ge_u32 s101, 2
    s_cbranch_scc1 L_go61
    s_waitcnt vmcnt(5)
    s_cmp_ge_u32 s101, 1
    s_cbranch_scc1 L_go61
    s_waitcnt vmcnt(4)
L_go61:
    s_add_u32 s66, s79, 22
    s_and_b32 s66, s66, 31
    s_mul_i32 s66, s66, 98304
    s_add_u32 s66, s66, s65
    buffer_load_dwordx4 v[148:151], v2, s[32:35], s66 offen offset:0 nt
    v_dot2_f32_bf16 v6, v108, v32, 0
    v_dot2_f32_bf16 v6, v109, v33, v6
    v_dot2_f32_bf16 v6, v110, v34, v6
    v_dot2_f32_bf16 v6, v111, v35, v6
    v_add_f32 v78, v4, v5
    s_nop 1
    v_add_f32 v78, v78, v6
    s_nop 1
    v_add_f32_dpp v78, v78, v78 quad_perm:[1,0,3,2] row_mask:0xf bank_mask:0xf
    s_nop 1
    v_add_f32_dpp v78, v78, v78 quad_perm:[2,3,0,1] row_mask:0xf bank_mask:0xf
    s_nop 1
    v_add_f32_dpp v78, v78, v78 row_half_mirror row_mask:0xf bank_mask:0xf
    v_cvt_pk_bf16_f32 v78, v78, v78
    v_lshlrev_b32 v78, 16, v78
    v_mul_f32 v78, 0x3d93cd3a, v78
    v_cvt_pk_bf16_f32 v78, v78, v78
    v_lshlrev_b32 v78, 16, v78
    v_max_f32 v22, v22, v78
    ds_write_b32 v3, v17 offset:28
    v_dot2_f32_bf16 v4, v112, v24, 0
    v_dot2_f32_bf16 v4, v113, v25, v4
    v_dot2_f32_bf16 v4, v114, v26, v4
    v_dot2_f32_bf16 v4, v115, v27, v4
    v_dot2_f32_bf16 v5, v116, v28, 0
    v_dot2_f32_bf16 v5, v117, v29, v5
    v_dot2_f32_bf16 v5, v118, v30, v5
    v_dot2_f32_bf16 v5, v119, v31, v5
    s_waitcnt vmcnt(7)
    s_cmp_ge_u32 s101, 3
    s_cbranch_scc1 L_go62
    s_waitcnt vmcnt(6)
    s_cmp_ge_u32 s101, 2
    s_cbranch_scc1 L_go62
    s_waitcnt vmcnt(5)
    s_cmp_ge_u32 s101, 1
    s_cbranch_scc1 L_go62
    s_waitcnt vmcnt(4)
L_go62:
    buffer_load_dwordx4 v[152:155], v2, s[32:35], s66 offen offset:128 nt
    v_dot2_f32_bf16 v6, v120, v32, 0
    v_dot2_f32_bf16 v6, v121, v33, v6
    v_dot2_f32_bf16 v6, v122, v34, v6
    v_dot2_f32_bf16 v6, v123, v35, v6
    v_add_f32 v79, v4, v5
    s_nop 1
    v_add_f32 v79, v79, v6
    s_nop 1
    v_add_f32_dpp v79, v79, v79 quad_perm:[1,0,3,2] row_mask:0xf bank_mask:0xf
    s_nop 1
    v_add_f32_dpp v79, v79, v79 quad_perm:[2,3,0,1] row_mask:0xf bank_mask:0xf
    s_nop 1
    v_add_f32_dpp v79, v79, v79 row_half_mirror row_mask:0xf bank_mask:0xf
    v_cvt_pk_bf16_f32 v79, v79, v79
    v_lshlrev_b32 v79, 16, v79
    v_mul_f32 v79, 0x3d93cd3a, v79
    v_cvt_pk_bf16_f32 v79, v79, v79
    v_lshlrev_b32 v79, 16, v79
    v_max_f32 v22, v22, v79
    s_waitcnt vmcnt(7)
    s_cmp_ge_u32 s101, 3
    s_cbranch_scc1 L_go63
    s_waitcnt vmcnt(6)
    s_cmp_ge_u32 s101, 2
    s_cbranch_scc1 L_go63
    s_waitcnt vmcnt(5)
    s_cmp_ge_u32 s101, 1
    s_cbranch_scc1 L_go63
    s_waitcnt vmcnt(4)
L_go63:
    buffer_load_dwordx4 v[156:159], v2, s[32:35], s66 offen offset:256 nt
    v_dot2_f32_bf16 v4, v124, v24, 0
    v_dot2_f32_bf16 v4, v125, v25, v4
    v_dot2_f32_bf16 v4, v126, v26, v4
    v_dot2_f32_bf16 v4, v127, v27, v4
    s_waitcnt vmcnt(7)
    s_cmp_ge_u32 s101, 3
    s_cbranch_scc1 L_go64
    s_waitcnt vmcnt(6)
    s_cmp_ge_u32 s101, 2
    s_cbranch_scc1 L_go64
    s_waitcnt vmcnt(5)
    s_cmp_ge_u32 s101, 1
    s_cbranch_scc1 L_go64
    s_waitcnt vmcnt(4)
L_go64:
    s_add_u32 s66, s79, 23
    s_and_b32 s66, s66, 31
    s_mul_i32 s66, s66, 98304
    s_add_u32 s66, s66, s65
    buffer_load_dwordx4 v[160:163], v2, s[32:35], s66 offen offset:0 nt
    v_dot2_f32_bf16 v5, v128, v28, 0
    v_dot2_f32_bf16 v5, v129, v29, v5
    v_dot2_f32_bf16 v5, v130, v30, v5
    v_dot2_f32_bf16 v5, v131, v31, v5
    s_waitcnt vmcnt(7)
    s_cmp_ge_u32 s101, 3
    s_cbranch_scc1 L_go65
    s_waitcnt vmcnt(6)
    s_cmp_ge_u32 s101, 2
    s_cbranch_scc1 L_go65
    s_waitcnt vmcnt(5)
    s_cmp_ge_u32 s101, 1
    s_cbranch_scc1 L_go65
    s_waitcnt vmcnt(4)
L_go65:
    buffer_load_dwordx4 v[164:167], v2, s[32:35], s66 offen offset:128 nt
    v_dot2_f32_bf16 v6, v132, v32, 0
    v_dot2_f32_bf16 v6, v133, v33, v6
    v_dot2_f32_bf16 v6, v134, v34, v6
    v_dot2_f32_bf16 v6, v135, v35, v6
    v_add_f32 v80, v4, v5
    s_nop 1
    v_add_f32 v80, v80, v6
    s_nop 1
    v_add_f32_dpp v80, v80, v80 quad_perm:[1,0,3,2] row_mask:0xf bank_mask:0xf
    s_nop 1
    v_add_f32_dpp v80, v80, v80 quad_perm:[2,3,0,1] row_mask:0xf bank_mask:0xf
    s_nop 1
    v_add_f32_dpp v80, v80, v80 row_half_mirror row_mask:0xf bank_mask:0xf
    v_cvt_pk_bf16_f32 v80, v80, v80
    v_lshlrev_b32 v80, 16, v80
    v_mul_f32 v80, 0x3d93cd3a, v80
    v_cvt_pk_bf16_f32 v80, v80, v80
    v_lshlrev_b32 v80, 16, v80
    v_max_f32 v22, v22, v80
    s_waitcnt vmcnt(7)
    s_cmp_ge_u32 s101, 3
    s_cbranch_scc1 L_go66
    s_waitcnt vmcnt(6)
    s_cmp_ge_u32 s101, 2
    s_cbranch_scc1 L_go66
    s_waitcnt vmcnt(5)
    s_cmp_ge_u32 s101, 1
    s_cbranch_scc1 L_go66
    s_waitcnt vmcnt(4)
L_go66:
    buffer_load_dwordx4 v[168:171], v2, s[32:35], s66 offen offset:256 nt
    v_dot2_f32_bf16 v4, v136, v24, 0
    v_dot2_f32_bf16 v4, v137, v25, v4
    v_dot2_f32_bf16 v4, v138, v26, v4
    v_dot2_f32_bf16 v4, v139, v27, v4
    s_waitcnt vmcnt(7)
    s_cmp_ge_u32 s101, 3
    s_cbranch_scc1 L_go67
    s_waitcnt vmcnt(6)
    s_cmp_ge_u32 s101, 2
    s_cbranch_scc1 L_go67
    s_waitcnt vmcnt(5)
    s_cmp_ge_u32 s101, 1
    s_cbranch_scc1 L_go67
    s_waitcnt vmcnt(4)
L_go67:
    s_add_u32 s66, s79, 24
    s_and_b32 s66, s66, 31
    s_mul_i32 s66, s66, 98304
    s_add_u32 s66, s66, s65
    buffer_load_dwordx4 v[172:175], v2, s[32:35], s66 offen offset:0 nt
    v_dot2_f32_bf16 v5, v140, v28, 0
    v_dot2_f32_bf16 v5, v141, v29, v5
    v_dot2_f32_bf16 v5, v142, v30, v5
    v_dot2_f32_bf16 v5, v143, v31, v5
    s_waitcnt vmcnt(7)
    s_cmp_ge_u32 s101, 3
    s_cbranch_scc1 L_go68
    s_waitcnt vmcnt(6)
    s_cmp_ge_u32 s101, 2
    s_cbranch_scc1 L_go68
    s_waitcnt vmcnt(5)
    s_cmp_ge_u32 s101, 1
    s_cbranch_scc1 L_go68
    s_waitcnt vmcnt(4)
L_go68:
    buffer_load_dwordx4 v[176:179], v2, s[32:35], s66 offen offset:128 nt
    v_dot2_f32_bf16 v6, v144, v32, 0
    v_dot2_f32_bf16 v6, v145, v33, v6
    v_dot2_f32_bf16 v6, v146, v34, v6
    v_dot2_f32_bf16 v6, v147, v35, v6
    v_add_f32 v81, v4, v5
    s_nop 1
    v_add_f32 v81, v81, v6
    s_nop 1
    v_add_f32_dpp v81, v81, v81 quad_perm:[1,0,3,2] row_mask:0xf bank_mask:0xf
    s_nop 1
    v_add_f32_dpp v81, v81, v81 quad_perm:[2,3,0,1] row_mask:0xf bank_mask:0xf
    s_nop 1
    v_add_f32_dpp v81, v81, v81 row_half_mirror row_mask:0xf bank_mask:0xf
    v_cvt_pk_bf16_f32 v81, v81, v81
    v_lshlrev_b32 v81, 16, v81
    v_mul_f32 v81, 0x3d93cd3a, v81
    v_cvt_pk_bf16_f32 v81, v81, v81
    v_lshlrev_b32 v81, 16, v81
    v_max_f32 v22, v22, v81
    s_waitcnt vmcnt(7)
    s_cmp_ge_u32 s101, 3
    s_cbranch_scc1 L_go69
    s_waitcnt vmcnt(6)
    s_cmp_ge_u32 s101, 2
    s_cbranch_scc1 L_go69
    s_waitcnt vmcnt(5)
    s_cmp_ge_u32 s101, 1
    s_cbranch_scc1 L_go69
    s_waitcnt vmcnt(4)
L_go69:
    buffer_load_dwordx4 v[180:183], v2, s[32:35], s66 offen offset:256 nt
    v_dot2_f32_bf16 v4, v148, v24, 0
    v_dot2_f32_bf16 v4, v149, v25, v4
    v_dot2_f32_bf16 v4, v150, v26, v4
    v_dot2_f32_bf16 v4, v151, v27, v4
    s_waitcnt vmcnt(7)
    s_cmp_ge_u32 s101, 3
    s_cbranch_scc1 L_go70
    s_waitcnt vmcnt(6)
    s_cmp_ge_u32 s101, 2
    s_cbranch_scc1 L_go70
    s_waitcnt vmcnt(5)
    s_cmp_ge_u32 s101, 1
    s_cbranch_scc1 L_go70
    s_waitcnt vmcnt(4)
L_go70:
    s_add_u32 s66, s79, 25
    s_and_b32 s66, s66, 31
    s_mul_i32 s66, s66, 98304
    s_add_u32 s66, s66, s65
    buffer_load_dwordx4 v[184:187], v2, s[32:35], s66 offen offset:0 nt
    v_dot2_f32_bf16 v5, v152, v28, 0
    v_dot2_f32_bf16 v5, v153, v29, v5
    v_dot2_f32_bf16 v5, v154, v30, v5
    v_dot2_f32_bf16 v5, v155, v31, v5
    s_waitcnt vmcnt(7)
    s_cmp_ge_u32 s101, 3
    s_cbranch_scc1 L_go71
    s_waitcnt vmcnt(6)
    s_cmp_ge_u32 s101, 2
    s_cbranch_scc1 L_go71
    s_waitcnt vmcnt(5)
    s_cmp_ge_u32 s101, 1
    s_cbranch_scc1 L_go71
    s_waitcnt vmcnt(4)
L_go71:
    buffer_load_dwordx4 v[188:191], v2, s[32:35], s66 offen offset:128 nt
    v_dot2_f32_bf16 v6, v156, v32, 0
    v_dot2_f32_bf16 v6, v157, v33, v6
    v_dot2_f32_bf16 v6, v158, v34, v6
    v_dot2_f32_bf16 v6, v159, v35, v6
    v_add_f32 v82, v4, v5
    s_nop 1
    v_add_f32 v82, v82, v6
    s_nop 1
    v_add_f32_dpp v82, v82, v82 quad_perm:[1,0,3,2] row_mask:0xf bank_mask:0xf
    s_nop 1
    v_add_f32_dpp v82, v82, v82 quad_perm:[2,3,0,1] row_mask:0xf bank_mask:0xf
    s_nop 1
    v_add_f32_dpp v82, v82, v82 row_half_mirror row_mask:0xf bank_mask:0xf
    v_cvt_pk_bf16_f32 v82, v82, v82
    v_lshlrev_b32 v82, 16, v82
    v_mul_f32 v82, 0x3d93cd3a, v82
    v_cvt_pk_bf16_f32 v82, v82, v82
    v_lshlrev_b32 v82, 16, v82
    v_max_f32 v22, v22, v82
    s_waitcnt vmcnt(7)
    s_cmp_ge_u32 s101, 3
    s_cbranch_scc1 L_go72
    s_waitcnt vmcnt(6)
    s_cmp_ge_u32 s101, 2
    s_cbranch_scc1 L_go72
    s_waitcnt vmcnt(5)
    s_cmp_ge_u32 s101, 1
    s_cbranch_scc1 L_go72
    s_waitcnt vmcnt(4)
L_go72:
    buffer_load_dwordx4 v[192:195], v2, s[32:35], s66 offen offset:256 nt
    v_dot2_f32_bf16 v4, v160, v24, 0
    v_dot2_f32_bf16 v4, v161, v25, v4
    v_dot2_f32_bf16 v4, v162, v26, v4
    v_dot2_f32_bf16 v4, v163, v27, v4
    s_waitcnt vmcnt(7)
    s_cmp_ge_u32 s101, 3
    s_cbranch_scc1 L_go73
    s_waitcnt vmcnt(6)
    s_cmp_ge_u32 s101, 2
    s_cbranch_scc1 L_go73
    s_waitcnt vmcnt(5)
    s_cmp_ge_u32 s101, 1
    s_cbranch_scc1 L_go73
    s_waitcnt vmcnt(4)
L_go73:
    s_add_u32 s66, s79, 26
    s_and_b32 s66, s66, 31
    s_mul_i32 s66, s66, 98304
    s_add_u32 s66, s66, s65
    buffer_load_dwordx4 v[196:199], v2, s[32:35], s66 offen offset:0 nt
    v_dot2_f32_bf16 v5, v164, v28, 0
    v_dot2_f32_bf16 v5, v165, v29, v5
    v_dot2_f32_bf16 v5, v166, v30, v5
    v_dot2_f32_bf16 v5, v167, v31, v5
    s_waitcnt vmcnt(7)
    s_cmp_ge_u32 s101, 3
    s_cbranch_scc1 L_go74
    s_waitcnt vmcnt(6)
    s_cmp_ge_u32 s101, 2
    s_cbranch_scc1 L_go74
    s_waitcnt vmcnt(5)
    s_cmp_ge_u32 s101, 1
    s_cbranch_scc1 L_go74
    s_waitcnt vmcnt(4)
L_go74:
    buffer_load_dwordx4 v[200:203], v2, s[32:35], s66 offen offset:128 nt
    v_dot2_f32_bf16 v6, v168, v32, 0
    v_dot2_f32_bf16 v6, v169, v33, v6
    v_dot2_f32_bf16 v6, v170, v34, v6
    v_dot2_f32_bf16 v6, v171, v35, v6
    v_add_f32 v83, v4, v5
    s_nop 1
    v_add_f32 v83, v83, v6
    s_nop 1
    v_add_f32_dpp v83, v83, v83 quad_perm:[1,0,3,2] row_mask:0xf bank_mask:0xf
    s_nop 1
    v_add_f32_dpp v83, v83, v83 quad_perm:[2,3,0,1] row_mask:0xf bank_mask:0xf
    s_nop 1
    v_add_f32_dpp v83, v83, v83 row_half_mirror row_mask:0xf bank_mask:0xf
    v_cvt_pk_bf16_f32 v83, v83, v83
    v_lshlrev_b32 v83, 16, v83
    v_mul_f32 v83, 0x3d93cd3a, v83
    v_cvt_pk_bf16_f32 v83, v83, v83
    v_lshlrev_b32 v83, 16, v83
    v_max_f32 v22, v22, v83
    s_waitcnt vmcnt(7)
    s_cmp_ge_u32 s101, 3
    s_cbranch_scc1 L_go75
    s_waitcnt vmcnt(6)
    s_cmp_ge_u32 s101, 2
    s_cbranch_scc1 L_go75
    s_waitcnt vmcnt(5)
    s_cmp_ge_u32 s101, 1
    s_cbranch_scc1 L_go75
    s_waitcnt vmcnt(4)
L_go75:
    buffer_load_dwordx4 v[204:207], v2, s[32:35], s66 offen offset:256 nt
    v_dot2_f32_bf16 v4, v172, v24, 0
    v_dot2_f32_bf16 v4, v173, v25, v4
    v_dot2_f32_bf16 v4, v174, v26, v4
    v_dot2_f32_bf16 v4, v175, v27, v4
    s_waitcnt vmcnt(7)
    s_cmp_ge_u32 s101, 3
    s_cbranch_scc1 L_go76
    s_waitcnt vmcnt(6)
    s_cmp_ge_u32 s101, 2
    s_cbranch_scc1 L_go76
    s_waitcnt vmcnt(5)
    s_cmp_ge_u32 s101, 1
    s_cbranch_scc1 L_go76
    s_waitcnt vmcnt(4)
L_go76:
    s_add_u32 s66, s79, 27
    s_and_b32 s66, s66, 31
    s_mul_i32 s66, s66, 98304
    s_add_u32 s66, s66, s65
    buffer_load_dwordx4 v[208:211], v2, s[32:35], s66 offen offset:0 nt
    v_dot2_f32_bf16 v5, v176, v28, 0
    v_dot2_f32_bf16 v5, v177, v29, v5
    v_dot2_f32_bf16 v5, v178, v30, v5
    v_dot2_f32_bf16 v5, v179, v31, v5
    s_waitcnt vmcnt(7)
    s_cmp_ge_u32 s101, 3
    s_cbranch_scc1 L_go77
    s_waitcnt vmcnt(6)
    s_cmp_ge_u32 s101, 2
    s_cbranch_scc1 L_go77
    s_waitcnt vmcnt(5)
    s_cmp_ge_u32 s101, 1
    s_cbranch_scc1 L_go77
    s_waitcnt vmcnt(4)
L_go77:
    buffer_load_dwordx4 v[212:215], v2, s[32:35], s66 offen offset:128 nt
    v_dot2_f32_bf16 v6, v180, v32, 0
    v_dot2_f32_bf16 v6, v181, v33, v6
    v_dot2_f32_bf16 v6, v182, v34, v6
    v_dot2_f32_bf16 v6, v183, v35, v6
    v_add_f32 v84, v4, v5
    s_nop 1
    v_add_f32 v84, v84, v6
    s_nop 1
    v_add_f32_dpp v84, v84, v84 quad_perm:[1,0,3,2] row_mask:0xf bank_mask:0xf
    s_nop 1
    v_add_f32_dpp v84, v84, v84 quad_perm:[2,3,0,1] row_mask:0xf bank_mask:0xf
    s_nop 1
    v_add_f32_dpp v84, v84, v84 row_half_mirror row_mask:0xf bank_mask:0xf
    v_cvt_pk_bf16_f32 v84, v84, v84
    v_lshlrev_b32 v84, 16, v84
    v_mul_f32 v84, 0x3d93cd3a, v84
    v_cvt_pk_bf16_f32 v84, v84, v84
    v_lshlrev_b32 v84, 16, v84
    v_max_f32 v22, v22, v84
    s_waitcnt vmcnt(7)
    s_cmp_ge_u32 s101, 3
    s_cbranch_scc1 L_go78
    s_waitcnt vmcnt(6)
    s_cmp_ge_u32 s101, 2
    s_cbranch_scc1 L_go78
    s_waitcnt vmcnt(5)
    s_cmp_ge_u32 s101, 1
    s_cbranch_scc1 L_go78
    s_waitcnt vmcnt(4)
L_go78:
    buffer_load_dwordx4 v[216:219], v2, s[32:35], s66 offen offset:256 nt
    v_dot2_f32_bf16 v4, v184, v24, 0
    v_dot2_f32_bf16 v4, v185, v25, v4
    v_dot2_f32_bf16 v4, v186, v26, v4
    v_dot2_f32_bf16 v4, v187, v27, v4
    s_waitcnt vmcnt(7)
    s_cmp_ge_u32 s101, 3
    s_cbranch_scc1 L_go79
    s_waitcnt vmcnt(6)
    s_cmp_ge_u32 s101, 2
    s_cbranch_scc1 L_go79
    s_waitcnt vmcnt(5)
    s_cmp_ge_u32 s101, 1
    s_cbranch_scc1 L_go79
    s_waitcnt vmcnt(4)
L_go79:
    s_add_u32 s66, s79, 28
    s_and_b32 s66, s66, 31
    s_mul_i32 s66, s66, 98304
    s_add_u32 s66, s66, s65
    buffer_load_dwordx4 v[220:223], v2, s[32:35], s66 offen offset:0 nt
    v_dot2_f32_bf16 v5, v188, v28, 0
    v_dot2_f32_bf16 v5, v189, v29, v5
    v_dot2_f32_bf16 v5, v190, v30, v5
    v_dot2_f32_bf16 v5, v191, v31, v5
    s_waitcnt vmcnt(7)
    s_cmp_ge_u32 s101, 3
    s_cbranch_scc1 L_go80
    s_waitcnt vmcnt(6)
    s_cmp_ge_u32 s101, 2
    s_cbranch_scc1 L_go80
    s_waitcnt vmcnt(5)
    s_cmp_ge_u32 s101, 1
    s_cbranch_scc1 L_go80
    s_waitcnt vmcnt(4)
L_go80:
    buffer_load_dwordx4 v[224:227], v2, s[32:35], s66 offen offset:128 nt
    v_dot2_f32_bf16 v6, v192, v32, 0
    v_dot2_f32_bf16 v6, v193, v33, v6
    v_dot2_f32_bf16 v6, v194, v34, v6
    v_dot2_f32_bf16 v6, v195, v35, v6
    v_add_f32 v85, v4, v5
    s_nop 1
    v_add_f32 v85, v85, v6
    s_nop 1
    v_add_f32_dpp v85, v85, v85 quad_perm:[1,0,3,2] row_mask:0xf bank_mask:0xf
    s_nop 1
    v_add_f32_dpp v85, v85, v85 quad_perm:[2,3,0,1] row_mask:0xf bank_mask:0xf
    s_nop 1
    v_add_f32_dpp v85, v85, v85 row_half_mirror row_mask:0xf bank_mask:0xf
    v_cvt_pk_bf16_f32 v85, v85, v85
    v_lshlrev_b32 v85, 16, v85
    v_mul_f32 v85, 0x3d93cd3a, v85
    v_cvt_pk_bf16_f32 v85, v85, v85
    v_lshlrev_b32 v85, 16, v85
    v_max_f32 v22, v22, v85
    s_waitcnt vmcnt(7)
    s_cmp_ge_u32 s101, 3
    s_cbranch_scc1 L_go81
    s_waitcnt vmcnt(6)
    s_cmp_ge_u32 s101, 2
    s_cbranch_scc1 L_go81
    s_waitcnt vmcnt(5)
    s_cmp_ge_u32 s101, 1
    s_cbranch_scc1 L_go81
    s_waitcnt vmcnt(4)
L_go81:
    buffer_load_dwordx4 v[228:231], v2, s[32:35], s66 offen offset:256 nt
    v_dot2_f32_bf16 v4, v196, v24, 0
    v_dot2_f32_bf16 v4, v197, v25, v4
    v_dot2_f32_bf16 v4, v198, v26, v4
    v_dot2_f32_bf16 v4, v199, v27, v4
    s_waitcnt vmcnt(7)
    s_cmp_ge_u32 s101, 3
    s_cbranch_scc1 L_go82
    s_waitcnt vmcnt(6)
    s_cmp_ge_u32 s101, 2
    s_cbranch_scc1 L_go82
    s_waitcnt vmcnt(5)
    s_cmp_ge_u32 s101, 1
    s_cbranch_scc1 L_go82
    s_waitcnt vmcnt(4)
L_go82:
    s_add_u32 s66, s79, 29
    s_and_b32 s66, s66, 31
    s_mul_i32 s66, s66, 98304
    s_add_u32 s66, s66, s65
    buffer_load_dwordx4 v[232:235], v2, s[32:35], s66 offen offset:0 nt
    v_dot2_f32_bf16 v5, v200, v28, 0
    v_dot2_f32_bf16 v5, v201, v29, v5
    v_dot2_f32_bf16 v5, v202, v30, v5
    v_dot2_f32_bf16 v5, v203, v31, v5
    s_waitcnt vmcnt(7)
    s_cmp_ge_u32 s101, 3
    s_cbranch_scc1 L_go83
    s_waitcnt vmcnt(6)
    s_cmp_ge_u32 s101, 2
    s_cbranch_scc1 L_go83
    s_waitcnt vmcnt(5)
    s_cmp_ge_u32 s101, 1
    s_cbranch_scc1 L_go83
    s_waitcnt vmcnt(4)
L_go83:
    buffer_load_dwordx4 v[236:239], v2, s[32:35], s66 offen offset:128 nt
    v_dot2_f32_bf16 v6, v204, v32, 0
    v_dot2_f32_bf16 v6, v205, v33, v6
    v_dot2_f32_bf16 v6, v206, v34, v6
    v_dot2_f32_bf16 v6, v207, v35, v6
    v_add_f32 v86, v4, v5
    s_nop 1
    v_add_f32 v86, v86, v6
    s_nop 1
    v_add_f32_dpp v86, v86, v86 quad_perm:[1,0,3,2] row_mask:0xf bank_mask:0xf
    s_nop 1
    v_add_f32_dpp v86, v86, v86 quad_perm:[2,3,0,1] row_mask:0xf bank_mask:0xf
    s_nop 1
    v_add_f32_dpp v86, v86, v86 row_half_mirror row_mask:0xf bank_mask:0xf
    v_cvt_pk_bf16_f32 v86, v86, v86
    v_lshlrev_b32 v86, 16, v86
    v_mul_f32 v86, 0x3d93cd3a, v86
    v_cvt_pk_bf16_f32 v86, v86, v86
    v_lshlrev_b32 v86, 16, v86
    v_max_f32 v22, v22, v86
    s_waitcnt vmcnt(7)
    s_cmp_ge_u32 s101, 3
    s_cbranch_scc1 L_go84
    s_waitcnt vmcnt(6)
    s_cmp_ge_u32 s101, 2
    s_cbranch_scc1 L_go84
    s_waitcnt vmcnt(5)
    s_cmp_ge_u32 s101, 1
    s_cbranch_scc1 L_go84
    s_waitcnt vmcnt(4)
L_go84:
    buffer_load_dwordx4 v[240:243], v2, s[32:35], s66 offen offset:256 nt
    v_dot2_f32_bf16 v4, v208, v24, 0
    v_dot2_f32_bf16 v4, v209, v25, v4
    v_dot2_f32_bf16 v4, v210, v26, v4
    v_dot2_f32_bf16 v4, v211, v27, v4
    s_waitcnt vmcnt(7)
    s_cmp_ge_u32 s101, 3
    s_cbranch_scc1 L_go85
    s_waitcnt vmcnt(6)
    s_cmp_ge_u32 s101, 2
    s_cbranch_scc1 L_go85
    s_waitcnt vmcnt(5)
    s_cmp_ge_u32 s101, 1
    s_cbranch_scc1 L_go85
    s_waitcnt vmcnt(4)
L_go85:
    s_add_u32 s66, s79, 30
    s_and_b32 s66, s66, 31
    s_mul_i32 s66, s66, 98304
    s_add_u32 s66, s66, s65
    buffer_load_dwordx4 v[244:247], v2, s[32:35], s66 offen offset:0 nt
    v_dot2_f32_bf16 v5, v212, v28, 0
    v_dot2_f32_bf16 v5, v213, v29, v5
    v_dot2_f32_bf16 v5, v214, v30, v5
    v_dot2_f32_bf16 v5, v215, v31, v5
    s_waitcnt vmcnt(7)
    s_cmp_ge_u32 s101, 3
    s_cbranch_scc1 L_go86
    s_waitcnt vmcnt(6)
    s_cmp_ge_u32 s101, 2
    s_cbranch_scc1 L_go86
    s_waitcnt vmcnt(5)
    s_cmp_ge_u32 s101, 1
    s_cbranch_scc1 L_go86
    s_waitcnt vmcnt(4)
L_go86:
    buffer_load_dwordx4 v[248:251], v2, s[32:35], s66 offen offset:128 nt
    v_dot2_f32_bf16 v6, v216, v32, 0
    v_dot2_f32_bf16 v6, v217, v33, v6
    v_dot2_f32_bf16 v6, v218, v34, v6
    v_dot2_f32_bf16 v6, v219, v35, v6
    v_add_f32 v87, v4, v5
    s_nop 1
    v_add_f32 v87, v87, v6
    s_nop 1
    v_add_f32_dpp v87, v87, v87 quad_perm:[1,0,3,2] row_mask:0xf bank_mask:0xf
    s_nop 1
    v_add_f32_dpp v87, v87, v87 quad_perm:[2,3,0,1] row_mask:0xf bank_mask:0xf
    s_nop 1
    v_add_f32_dpp v87, v87, v87 row_half_mirror row_mask:0xf bank_mask:0xf
    v_cvt_pk_bf16_f32 v87, v87, v87
    v_lshlrev_b32 v87, 16, v87
    v_mul_f32 v87, 0x3d93cd3a, v87
    v_cvt_pk_bf16_f32 v87, v87, v87
    v_lshlrev_b32 v87, 16, v87
    v_max_f32 v22, v22, v87
    s_waitcnt vmcnt(7)
    s_cmp_ge_u32 s101, 3
    s_cbranch_scc1 L_go87
    s_waitcnt vmcnt(6)
    s_cmp_ge_u32 s101, 2
    s_cbranch_scc1 L_go87
    s_waitcnt vmcnt(5)
    s_cmp_ge_u32 s101, 1
    s_cbranch_scc1 L_go87
    s_waitcnt vmcnt(4)
L_go87:
    buffer_load_dwordx4 v[92:95], v2, s[32:35], s66 offen offset:256 nt
    v_dot2_f32_bf16 v4, v220, v24, 0
    v_dot2_f32_bf16 v4, v221, v25, v4
    v_dot2_f32_bf16 v4, v222, v26, v4
    v_dot2_f32_bf16 v4, v223, v27, v4
    s_waitcnt vmcnt(7)
    s_cmp_ge_u32 s101, 3
    s_cbranch_scc1 L_go88
    s_waitcnt vmcnt(6)
    s_cmp_ge_u32 s101, 2
    s_cbranch_scc1 L_go88
    s_waitcnt vmcnt(5)
    s_cmp_ge_u32 s101, 1
    s_cbranch_scc1 L_go88
    s_waitcnt vmcnt(4)
L_go88:
    s_add_u32 s66, s79, 31
    s_and_b32 s66, s66, 31
    s_mul_i32 s66, s66, 98304
    s_add_u32 s66, s66, s65
    buffer_load_dwordx4 v[96:99], v2, s[32:35], s66 offen offset:0 nt
    v_dot2_f32_bf16 v5, v224, v28, 0
    v_dot2_f32_bf16 v5, v225, v29, v5
    v_dot2_f32_bf16 v5, v226, v30, v5
    v_dot2_f32_bf16 v5, v227, v31, v5
    s_waitcnt vmcnt(7)
    s_cmp_ge_u32 s101, 3
    s_cbranch_scc1 L_go89
    s_waitcnt vmcnt(6)
    s_cmp_ge_u32 s101, 2
    s_cbranch_scc1 L_go89
    s_waitcnt vmcnt(5)
    s_cmp_ge_u32 s101, 1
    s_cbranch_scc1 L_go89
    s_waitcnt vmcnt(4)
L_go89:
    buffer_load_dwordx4 v[100:103], v2, s[32:35], s66 offen offset:128 nt
    v_dot2_f32_bf16 v6, v228, v32, 0
    v_dot2_f32_bf16 v6, v229, v33, v6
    v_dot2_f32_bf16 v6, v230, v34, v6
    v_dot2_f32_bf16 v6, v231, v35, v6
    v_add_f32 v88, v4, v5
    s_nop 1
    v_add_f32 v88, v88, v6
    s_nop 1
    v_add_f32_dpp v88, v88, v88 quad_perm:[1,0,3,2] row_mask:0xf bank_mask:0xf
    s_nop 1
    v_add_f32_dpp v88, v88, v88 quad_perm:[2,3,0,1] row_mask:0xf bank_mask:0xf
    s_nop 1
    v_add_f32_dpp v88, v88, v88 row_half_mirror row_mask:0xf bank_mask:0xf
    v_cvt_pk_bf16_f32 v88, v88, v88
    v_lshlrev_b32 v88, 16, v88
    v_mul_f32 v88, 0x3d93cd3a, v88
    v_cvt_pk_bf16_f32 v88, v88, v88
    v_lshlrev_b32 v88, 16, v88
    v_max_f32 v22, v22, v88
    s_waitcnt vmcnt(7)
    s_cmp_ge_u32 s101, 3
    s_cbranch_scc1 L_go90
    s_waitcnt vmcnt(6)
    s_cmp_ge_u32 s101, 2
    s_cbranch_scc1 L_go90
    s_waitcnt vmcnt(5)
    s_cmp_ge_u32 s101, 1
    s_cbranch_scc1 L_go90
    s_waitcnt vmcnt(4)
L_go90:
    buffer_load_dwordx4 v[104:107], v2, s[32:35], s66 offen offset:256 nt
    v_dot2_f32_bf16 v4, v232, v24, 0
    v_dot2_f32_bf16 v4, v233, v25, v4
    v_dot2_f32_bf16 v4, v234, v26, v4
    v_dot2_f32_bf16 v4, v235, v27, v4
    s_waitcnt vmcnt(7)
    s_cmp_ge_u32 s101, 3
    s_cbranch_scc1 L_go91
    s_waitcnt vmcnt(6)
    s_cmp_ge_u32 s101, 2
    s_cbranch_scc1 L_go91
    s_waitcnt vmcnt(5)
    s_cmp_ge_u32 s101, 1
    s_cbranch_scc1 L_go91
    s_waitcnt vmcnt(4)
L_go91:
    s_add_u32 s66, s79, 0
    s_and_b32 s66, s66, 31
    s_mul_i32 s66, s66, 98304
    s_add_u32 s66, s66, s65
    buffer_load_dwordx4 v[108:111], v2, s[36:39], s66 offen offset:0 nt
    v_dot2_f32_bf16 v5, v236, v28, 0
    v_dot2_f32_bf16 v5, v237, v29, v5
    v_dot2_f32_bf16 v5, v238, v30, v5
    v_dot2_f32_bf16 v5, v239, v31, v5
    s_mov_b32 s22, s20
    s_memrealtime s[20:21]
    s_waitcnt vmcnt(7)
    s_cmp_ge_u32 s101, 3
    s_cbranch_scc1 L_go92
    s_waitcnt vmcnt(6)
    s_cmp_ge_u32 s101, 2
    s_cbranch_scc1 L_go92
    s_waitcnt vmcnt(5)
    s_cmp_ge_u32 s101, 1
    s_cbranch_scc1 L_go92
    s_waitcnt vmcnt(4)
L_go92:
    buffer_load_dwordx4 v[112:115], v2, s[36:39], s66 offen offset:128 nt
    v_dot2_f32_bf16 v6, v240, v32, 0
    v_dot2_f32_bf16 v6, v241, v33, v6
    v_dot2_f32_bf16 v6, v242, v34, v6
    v_dot2_f32_bf16 v6, v243, v35, v6
    s_waitcnt lgkmcnt(0)
    v_mov_b32 v254, s20
    s_mov_b32 s70, 983168
    buffer_store_dword v254, v253, s[56:59], s70 offen sc1
    ds_read_b32 v255, v3 offset:8
    v_add_f32 v89, v4, v5
    v_add_f32 v89, v89, v6
    s_nop 1
    v_add_f32_dpp v89, v89, v89 quad_perm:[1,0,3,2] row_mask:0xf bank_mask:0xf
    s_nop 1
    v_add_f32_dpp v89, v89, v89 quad_perm:[2,3,0,1] row_mask:0xf bank_mask:0xf
    s_nop 1
    v_add_f32_dpp v89, v89, v89 row_half_mirror row_mask:0xf bank_mask:0xf
    v_cvt_pk_bf16_f32 v89, v89, v89
    v_lshlrev_b32 v89, 16, v89
    v_mul_f32 v89, 0x3d93cd3a, v89
    v_cvt_pk_bf16_f32 v89, v89, v89
    v_lshlrev_b32 v89, 16, v89
    v_max_f32 v22, v22, v89
    s_waitcnt vmcnt(7)
    s_cmp_ge_u32 s101, 3
    s_cbranch_scc1 L_go93
    s_waitcnt vmcnt(6)
    s_cmp_ge_u32 s101, 2
    s_cbranch_scc1 L_go93
    s_waitcnt vmcnt(5)
    s_cmp_ge_u32 s101, 1
    s_cbranch_scc1 L_go93
    s_waitcnt vmcnt(4)
L_go93:
    buffer_load_dwordx4 v[116:119], v2, s[36:39], s66 offen offset:256 nt
    v_dot2_f32_bf16 v4, v244, v24, 0
    v_dot2_f32_bf16 v4, v245, v25, v4
    v_dot2_f32_bf16 v4, v246, v26, v4
    v_dot2_f32_bf16 v4, v247, v27, v4
    s_waitcnt vmcnt(7)
    s_cmp_ge_u32 s101, 3
    s_cbranch_scc1 L_go94
    s_waitcnt vmcnt(6)
    s_cmp_ge_u32 s101, 2
    s_cbranch_scc1 L_go94
    s_waitcnt vmcnt(5)
    s_cmp_ge_u32 s101, 1
    s_cbranch_scc1 L_go94
    s_waitcnt vmcnt(4)
L_go94:
    s_add_u32 s66, s79, 1
    s_and_b32 s66, s66, 31
    s_mul_i32 s66, s66, 98304
    s_add_u32 s66, s66, s65
    buffer_load_dwordx4 v[120:123], v2, s[36:39], s66 offen offset:0 nt
    v_dot2_f32_bf16 v5, v248, v28, 0
    v_dot2_f32_bf16 v5, v249, v29, v5
    v_dot2_f32_bf16 v5, v250, v30, v5
    v_dot2_f32_bf16 v5, v251, v31, v5
    s_waitcnt vmcnt(7)
    s_cmp_ge_u32 s101, 3
    s_cbranch_scc1 L_go95
    s_waitcnt vmcnt(6)
    s_cmp_ge_u32 s101, 2
    s_cbranch_scc1 L_go95
    s_waitcnt vmcnt(5)
    s_cmp_ge_u32 s101, 1
    s_cbranch_scc1 L_go95
    s_waitcnt vmcnt(4)
L_go95:
    buffer_load_dwordx4 v[124:127], v2, s[36:39], s66 offen offset:128 nt
    v_dot2_f32_bf16 v6, v92, v32, 0
    v_dot2_f32_bf16 v6, v93, v33, v6
    v_dot2_f32_bf16 v6, v94, v34, v6
    v_dot2_f32_bf16 v6, v95, v35, v6
    v_add_f32 v90, v4, v5
    s_nop 1
    v_add_f32 v90, v90, v6
    s_nop 1
    v_add_f32_dpp v90, v90, v90 quad_perm:[1,0,3,2] row_mask:0xf bank_mask:0xf
    s_nop 1
    v_add_f32_dpp v90, v90, v90 quad_perm:[2,3,0,1] row_mask:0xf bank_mask:0xf
    s_nop 1
    v_add_f32_dpp v90, v90, v90 row_half_mirror row_mask:0xf bank_mask:0xf
    v_cvt_pk_bf16_f32 v90, v90, v90
    v_lshlrev_b32 v90, 16, v90
    v_mul_f32 v90, 0x3d93cd3a, v90
    v_cvt_pk_bf16_f32 v90, v90, v90
    v_lshlrev_b32 v90, 16, v90
    v_max_f32 v22, v22, v90
    s_waitcnt vmcnt(7)
    s_cmp_ge_u32 s101, 3
    s_cbranch_scc1 L_go96
    s_waitcnt vmcnt(6)
    s_cmp_ge_u32 s101, 2
    s_cbranch_scc1 L_go96
    s_waitcnt vmcnt(5)
    s_cmp_ge_u32 s101, 1
    s_cbranch_scc1 L_go96
    s_waitcnt vmcnt(4)
L_go96:
    buffer_load_dwordx4 v[128:131], v2, s[36:39], s66 offen offset:256 nt
    v_dot2_f32_bf16 v4, v96, v24, 0
    v_dot2_f32_bf16 v4, v97, v25, v4
    v_dot2_f32_bf16 v4, v98, v26, v4
    v_dot2_f32_bf16 v4, v99, v27, v4
    s_waitcnt vmcnt(7)
    s_cmp_ge_u32 s101, 3
    s_cbranch_scc1 L_go97
    s_waitcnt vmcnt(6)
    s_cmp_ge_u32 s101, 2
    s_cbranch_scc1 L_go97
    s_waitcnt vmcnt(5)
    s_cmp_ge_u32 s101, 1
    s_cbranch_scc1 L_go97
    s_waitcnt vmcnt(4)
L_go97:
    s_add_u32 s66, s79, 2
    s_and_b32 s66, s66, 31
    s_mul_i32 s66, s66, 98304
    s_add_u32 s66, s66, s65
    buffer_load_dwordx4 v[132:135], v2, s[36:39], s66 offen offset:0 nt
    v_dot2_f32_bf16 v5, v100, v28, 0
    v_dot2_f32_bf16 v5, v101, v29, v5
    v_dot2_f32_bf16 v5, v102, v30, v5
    v_dot2_f32_bf16 v5, v103, v31, v5
    s_waitcnt vmcnt(7)
    s_cmp_ge_u32 s101, 3
    s_cbranch_scc1 L_go98
    s_waitcnt vmcnt(6)
    s_cmp_ge_u32 s101, 2
    s_cbranch_scc1 L_go98
    s_waitcnt vmcnt(5)
    s_cmp_ge_u32 s101, 1
    s_cbranch_scc1 L_go98
    s_waitcnt vmcnt(4)
L_go98:
    buffer_load_dwordx4 v[136:139], v2, s[36:39], s66 offen offset:128 nt
    v_dot2_f32_bf16 v6, v104, v32, 0
    v_dot2_f32_bf16 v6, v105, v33, v6
    v_dot2_f32_bf16 v6, v106, v34, v6
    v_dot2_f32_bf16 v6, v107, v35, v6
    v_add_f32 v91, v4, v5
    s_nop 1
    v_add_f32 v91, v91, v6
    s_nop 1
    v_add_f32_dpp v91, v91, v91 quad_perm:[1,0,3,2] row_mask:0xf bank_mask:0xf
    s_nop 1
    v_add_f32_dpp v91, v91, v91 quad_perm:[2,3,0,1] row_mask:0xf bank_mask:0xf
    s_nop 1
    v_add_f32_dpp v91, v91, v91 row_half_mirror row_mask:0xf bank_mask:0xf
    v_cvt_pk_bf16_f32 v91, v91, v91
    v_lshlrev_b32 v91, 16, v91
    v_mul_f32 v91, 0x3d93cd3a, v91
    v_cvt_pk_bf16_f32 v91, v91, v91
    v_lshlrev_b32 v91, 16, v91
    v_max_f32 v22, v22, v91
    s_nop 1
    v_max_f32_dpp v22, v22, v22 row_ror:8 row_mask:0xf bank_mask:0xf
    v_mov_b32 v5, v22
    s_nop 1
    v_permlane16_swap_b32 v22, v5
    v_max_f32 v22, v22, v5
    v_mov_b32 v5, v22
    s_nop 1
    v_permlane32_swap_b32 v22, v5
    v_max_f32 v22, v22, v5
    v_sub_f32 v60, v60, v22
    v_mul_f32 v60, 0x3fb8aa3b, v60
    v_exp_f32 v60, v60
    s_nop 0
    v_mov_b32 v23, v60
    v_sub_f32 v61, v61, v22
    v_mul_f32 v61, 0x3fb8aa3b, v61
    v_exp_f32 v61, v61
    s_nop 0
    v_add_f32 v23, v23, v61
    v_sub_f32 v62, v62, v22
    v_mul_f32 v62, 0x3fb8aa3b, v62
    v_exp_f32 v62, v62
    s_nop 0
    v_add_f32 v23, v23, v62
    v_sub_f32 v63, v63, v22
    v_mul_f32 v63, 0x3fb8aa3b, v63
    v_exp_f32 v63, v63
    s_nop 0
    v_add_f32 v23, v23, v63
    s_waitcnt vmcnt(7)
    s_cmp_ge_u32 s101, 3
    s_cbranch_scc1 L_go99
    s_waitcnt vmcnt(6)
    s_cmp_ge_u32 s101, 2
    s_cbranch_scc1 L_go99
    s_waitcnt vmcnt(5)
    s_cmp_ge_u32 s101, 1
    s_cbranch_scc1 L_go99
    s_waitcnt vmcnt(4)
L_go99:
    buffer_load_dwordx4 v[140:143], v2, s[36:39], s66 offen offset:256 nt
    v_lshlrev_b32 v4, 16, v108
    v_and_b32 v5, s67, v108
    v_mul_f32 v36, v60, v4
    v_mul_f32 v37, v60, v5
    v_lshlrev_b32 v6, 16, v109
    v_and_b32 v7, s67, v109
    v_mul_f32 v38, v60, v6
    v_mul_f32 v39, v60, v7
    v_lshlrev_b32 v8, 16, v110
    v_and_b32 v9, s67, v110
    v_mul_f32 v40, v60, v8
    v_mul_f32 v41, v60, v9
    v_lshlrev_b32 v10, 16, v111
    v_and_b32 v11, s67, v111
    v_mul_f32 v42, v60, v10
    v_mul_f32 v43, v60, v11
    s_waitcnt vmcnt(7)
    s_cmp_ge_u32 s101, 3
    s_cbranch_scc1 L_go100
    s_waitcnt vmcnt(6)
    s_cmp_ge_u32 s101, 2
    s_cbranch_scc1 L_go100
    s_waitcnt vmcnt(5)
    s_cmp_ge_u32 s101, 1
    s_cbranch_scc1 L_go100
    s_waitcnt vmcnt(4)
L_go100:
    s_add_u32 s66, s79, 3
    s_and_b32 s66, s66, 31
    s_mul_i32 s66, s66, 98304
    s_add_u32 s66, s66, s65
    buffer_load_dwordx4 v[144:147], v2, s[36:39], s66 offen offset:0 nt
    v_lshlrev_b32 v4, 16, v112
    v_and_b32 v5, s67, v112
    v_mul_f32 v44, v60, v4
    v_mul_f32 v45, v60, v5
    v_lshlrev_b32 v6, 16, v113
    v_and_b32 v7, s67, v113
    v_mul_f32 v46, v60, v6
    v_mul_f32 v47, v60, v7
    v_lshlrev_b32 v8, 16, v114
    v_and_b32 v9, s67, v114
    v_mul_f32 v48, v60, v8
    v_mul_f32 v49, v60, v9
    v_lshlrev_b32 v10, 16, v115
    v_and_b32 v11, s67, v115
    v_mul_f32 v50, v60, v10
    v_mul_f32 v51, v60, v11
    s_waitcnt lgkmcnt(0)
    v_readfirstlane_b32 s76, v255
    s_waitcnt vmcnt(7)
    s_cmp_ge_u32 s101, 3
    s_cbranch_scc1 L_go101
    s_waitcnt vmcnt(6)
    s_cmp_ge_u32 s101, 2
    s_cbranch_scc1 L_go101
    s_waitcnt vmcnt(5)
    s_cmp_ge_u32 s101, 1
    s_cbranch_scc1 L_go101
    s_waitcnt vmcnt(4)
L_go101:
    buffer_load_dwordx4 v[148:151], v2, s[36:39], s66 offen offset:128 nt
    v_lshlrev_b32 v4, 16, v116
    v_and_b32 v5, s67, v116
    v_mul_f32 v52, v60, v4
    v_mul_f32 v53, v60, v5
    v_lshlrev_b32 v6, 16, v117
    v_and_b32 v7, s67, v117
    v_mul_f32 v54, v60, v6
    v_mul_f32 v55, v60, v7
    v_lshlrev_b32 v8, 16, v118
    v_and_b32 v9, s67, v118
    v_mul_f32 v56, v60, v8
    v_mul_f32 v57, v60, v9
    v_lshlrev_b32 v10, 16, v119
    v_and_b32 v11, s67, v119
    v_mul_f32 v58, v60, v10
    v_mul_f32 v59, v60, v11
    v_sub_f32 v64, v64, v22
    v_mul_f32 v64, 0x3fb8aa3b, v64
    v_exp_f32 v64, v64
    s_nop 0
    v_add_f32 v23, v23, v64
    v_sub_f32 v65, v65, v22
    v_mul_f32 v65, 0x3fb8aa3b, v65
    v_exp_f32 v65, v65
    s_nop 0
    v_add_f32 v23, v23, v65
    v_sub_f32 v66, v66, v22
    v_mul_f32 v66, 0x3fb8aa3b, v66
    v_exp_f32 v66, v66
    s_nop 0
    v_add_f32 v23, v23, v66
    v_sub_f32 v67, v67, v22
    v_mul_f32 v67, 0x3fb8aa3b, v67
    v_exp_f32 v67, v67
    s_nop 0
    v_add_f32 v23, v23, v67
    s_waitcnt vmcnt(7)
    s_cmp_ge_u32 s101, 3
    s_cbranch_scc1 L_go102
    s_waitcnt vmcnt(6)
    s_cmp_ge_u32 s101, 2
    s_cbranch_scc1 L_go102
    s_waitcnt vmcnt(5)
    s_cmp_ge_u32 s101, 1
    s_cbranch_scc1 L_go102
    s_waitcnt vmcnt(4)
L_go102:
    buffer_load_dwordx4 v[152:155], v2, s[36:39], s66 offen offset:256 nt
    v_lshlrev_b32 v4, 16, v120
    v_and_b32 v5, s67, v120
    v_fmac_f32 v36, v61, v4
    v_fmac_f32 v37, v61, v5
    v_lshlrev_b32 v6, 16, v121
    v_and_b32 v7, s67, v121
    v_fmac_f32 v38, v61, v6
    v_fmac_f32 v39, v61, v7
    v_lshlrev_b32 v8, 16, v122
    v_and_b32 v9, s67, v122
    v_fmac_f32 v40, v61, v8
    v_fmac_f32 v41, v61, v9
    v_lshlrev_b32 v10, 16, v123
    v_and_b32 v11, s67, v123
    v_fmac_f32 v42, v61, v10
    v_fmac_f32 v43, v61, v11
    s_waitcnt vmcnt(7)
    s_cmp_ge_u32 s101, 3
    s_cbranch_scc1 L_go103
    s_waitcnt vmcnt(6)
    s_cmp_ge_u32 s101, 2
    s_cbranch_scc1 L_go103
    s_waitcnt vmcnt(5)
    s_cmp_ge_u32 s101, 1
    s_cbranch_scc1 L_go103
    s_waitcnt vmcnt(4)
L_go103:
    s_add_u32 s66, s79, 4
    s_and_b32 s66, s66, 31
    s_mul_i32 s66, s66, 98304
    s_add_u32 s66, s66, s65
    buffer_load_dwordx4 v[156:159], v2, s[36:39], s66 offen offset:0 nt
    v_lshlrev_b32 v4, 16, v124
    v_and_b32 v5, s67, v124
    v_fmac_f32 v44, v61, v4
    v_fmac_f32 v45, v61, v5
    v_lshlrev_b32 v6, 16, v125
    v_and_b32 v7, s67, v125
    v_fmac_f32 v46, v61, v6
    v_fmac_f32 v47, v61, v7
    v_lshlrev_b32 v8, 16, v126
    v_and_b32 v9, s67, v126
    v_fmac_f32 v48, v61, v8
    v_fmac_f32 v49, v61, v9
    v_lshlrev_b32 v10, 16, v127
    v_and_b32 v11, s67, v127
    v_fmac_f32 v50, v61, v10
    v_fmac_f32 v51, v61, v11
    s_waitcnt vmcnt(7)
    s_cmp_ge_u32 s101, 3
    s_cbranch_scc1 L_go104
    s_waitcnt vmcnt(6)
    s_cmp_ge_u32 s101, 2
    s_cbranch_scc1 L_go104
    s_waitcnt vmcnt(5)
    s_cmp_ge_u32 s101, 1
    s_cbranch_scc1 L_go104
    s_waitcnt vmcnt(4)
L_go104:
    buffer_load_dwordx4 v[160:163], v2, s[36:39], s66 offen offset:128 nt
    v_lshlrev_b32 v4, 16, v128
    v_and_b32 v5, s67, v128
    v_fmac_f32 v52, v61, v4
    v_fmac_f32 v53, v61, v5
    v_lshlrev_b32 v6, 16, v129
    v_and_b32 v7, s67, v129
    v_fmac_f32 v54, v61, v6
    v_fmac_f32 v55, v61, v7
    v_lshlrev_b32 v8, 16, v130
    v_and_b32 v9, s67, v130
    v_fmac_f32 v56, v61, v8
    v_fmac_f32 v57, v61, v9
    v_lshlrev_b32 v10, 16, v131
    v_and_b32 v11, s67, v131
    v_fmac_f32 v58, v61, v10
    v_fmac_f32 v59, v61, v11
    v_sub_f32 v68, v68, v22
    v_mul_f32 v68, 0x3fb8aa3b, v68
    v_exp_f32 v68, v68
    s_nop 0
    v_add_f32 v23, v23, v68
    v_sub_f32 v69, v69, v22
    v_mul_f32 v69, 0x3fb8aa3b, v69
    v_exp_f32 v69, v69
    s_nop 0
    v_add_f32 v23, v23, v69
    v_sub_f32 v70, v70, v22
    v_mul_f32 v70, 0x3fb8aa3b, v70
    v_exp_f32 v70, v70
    s_nop 0
    v_add_f32 v23, v23, v70
    v_sub_f32 v71, v71, v22
    v_mul_f32 v71, 0x3fb8aa3b, v71
    v_exp_f32 v71, v71
    s_nop 0
    v_add_f32 v23, v23, v71
    s_waitcnt vmcnt(7)
    s_cmp_ge_u32 s101, 3
    s_cbranch_scc1 L_go105
    s_waitcnt vmcnt(6)
    s_cmp_ge_u32 s101, 2
    s_cbranch_scc1 L_go105
    s_waitcnt vmcnt(5)
    s_cmp_ge_u32 s101, 1
    s_cbranch_scc1 L_go105
    s_waitcnt vmcnt(4)
L_go105:
    buffer_load_dwordx4 v[164:167], v2, s[36:39], s66 offen offset:256 nt
    v_lshlrev_b32 v4, 16, v132
    v_and_b32 v5, s67, v132
    v_fmac_f32 v36, v62, v4
    v_fmac_f32 v37, v62, v5
    v_lshlrev_b32 v6, 16, v133
    v_and_b32 v7, s67, v133
    v_fmac_f32 v38, v62, v6
    v_fmac_f32 v39, v62, v7
    v_lshlrev_b32 v8, 16, v134
    v_and_b32 v9, s67, v134
    v_fmac_f32 v40, v62, v8
    v_fmac_f32 v41, v62, v9
    v_lshlrev_b32 v10, 16, v135
    v_and_b32 v11, s67, v135
    v_fmac_f32 v42, v62, v10
    v_fmac_f32 v43, v62, v11
    s_waitcnt vmcnt(7)
    s_cmp_ge_u32 s101, 3
    s_cbranch_scc1 L_go106
    s_waitcnt vmcnt(6)
    s_cmp_ge_u32 s101, 2
    s_cbranch_scc1 L_go106
    s_waitcnt vmcnt(5)
    s_cmp_ge_u32 s101, 1
    s_cbranch_scc1 L_go106
    s_waitcnt vmcnt(4)
L_go106:
    s_add_u32 s66, s79, 5
    s_and_b32 s66, s66, 31
    s_mul_i32 s66, s66, 98304
    s_add_u32 s66, s66, s65
    buffer_load_dwordx4 v[168:171], v2, s[36:39], s66 offen offset:0 nt
    v_lshlrev_b32 v4, 16, v136
    v_and_b32 v5, s67, v136
    v_fmac_f32 v44, v62, v4
    v_fmac_f32 v45, v62, v5
    v_lshlrev_b32 v6, 16, v137
    v_and_b32 v7, s67, v137
    v_fmac_f32 v46, v62, v6
    v_fmac_f32 v47, v62, v7
    v_lshlrev_b32 v8, 16, v138
    v_and_b32 v9, s67, v138
    v_fmac_f32 v48, v62, v8
    v_fmac_f32 v49, v62, v9
    v_lshlrev_b32 v10, 16, v139
    v_and_b32 v11, s67, v139
    v_fmac_f32 v50, v62, v10
    v_fmac_f32 v51, v62, v11
    s_waitcnt vmcnt(7)
    s_cmp_ge_u32 s101, 3
    s_cbranch_scc1 L_go107
    s_waitcnt vmcnt(6)
    s_cmp_ge_u32 s101, 2
    s_cbranch_scc1 L_go107
    s_waitcnt vmcnt(5)
    s_cmp_ge_u32 s101, 1
    s_cbranch_scc1 L_go107
    s_waitcnt vmcnt(4)
L_go107:
    buffer_load_dwordx4 v[172:175], v2, s[36:39], s66 offen offset:128 nt
    v_lshlrev_b32 v4, 16, v140
    v_and_b32 v5, s67, v140
    v_fmac_f32 v52, v62, v4
    v_fmac_f32 v53, v62, v5
    v_lshlrev_b32 v6, 16, v141
    v_and_b32 v7, s67, v141
    v_fmac_f32 v54, v62, v6
    v_fmac_f32 v55, v62, v7
    v_lshlrev_b32 v8, 16, v142
    v_and_b32 v9, s67, v142
    v_fmac_f32 v56, v62, v8
    v_fmac_f32 v57, v62, v9
    v_lshlrev_b32 v10, 16, v143
    v_and_b32 v11, s67, v143
    v_fmac_f32 v58, v62, v10
    v_fmac_f32 v59, v62, v11
    v_sub_f32 v72, v72, v22
    v_mul_f32 v72, 0x3fb8aa3b, v72
    v_exp_f32 v72, v72
    s_nop 0
    v_add_f32 v23, v23, v72
    v_sub_f32 v73, v73, v22
    v_mul_f32 v73, 0x3fb8aa3b, v73
    v_exp_f32 v73, v73
    s_nop 0
    v_add_f32 v23, v23, v73
    v_sub_f32 v74, v74, v22
    v_mul_f32 v74, 0x3fb8aa3b, v74
    v_exp_f32 v74, v74
    s_nop 0
    v_add_f32 v23, v23, v74
    v_sub_f32 v75, v75, v22
    v_mul_f32 v75, 0x3fb8aa3b, v75
    v_exp_f32 v75, v75
    s_nop 0
    v_add_f32 v23, v23, v75
    s_waitcnt vmcnt(7)
    s_cmp_ge_u32 s101, 3
    s_cbranch_scc1 L_go108
    s_waitcnt vmcnt(6)
    s_cmp_ge_u32 s101, 2
    s_cbranch_scc1 L_go108
    s_waitcnt vmcnt(5)
    s_cmp_ge_u32 s101, 1
    s_cbranch_scc1 L_go108
    s_waitcnt vmcnt(4)
L_go108:
    buffer_load_dwordx4 v[176:179], v2, s[36:39], s66 offen offset:256 nt
    v_lshlrev_b32 v4, 16, v144
    v_and_b32 v5, s67, v144
    v_fmac_f32 v36, v63, v4
    v_fmac_f32 v37, v63, v5
    v_lshlrev_b32 v6, 16, v145
    v_and_b32 v7, s67, v145
    v_fmac_f32 v38, v63, v6
    v_fmac_f32 v39, v63, v7
    v_lshlrev_b32 v8, 16, v146
    v_and_b32 v9, s67, v146
    v_fmac_f32 v40, v63, v8
    v_fmac_f32 v41, v63, v9
    v_lshlrev_b32 v10, 16, v147
    v_and_b32 v11, s67, v147
    v_fmac_f32 v42, v63, v10
    v_fmac_f32 v43, v63, v11
    s_waitcnt vmcnt(7)
    s_cmp_ge_u32 s101, 3
    s_cbranch_scc1 L_go109
    s_waitcnt vmcnt(6)
    s_cmp_ge_u32 s101, 2
    s_cbranch_scc1 L_go109
    s_waitcnt vmcnt(5)
    s_cmp_ge_u32 s101, 1
    s_cbranch_scc1 L_go109
    s_waitcnt vmcnt(4)
L_go109:
    s_add_u32 s66, s79, 6
    s_and_b32 s66, s66, 31
    s_mul_i32 s66, s66, 98304
    s_add_u32 s66, s66, s65
    buffer_load_dwordx4 v[180:183], v2, s[36:39], s66 offen offset:0 nt
    v_lshlrev_b32 v4, 16, v148
    v_and_b32 v5, s67, v148
    v_fmac_f32 v44, v63, v4
    v_fmac_f32 v45, v63, v5
    v_lshlrev_b32 v6, 16, v149
    v_and_b32 v7, s67, v149
    v_fmac_f32 v46, v63, v6
    v_fmac_f32 v47, v63, v7
    v_lshlrev_b32 v8, 16, v150
    v_and_b32 v9, s67, v150
    v_fmac_f32 v48, v63, v8
    v_fmac_f32 v49, v63, v9
    v_lshlrev_b32 v10, 16, v151
    v_and_b32 v11, s67, v151
    v_fmac_f32 v50, v63, v10
    v_fmac_f32 v51, v63, v11
    s_mov_b32 s22, s20
    s_memrealtime s[20:21]
    s_waitcnt vmcnt(7)
    s_cmp_ge_u32 s101, 3
    s_cbranch_scc1 L_go110
    s_waitcnt vmcnt(6)
    s_cmp_ge_u32 s101, 2
    s_cbranch_scc1 L_go110
    s_waitcnt vmcnt(5)
    s_cmp_ge_u32 s101, 1
    s_cbranch_scc1 L_go110
    s_waitcnt vmcnt(4)
L_go110:
    buffer_load_dwordx4 v[184:187], v2, s[36:39], s66 offen offset:128 nt
    v_lshlrev_b32 v4, 16, v152
    v_and_b32 v5, s67, v152
    v_fmac_f32 v52, v63, v4
    v_fmac_f32 v53, v63, v5
    v_lshlrev_b32 v6, 16, v153
    v_and_b32 v7, s67, v153
    v_fmac_f32 v54, v63, v6
    v_fmac_f32 v55, v63, v7
    v_lshlrev_b32 v8, 16, v154
    v_and_b32 v9, s67, v154
    v_fmac_f32 v56, v63, v8
    v_fmac_f32 v57, v63, v9
    v_lshlrev_b32 v10, 16, v155
    v_and_b32 v11, s67, v155
    v_fmac_f32 v58, v63, v10
    v_fmac_f32 v59, v63, v11
    s_waitcnt lgkmcnt(0)
    v_mov_b32 v254, s20
    s_mov_b32 s70, 983296
    buffer_store_dword v254, v253, s[56:59], s70 offen sc1
    s_cmp_eq_u32 s76, 0
    s_cbranch_scc1 L_fb2a
    s_load_dwordx16 s[4:19], s[24:25], 983168
L_fb2a:
    ds_read_b32 v255, v3 offset:8
    v_sub_f32 v76, v76, v22
    v_mul_f32 v76, 0x3fb8aa3b, v76
    v_exp_f32 v76, v76
    s_nop 0
    v_add_f32 v23, v23, v76
    v_sub_f32 v77, v77, v22
    v_mul_f32 v77, 0x3fb8aa3b, v77
    v_exp_f32 v77, v77
    s_nop 0
    v_add_f32 v23, v23, v77
    v_sub_f32 v78, v78, v22
    v_mul_f32 v78, 0x3fb8aa3b, v78
    v_exp_f32 v78, v78
    s_nop 0
    v_add_f32 v23, v23, v78
    v_sub_f32 v79, v79, v22
    v_mul_f32 v79, 0x3fb8aa3b, v79
    v_exp_f32 v79, v79
    s_nop 0
    v_add_f32 v23, v23, v79
    s_waitcnt vmcnt(7)
    s_cmp_ge_u32 s101, 3
    s_cbranch_scc1 L_go111
    s_waitcnt vmcnt(6)
    s_cmp_ge_u32 s101, 2
    s_cbranch_scc1 L_go111
    s_waitcnt vmcnt(5)
    s_cmp_ge_u32 s101, 1
    s_cbranch_scc1 L_go111
    s_waitcnt vmcnt(4)
L_go111:
    buffer_load_dwordx4 v[188:191], v2, s[36:39], s66 offen offset:256 nt
    v_lshlrev_b32 v4, 16, v156
    v_and_b32 v5, s67, v156
    v_fmac_f32 v36, v64, v4
    v_fmac_f32 v37, v64, v5
    v_lshlrev_b32 v6, 16, v157
    v_and_b32 v7, s67, v157
    v_fmac_f32 v38, v64, v6
    v_fmac_f32 v39, v64, v7
    v_lshlrev_b32 v8, 16, v158
    v_and_b32 v9, s67, v158
    v_fmac_f32 v40, v64, v8
    v_fmac_f32 v41, v64, v9
    v_lshlrev_b32 v10, 16, v159
    v_and_b32 v11, s67, v159
    v_fmac_f32 v42, v64, v10
    v_fmac_f32 v43, v64, v11
    s_waitcnt vmcnt(7)
    s_cmp_ge_u32 s101, 3
    s_cbranch_scc1 L_go112
    s_waitcnt vmcnt(6)
    s_cmp_ge_u32 s101, 2
    s_cbranch_scc1 L_go112
    s_waitcnt vmcnt(5)
    s_cmp_ge_u32 s101, 1
    s_cbranch_scc1 L_go112
    s_waitcnt vmcnt(4)
L_go112:
    s_add_u32 s66, s79, 7
    s_and_b32 s66, s66, 31
    s_mul_i32 s66, s66, 98304
    s_add_u32 s66, s66, s65
    buffer_load_dwordx4 v[192:195], v2, s[36:39], s66 offen offset:0 nt
    v_lshlrev_b32 v4, 16, v160
    v_and_b32 v5, s67, v160
    v_fmac_f32 v44, v64, v4
    v_fmac_f32 v45, v64, v5
    v_lshlrev_b32 v6, 16, v161
    v_and_b32 v7, s67, v161
    v_fmac_f32 v46, v64, v6
    v_fmac_f32 v47, v64, v7
    v_lshlrev_b32 v8, 16, v162
    v_and_b32 v9, s67, v162
    v_fmac_f32 v48, v64, v8
    v_fmac_f32 v49, v64, v9
    v_lshlrev_b32 v10, 16, v163
    v_and_b32 v11, s67, v163
    v_fmac_f32 v50, v64, v10
    v_fmac_f32 v51, v64, v11
    s_waitcnt vmcnt(7)
    s_cmp_ge_u32 s101, 3
    s_cbranch_scc1 L_go113
    s_waitcnt vmcnt(6)
    s_cmp_ge_u32 s101, 2
    s_cbranch_scc1 L_go113
    s_waitcnt vmcnt(5)
    s_cmp_ge_u32 s101, 1
    s_cbranch_scc1 L_go113
    s_waitcnt vmcnt(4)
L_go113:
    buffer_load_dwordx4 v[196:199], v2, s[36:39], s66 offen offset:128 nt
    v_lshlrev_b32 v4, 16, v164
    v_and_b32 v5, s67, v164
    v_fmac_f32 v52, v64, v4
    v_fmac_f32 v53, v64, v5
    v_lshlrev_b32 v6, 16, v165
    v_and_b32 v7, s67, v165
    v_fmac_f32 v54, v64, v6
    v_fmac_f32 v55, v64, v7
    v_lshlrev_b32 v8, 16, v166
    v_and_b32 v9, s67, v166
    v_fmac_f32 v56, v64, v8
    v_fmac_f32 v57, v64, v9
    v_lshlrev_b32 v10, 16, v167
    v_and_b32 v11, s67, v167
    v_fmac_f32 v58, v64, v10
    v_fmac_f32 v59, v64, v11
    v_sub_f32 v80, v80, v22
    v_mul_f32 v80, 0x3fb8aa3b, v80
    v_exp_f32 v80, v80
    s_nop 0
    v_add_f32 v23, v23, v80
    v_sub_f32 v81, v81, v22
    v_mul_f32 v81, 0x3fb8aa3b, v81
    v_exp_f32 v81, v81
    s_nop 0
    v_add_f32 v23, v23, v81
    v_sub_f32 v82, v82, v22
    v_mul_f32 v82, 0x3fb8aa3b, v82
    v_exp_f32 v82, v82
    s_nop 0
    v_add_f32 v23, v23, v82
    v_sub_f32 v83, v83, v22
    v_mul_f32 v83, 0x3fb8aa3b, v83
    v_exp_f32 v83, v83
    s_nop 0
    v_add_f32 v23, v23, v83
    s_waitcnt vmcnt(7)
    s_cmp_ge_u32 s101, 3
    s_cbranch_scc1 L_go114
    s_waitcnt vmcnt(6)
    s_cmp_ge_u32 s101, 2
    s_cbranch_scc1 L_go114
    s_waitcnt vmcnt(5)
    s_cmp_ge_u32 s101, 1
    s_cbranch_scc1 L_go114
    s_waitcnt vmcnt(4)
L_go114:
    buffer_load_dwordx4 v[200:203], v2, s[36:39], s66 offen offset:256 nt
    v_lshlrev_b32 v4, 16, v168
    v_and_b32 v5, s67, v168
    v_fmac_f32 v36, v65, v4
    v_fmac_f32 v37, v65, v5
    v_lshlrev_b32 v6, 16, v169
    v_and_b32 v7, s67, v169
    v_fmac_f32 v38, v65, v6
    v_fmac_f32 v39, v65, v7
    v_lshlrev_b32 v8, 16, v170
    v_and_b32 v9, s67, v170
    v_fmac_f32 v40, v65, v8
    v_fmac_f32 v41, v65, v9
    v_lshlrev_b32 v10, 16, v171
    v_and_b32 v11, s67, v171
    v_fmac_f32 v42, v65, v10
    v_fmac_f32 v43, v65, v11
    s_waitcnt vmcnt(7)
    s_cmp_ge_u32 s101, 3
    s_cbranch_scc1 L_go115
    s_waitcnt vmcnt(6)
    s_cmp_ge_u32 s101, 2
    s_cbranch_scc1 L_go115
    s_waitcnt vmcnt(5)
    s_cmp_ge_u32 s101, 1
    s_cbranch_scc1 L_go115
    s_waitcnt vmcnt(4)
L_go115:
    s_add_u32 s66, s79, 8
    s_and_b32 s66, s66, 31
    s_mul_i32 s66, s66, 98304
    s_add_u32 s66, s66, s65
    buffer_load_dwordx4 v[204:207], v2, s[36:39], s66 offen offset:0 nt
    v_lshlrev_b32 v4, 16, v172
    v_and_b32 v5, s67, v172
    v_fmac_f32 v44, v65, v4
    v_fmac_f32 v45, v65, v5
    v_lshlrev_b32 v6, 16, v173
    v_and_b32 v7, s67, v173
    v_fmac_f32 v46, v65, v6
    v_fmac_f32 v47, v65, v7
    v_lshlrev_b32 v8, 16, v174
    v_and_b32 v9, s67, v174
    v_fmac_f32 v48, v65, v8
    v_fmac_f32 v49, v65, v9
    v_lshlrev_b32 v10, 16, v175
    v_and_b32 v11, s67, v175
    v_fmac_f32 v50, v65, v10
    v_fmac_f32 v51, v65, v11
    s_waitcnt vmcnt(7)
    s_cmp_ge_u32 s101, 3
    s_cbranch_scc1 L_go116
    s_waitcnt vmcnt(6)
    s_cmp_ge_u32 s101, 2
    s_cbranch_scc1 L_go116
    s_waitcnt vmcnt(5)
    s_cmp_ge_u32 s101, 1
    s_cbranch_scc1 L_go116
    s_waitcnt vmcnt(4)
L_go116:
    buffer_load_dwordx4 v[208:211], v2, s[36:39], s66 offen offset:128 nt
    v_lshlrev_b32 v4, 16, v176
    v_and_b32 v5, s67, v176
    v_fmac_f32 v52, v65, v4
    v_fmac_f32 v53, v65, v5
    v_lshlrev_b32 v6, 16, v177
    v_and_b32 v7, s67, v177
    v_fmac_f32 v54, v65, v6
    v_fmac_f32 v55, v65, v7
    v_lshlrev_b32 v8, 16, v178
    v_and_b32 v9, s67, v178
    v_fmac_f32 v56, v65, v8
    v_fmac_f32 v57, v65, v9
    v_lshlrev_b32 v10, 16, v179
    v_and_b32 v11, s67, v179
    v_fmac_f32 v58, v65, v10
    v_fmac_f32 v59, v65, v11
    v_sub_f32 v84, v84, v22
    v_mul_f32 v84, 0x3fb8aa3b, v84
    v_exp_f32 v84, v84
    s_nop 0
    v_add_f32 v23, v23, v84
    v_sub_f32 v85, v85, v22
    v_mul_f32 v85, 0x3fb8aa3b, v85
    v_exp_f32 v85, v85
    s_nop 0
    v_add_f32 v23, v23, v85
    v_sub_f32 v86, v86, v22
    v_mul_f32 v86, 0x3fb8aa3b, v86
    v_exp_f32 v86, v86
    s_nop 0
    v_add_f32 v23, v23, v86
    v_sub_f32 v87, v87, v22
    v_mul_f32 v87, 0x3fb8aa3b, v87
    v_exp_f32 v87, v87
    s_nop 0
    v_add_f32 v23, v23, v87
    s_waitcnt vmcnt(7)
    s_cmp_ge_u32 s101, 3
    s_cbranch_scc1 L_go117
    s_waitcnt vmcnt(6)
    s_cmp_ge_u32 s101, 2
    s_cbranch_scc1 L_go117
    s_waitcnt vmcnt(5)
    s_cmp_ge_u32 s101, 1
    s_cbranch_scc1 L_go117
    s_waitcnt vmcnt(4)
L_go117:
    buffer_load_dwordx4 v[212:215], v2, s[36:39], s66 offen offset:256 nt
    v_lshlrev_b32 v4, 16, v180
    v_and_b32 v5, s67, v180
    v_fmac_f32 v36, v66, v4
    v_fmac_f32 v37, v66, v5
    v_lshlrev_b32 v6, 16, v181
    v_and_b32 v7, s67, v181
    v_fmac_f32 v38, v66, v6
    v_fmac_f32 v39, v66, v7
    v_lshlrev_b32 v8, 16, v182
    v_and_b32 v9, s67, v182
    v_fmac_f32 v40, v66, v8
    v_fmac_f32 v41, v66, v9
    v_lshlrev_b32 v10, 16, v183
    v_and_b32 v11, s67, v183
    v_fmac_f32 v42, v66, v10
    v_fmac_f32 v43, v66, v11
    s_waitcnt vmcnt(7)
    s_cmp_ge_u32 s101, 3
    s_cbranch_scc1 L_go118
    s_waitcnt vmcnt(6)
    s_cmp_ge_u32 s101, 2
    s_cbranch_scc1 L_go118
    s_waitcnt vmcnt(5)
    s_cmp_ge_u32 s101, 1
    s_cbranch_scc1 L_go118
    s_waitcnt vmcnt(4)
L_go118:
    s_add_u32 s66, s79, 9
    s_and_b32 s66, s66, 31
    s_mul_i32 s66, s66, 98304
    s_add_u32 s66, s66, s65
    buffer_load_dwordx4 v[216:219], v2, s[36:39], s66 offen offset:0 nt
    v_lshlrev_b32 v4, 16, v184
    v_and_b32 v5, s67, v184
    v_fmac_f32 v44, v66, v4
    v_fmac_f32 v45, v66, v5
    v_lshlrev_b32 v6, 16, v185
    v_and_b32 v7, s67, v185
    v_fmac_f32 v46, v66, v6
    v_fmac_f32 v47, v66, v7
    v_lshlrev_b32 v8, 16, v186
    v_and_b32 v9, s67, v186
    v_fmac_f32 v48, v66, v8
    v_fmac_f32 v49, v66, v9
    v_lshlrev_b32 v10, 16, v187
    v_and_b32 v11, s67, v187
    v_fmac_f32 v50, v66, v10
    v_fmac_f32 v51, v66, v11
    s_waitcnt lgkmcnt(0)
    s_cmp_eq_u32 s76, 0
    s_cbranch_scc1 L_fb2b
    s_mov_b32 s23, 0
    s_min_u32 s4, s4, s20
    s_sub_u32 s4, s22, s4
    s_add_u32 s23, s23, s4
    s_min_u32 s5, s5, s20
    s_sub_u32 s5, s22, s5
    s_add_u32 s23, s23, s5
    s_min_u32 s6, s6, s20
    s_sub_u32 s6, s22, s6
    s_add_u32 s23, s23, s6
    s_min_u32 s7, s7, s20
    s_sub_u32 s7, s22, s7
    s_add_u32 s23, s23, s7
    s_min_u32 s8, s8, s20
    s_sub_u32 s8, s22, s8
    s_add_u32 s23, s23, s8
    s_min_u32 s9, s9, s20
    s_sub_u32 s9, s22, s9
    s_add_u32 s23, s23, s9
    s_min_u32 s10, s10, s20
    s_sub_u32 s10, s22, s10
    s_add_u32 s23, s23, s10
    s_min_u32 s11, s11, s20
    s_sub_u32 s11, s22, s11
    s_add_u32 s23, s23, s11
    s_min_u32 s12, s12, s20
    s_sub_u32 s12, s22, s12
    s_add_u32 s23, s23, s12
    s_min_u32 s13, s13, s20
    s_sub_u32 s13, s22, s13
    s_add_u32 s23, s23, s13
    s_min_u32 s14, s14, s20
    s_sub_u32 s14, s22, s14
    s_add_u32 s23, s23, s14
    s_min_u32 s15, s15, s20
    s_sub_u32 s15, s22, s15
    s_add_u32 s23, s23, s15
    s_min_u32 s16, s16, s20
    s_sub_u32 s16, s22, s16
    s_add_u32 s23, s23, s16
    s_min_u32 s17, s17, s20
    s_sub_u32 s17, s22, s17
    s_add_u32 s23, s23, s17
    s_min_u32 s18, s18, s20
    s_sub_u32 s18, s22, s18
    s_add_u32 s23, s23, s18
    s_min_u32 s19, s19, s20
    s_sub_u32 s19, s22, s19
    s_add_u32 s23, s23, s19
    s_ashr_i32 s23, s23, 4
    s_mov_b32 s101, 0
    s_cmp_ge_i32 s23, -60
    s_cselect_b32 s101, 1, s101
    s_cmp_ge_i32 s23, 20
    s_cselect_b32 s101, 2, s101
    s_cmp_ge_i32 s23, 100
    s_cselect_b32 s101, 3, s101
L_fb2b:
    s_nop 2
    v_readfirstlane_b32 s76, v255
    s_waitcnt vmcnt(7)
    s_cmp_ge_u32 s101, 3
    s_cbranch_scc1 L_go119
    s_waitcnt vmcnt(6)
    s_cmp_ge_u32 s101, 2
    s_cbranch_scc1 L_go119
    s_waitcnt vmcnt(5)
    s_cmp_ge_u32 s101, 1
    s_cbranch_scc1 L_go119
    s_waitcnt vmcnt(4)
L_go119:
    buffer_load_dwordx4 v[220:223], v2, s[36:39], s66 offen offset:128 nt
    v_lshlrev_b32 v4, 16, v188
    v_and_b32 v5, s67, v188
    v_fmac_f32 v52, v66, v4
    v_fmac_f32 v53, v66, v5
    v_lshlrev_b32 v6, 16, v189
    v_and_b32 v7, s67, v189
    v_fmac_f32 v54, v66, v6
    v_fmac_f32 v55, v66, v7
    v_lshlrev_b32 v8, 16, v190
    v_and_b32 v9, s67, v190
    v_fmac_f32 v56, v66, v8
    v_fmac_f32 v57, v66, v9
    v_lshlrev_b32 v10, 16, v191
    v_and_b32 v11, s67, v191
    v_fmac_f32 v58, v66, v10
    v_fmac_f32 v59, v66, v11
    v_sub_f32 v88, v88, v22
    v_mul_f32 v88, 0x3fb8aa3b, v88
    v_exp_f32 v88, v88
    s_nop 0
    v_add_f32 v23, v23, v88
    v_sub_f32 v89, v89, v22
    v_mul_f32 v89, 0x3fb8aa3b, v89
    v_exp_f32 v89, v89
    s_nop 0
    v_add_f32 v23, v23, v89
    v_sub_f32 v90, v90, v22
    v_mul_f32 v90, 0x3fb8aa3b, v90
    v_exp_f32 v90, v90
    s_nop 0
    v_add_f32 v23, v23, v90
    v_sub_f32 v91, v91, v22
    v_mul_f32 v91, 0x3fb8aa3b, v91
    v_exp_f32 v91, v91
    s_nop 0
    v_add_f32 v23, v23, v91
    s_waitcnt vmcnt(7)
    s_cmp_ge_u32 s101, 3
    s_cbranch_scc1 L_go120
    s_waitcnt vmcnt(6)
    s_cmp_ge_u32 s101, 2
    s_cbranch_scc1 L_go120
    s_waitcnt vmcnt(5)
    s_cmp_ge_u32 s101, 1
    s_cbranch_scc1 L_go120
    s_waitcnt vmcnt(4)
L_go120:
    buffer_load_dwordx4 v[224:227], v2, s[36:39], s66 offen offset:256 nt
    v_lshlrev_b32 v4, 16, v192
    v_and_b32 v5, s67, v192
    v_fmac_f32 v36, v67, v4
    v_fmac_f32 v37, v67, v5
    v_lshlrev_b32 v6, 16, v193
    v_and_b32 v7, s67, v193
    v_fmac_f32 v38, v67, v6
    v_fmac_f32 v39, v67, v7
    v_lshlrev_b32 v8, 16, v194
    v_and_b32 v9, s67, v194
    v_fmac_f32 v40, v67, v8
    v_fmac_f32 v41, v67, v9
    v_lshlrev_b32 v10, 16, v195
    v_and_b32 v11, s67, v195
    v_fmac_f32 v42, v67, v10
    v_fmac_f32 v43, v67, v11
    s_waitcnt vmcnt(7)
    s_cmp_ge_u32 s101, 3
    s_cbranch_scc1 L_go121
    s_waitcnt vmcnt(6)
    s_cmp_ge_u32 s101, 2
    s_cbranch_scc1 L_go121
    s_waitcnt vmcnt(5)
    s_cmp_ge_u32 s101, 1
    s_cbranch_scc1 L_go121
    s_waitcnt vmcnt(4)
L_go121:
    s_add_u32 s66, s79, 10
    s_and_b32 s66, s66, 31
    s_mul_i32 s66, s66, 98304
    s_add_u32 s66, s66, s65
    buffer_load_dwordx4 v[228:231], v2, s[36:39], s66 offen offset:0 nt
    v_lshlrev_b32 v4, 16, v196
    v_and_b32 v5, s67, v196
    v_fmac_f32 v44, v67, v4
    v_fmac_f32 v45, v67, v5
    v_lshlrev_b32 v6, 16, v197
    v_and_b32 v7, s67, v197
    v_fmac_f32 v46, v67, v6
    v_fmac_f32 v47, v67, v7
    v_lshlrev_b32 v8, 16, v198
    v_and_b32 v9, s67, v198
    v_fmac_f32 v48, v67, v8
    v_fmac_f32 v49, v67, v9
    v_lshlrev_b32 v10, 16, v199
    v_and_b32 v11, s67, v199
    v_fmac_f32 v50, v67, v10
    v_fmac_f32 v51, v67, v11
    s_waitcnt vmcnt(7)
    s_cmp_ge_u32 s101, 3
    s_cbranch_scc1 L_go122
    s_waitcnt vmcnt(6)
    s_cmp_ge_u32 s101, 2
    s_cbranch_scc1 L_go122
    s_waitcnt vmcnt(5)
    s_cmp_ge_u32 s101, 1
    s_cbranch_scc1 L_go122
    s_waitcnt vmcnt(4)
L_go122:
    buffer_load_dwordx4 v[232:235], v2, s[36:39], s66 offen offset:128 nt
    v_lshlrev_b32 v4, 16, v200
    v_and_b32 v5, s67, v200
    v_fmac_f32 v52, v67, v4
    v_fmac_f32 v53, v67, v5
    v_lshlrev_b32 v6, 16, v201
    v_and_b32 v7, s67, v201
    v_fmac_f32 v54, v67, v6
    v_fmac_f32 v55, v67, v7
    v_lshlrev_b32 v8, 16, v202
    v_and_b32 v9, s67, v202
    v_fmac_f32 v56, v67, v8
    v_fmac_f32 v57, v67, v9
    v_lshlrev_b32 v10, 16, v203
    v_and_b32 v11, s67, v203
    v_fmac_f32 v58, v67, v10
    v_fmac_f32 v59, v67, v11
    v_add_f32_dpp v23, v23, v23 row_ror:8 row_mask:0xf bank_mask:0xf
    v_mov_b32 v12, v23
    s_nop 1
    v_permlane16_swap_b32 v23, v12
    v_add_f32 v23, v23, v12
    v_mov_b32 v12, v23
    s_nop 1
    v_permlane32_swap_b32 v23, v12
    v_add_f32 v23, v23, v12
    s_lshl_b32 s70, s63, 3
    v_mov_b32 v12, s70
    ds_write_b64 v12, v[22:23] offset:64
    s_waitcnt vmcnt(7)
    s_cmp_ge_u32 s101, 3
    s_cbranch_scc1 L_go123
    s_waitcnt vmcnt(6)
    s_cmp_ge_u32 s101, 2
    s_cbranch_scc1 L_go123
    s_waitcnt vmcnt(5)
    s_cmp_ge_u32 s101, 1
    s_cbranch_scc1 L_go123
    s_waitcnt vmcnt(4)
L_go123:
    buffer_load_dwordx4 v[236:239], v2, s[36:39], s66 offen offset:256 nt
    v_lshlrev_b32 v4, 16, v204
    v_and_b32 v5, s67, v204
    v_fmac_f32 v36, v68, v4
    v_fmac_f32 v37, v68, v5
    v_lshlrev_b32 v6, 16, v205
    v_and_b32 v7, s67, v205
    v_fmac_f32 v38, v68, v6
    v_fmac_f32 v39, v68, v7
    v_lshlrev_b32 v8, 16, v206
    v_and_b32 v9, s67, v206
    v_fmac_f32 v40, v68, v8
    v_fmac_f32 v41, v68, v9
    v_lshlrev_b32 v10, 16, v207
    v_and_b32 v11, s67, v207
    v_fmac_f32 v42, v68, v10
    v_fmac_f32 v43, v68, v11
    s_waitcnt vmcnt(7)
    s_cmp_ge_u32 s101, 3
    s_cbranch_scc1 L_go124
    s_waitcnt vmcnt(6)
    s_cmp_ge_u32 s101, 2
    s_cbranch_scc1 L_go124
    s_waitcnt vmcnt(5)
    s_cmp_ge_u32 s101, 1
    s_cbranch_scc1 L_go124
    s_waitcnt vmcnt(4)
L_go124:
    s_add_u32 s66, s79, 11
    s_and_b32 s66, s66, 31
    s_mul_i32 s66, s66, 98304
    s_add_u32 s66, s66, s65
    buffer_load_dwordx4 v[240:243], v2, s[36:39], s66 offen offset:0 nt
    v_lshlrev_b32 v4, 16, v208
    v_and_b32 v5, s67, v208
    v_fmac_f32 v44, v68, v4
    v_fmac_f32 v45, v68, v5
    v_lshlrev_b32 v6, 16, v209
    v_and_b32 v7, s67, v209
    v_fmac_f32 v46, v68, v6
    v_fmac_f32 v47, v68, v7
    v_lshlrev_b32 v8, 16, v210
    v_and_b32 v9, s67, v210
    v_fmac_f32 v48, v68, v8
    v_fmac_f32 v49, v68, v9
    v_lshlrev_b32 v10, 16, v211
    v_and_b32 v11, s67, v211
    v_fmac_f32 v50, v68, v10
    v_fmac_f32 v51, v68, v11
    s_waitcnt vmcnt(7)
    s_cmp_ge_u32 s101, 3
    s_cbranch_scc1 L_go125
    s_waitcnt vmcnt(6)
    s_cmp_ge_u32 s101, 2
    s_cbranch_scc1 L_go125
    s_waitcnt vmcnt(5)
    s_cmp_ge_u32 s101, 1
    s_cbranch_scc1 L_go125
    s_waitcnt vmcnt(4)
L_go125:
    buffer_load_dwordx4 v[244:247], v2, s[36:39], s66 offen offset:128 nt
    v_lshlrev_b32 v4, 16, v212
    v_and_b32 v5, s67, v212
    v_fmac_f32 v52, v68, v4
    v_fmac_f32 v53, v68, v5
    v_lshlrev_b32 v6, 16, v213
    v_and_b32 v7, s67, v213
    v_fmac_f32 v54, v68, v6
    v_fmac_f32 v55, v68, v7
    v_lshlrev_b32 v8, 16, v214
    v_and_b32 v9, s67, v214
    v_fmac_f32 v56, v68, v8
    v_fmac_f32 v57, v68, v9
    v_lshlrev_b32 v10, 16, v215
    v_and_b32 v11, s67, v215
    v_fmac_f32 v58, v68, v10
    v_fmac_f32 v59, v68, v11
    s_waitcnt vmcnt(7)
    s_cmp_ge_u32 s101, 3
    s_cbranch_scc1 L_go126
    s_waitcnt vmcnt(6)
    s_cmp_ge_u32 s101, 2
    s_cbranch_scc1 L_go126
    s_waitcnt vmcnt(5)
    s_cmp_ge_u32 s101, 1
    s_cbranch_scc1 L_go126
    s_waitcnt vmcnt(4)
L_go126:
    buffer_load_dwordx4 v[248:251], v2, s[36:39], s66 offen offset:256 nt
    v_lshlrev_b32 v4, 16, v216
    v_and_b32 v5, s67, v216
    v_fmac_f32 v36, v69, v4
    v_fmac_f32 v37, v69, v5
    v_lshlrev_b32 v6, 16, v217
    v_and_b32 v7, s67, v217
    v_fmac_f32 v38, v69, v6
    v_fmac_f32 v39, v69, v7
    v_lshlrev_b32 v8, 16, v218
    v_and_b32 v9, s67, v218
    v_fmac_f32 v40, v69, v8
    v_fmac_f32 v41, v69, v9
    v_lshlrev_b32 v10, 16, v219
    v_and_b32 v11, s67, v219
    v_fmac_f32 v42, v69, v10
    v_fmac_f32 v43, v69, v11
    s_waitcnt vmcnt(7)
    s_cmp_ge_u32 s101, 3
    s_cbranch_scc1 L_go127
    s_waitcnt vmcnt(6)
    s_cmp_ge_u32 s101, 2
    s_cbranch_scc1 L_go127
    s_waitcnt vmcnt(5)
    s_cmp_ge_u32 s101, 1
    s_cbranch_scc1 L_go127
    s_waitcnt vmcnt(4)
L_go127:
    s_add_u32 s66, s79, 12
    s_and_b32 s66, s66, 31
    s_mul_i32 s66, s66, 98304
    s_add_u32 s66, s66, s65
    buffer_load_dwordx4 v[92:95], v2, s[36:39], s66 offen offset:0 nt
    v_lshlrev_b32 v4, 16, v220
    v_and_b32 v5, s67, v220
    v_fmac_f32 v44, v69, v4
    v_fmac_f32 v45, v69, v5
    v_lshlrev_b32 v6, 16, v221
    v_and_b32 v7, s67, v221
    v_fmac_f32 v46, v69, v6
    v_fmac_f32 v47, v69, v7
    v_lshlrev_b32 v8, 16, v222
    v_and_b32 v9, s67, v222
    v_fmac_f32 v48, v69, v8
    v_fmac_f32 v49, v69, v9
    v_lshlrev_b32 v10, 16, v223
    v_and_b32 v11, s67, v223
    v_fmac_f32 v50, v69, v10
    v_fmac_f32 v51, v69, v11
    s_mov_b32 s22, s20
    s_memrealtime s[20:21]
    s_waitcnt vmcnt(7)
    s_cmp_ge_u32 s101, 3
    s_cbranch_scc1 L_go128
    s_waitcnt vmcnt(6)
    s_cmp_ge_u32 s101, 2
    s_cbranch_scc1 L_go128
    s_waitcnt vmcnt(5)
    s_cmp_ge_u32 s101, 1
    s_cbranch_scc1 L_go128
    s_waitcnt vmcnt(4)
L_go128:
    buffer_load_dwordx4 v[96:99], v2, s[36:39], s66 offen offset:128 nt
    v_lshlrev_b32 v4, 16, v224
    v_and_b32 v5, s67, v224
    v_fmac_f32 v52, v69, v4
    v_fmac_f32 v53, v69, v5
    v_lshlrev_b32 v6, 16, v225
    v_and_b32 v7, s67, v225
    v_fmac_f32 v54, v69, v6
    v_fmac_f32 v55, v69, v7
    v_lshlrev_b32 v8, 16, v226
    v_and_b32 v9, s67, v226
    v_fmac_f32 v56, v69, v8
    v_fmac_f32 v57, v69, v9
    v_lshlrev_b32 v10, 16, v227
    v_and_b32 v11, s67, v227
    v_fmac_f32 v58, v69, v10
    v_fmac_f32 v59, v69, v11
    s_waitcnt lgkmcnt(0)
    v_mov_b32 v254, s20
    s_mov_b32 s70, 983424
    buffer_store_dword v254, v253, s[56:59], s70 offen sc1
    s_cmp_eq_u32 s76, 0
    s_cbranch_scc1 L_fb3a
    s_load_dwordx16 s[4:19], s[24:25], 983296
L_fb3a:
    ds_read_b32 v255, v3 offset:8
    s_waitcnt vmcnt(7)
    s_cmp_ge_u32 s101, 3
    s_cbranch_scc1 L_go129
    s_waitcnt vmcnt(6)
    s_cmp_ge_u32 s101, 2
    s_cbranch_scc1 L_go129
    s_waitcnt vmcnt(5)
    s_cmp_ge_u32 s101, 1
    s_cbranch_scc1 L_go129
    s_waitcnt vmcnt(4)
L_go129:
    buffer_load_dwordx4 v[100:103], v2, s[36:39], s66 offen offset:256 nt
    v_lshlrev_b32 v4, 16, v228
    v_and_b32 v5, s67, v228
    v_fmac_f32 v36, v70, v4
    v_fmac_f32 v37, v70, v5
    v_lshlrev_b32 v6, 16, v229
    v_and_b32 v7, s67, v229
    v_fmac_f32 v38, v70, v6
    v_fmac_f32 v39, v70, v7
    v_lshlrev_b32 v8, 16, v230
    v_and_b32 v9, s67, v230
    v_fmac_f32 v40, v70, v8
    v_fmac_f32 v41, v70, v9
    v_lshlrev_b32 v10, 16, v231
    v_and_b32 v11, s67, v231
    v_fmac_f32 v42, v70, v10
    v_fmac_f32 v43, v70, v11
    s_waitcnt vmcnt(7)
    s_cmp_ge_u32 s101, 3
    s_cbranch_scc1 L_go130
    s_waitcnt vmcnt(6)
    s_cmp_ge_u32 s101, 2
    s_cbranch_scc1 L_go130
    s_waitcnt vmcnt(5)
    s_cmp_ge_u32 s101, 1
    s_cbranch_scc1 L_go130
    s_waitcnt vmcnt(4)
L_go130:
    s_add_u32 s66, s79, 13
    s_and_b32 s66, s66, 31
    s_mul_i32 s66, s66, 98304
    s_add_u32 s66, s66, s65
    buffer_load_dwordx4 v[104:107], v2, s[36:39], s66 offen offset:0 nt
    v_lshlrev_b32 v4, 16, v232
    v_and_b32 v5, s67, v232
    v_fmac_f32 v44, v70, v4
    v_fmac_f32 v45, v70, v5
    v_lshlrev_b32 v6, 16, v233
    v_and_b32 v7, s67, v233
    v_fmac_f32 v46, v70, v6
    v_fmac_f32 v47, v70, v7
    v_lshlrev_b32 v8, 16, v234
    v_and_b32 v9, s67, v234
    v_fmac_f32 v48, v70, v8
    v_fmac_f32 v49, v70, v9
    v_lshlrev_b32 v10, 16, v235
    v_and_b32 v11, s67, v235
    v_fmac_f32 v50, v70, v10
    v_fmac_f32 v51, v70, v11
    s_waitcnt vmcnt(7)
    s_cmp_ge_u32 s101, 3
    s_cbranch_scc1 L_go131
    s_waitcnt vmcnt(6)
    s_cmp_ge_u32 s101, 2
    s_cbranch_scc1 L_go131
    s_waitcnt vmcnt(5)
    s_cmp_ge_u32 s101, 1
    s_cbranch_scc1 L_go131
    s_waitcnt vmcnt(4)
L_go131:
    buffer_load_dwordx4 v[108:111], v2, s[36:39], s66 offen offset:128 nt
    v_lshlrev_b32 v4, 16, v236
    v_and_b32 v5, s67, v236
    v_fmac_f32 v52, v70, v4
    v_fmac_f32 v53, v70, v5
    v_lshlrev_b32 v6, 16, v237
    v_and_b32 v7, s67, v237
    v_fmac_f32 v54, v70, v6
    v_fmac_f32 v55, v70, v7
    v_lshlrev_b32 v8, 16, v238
    v_and_b32 v9, s67, v238
    v_fmac_f32 v56, v70, v8
    v_fmac_f32 v57, v70, v9
    v_lshlrev_b32 v10, 16, v239
    v_and_b32 v11, s67, v239
    v_fmac_f32 v58, v70, v10
    v_fmac_f32 v59, v70, v11
    s_waitcnt vmcnt(7)
    s_cmp_ge_u32 s101, 3
    s_cbranch_scc1 L_go132
    s_waitcnt vmcnt(6)
    s_cmp_ge_u32 s101, 2
    s_cbranch_scc1 L_go132
    s_waitcnt vmcnt(5)
    s_cmp_ge_u32 s101, 1
    s_cbranch_scc1 L_go132
    s_waitcnt vmcnt(4)
L_go132:
    buffer_load_dwordx4 v[112:115], v2, s[36:39], s66 offen offset:256 nt
    v_lshlrev_b32 v4, 16, v240
    v_and_b32 v5, s67, v240
    v_fmac_f32 v36, v71, v4
    v_fmac_f32 v37, v71, v5
    v_lshlrev_b32 v6, 16, v241
    v_and_b32 v7, s67, v241
    v_fmac_f32 v38, v71, v6
    v_fmac_f32 v39, v71, v7
    v_lshlrev_b32 v8, 16, v242
    v_and_b32 v9, s67, v242
    v_fmac_f32 v40, v71, v8
    v_fmac_f32 v41, v71, v9
    v_lshlrev_b32 v10, 16, v243
    v_and_b32 v11, s67, v243
    v_fmac_f32 v42, v71, v10
    v_fmac_f32 v43, v71, v11
    s_waitcnt vmcnt(7)
    s_cmp_ge_u32 s101, 3
    s_cbranch_scc1 L_go133
    s_waitcnt vmcnt(6)
    s_cmp_ge_u32 s101, 2
    s_cbranch_scc1 L_go133
    s_waitcnt vmcnt(5)
    s_cmp_ge_u32 s101, 1
    s_cbranch_scc1 L_go133
    s_waitcnt vmcnt(4)
L_go133:
    s_add_u32 s66, s79, 14
    s_and_b32 s66, s66, 31
    s_mul_i32 s66, s66, 98304
    s_add_u32 s66, s66, s65
    buffer_load_dwordx4 v[116:119], v2, s[36:39], s66 offen offset:0 nt
    v_lshlrev_b32 v4, 16, v244
    v_and_b32 v5, s67, v244
    v_fmac_f32 v44, v71, v4
    v_fmac_f32 v45, v71, v5
    v_lshlrev_b32 v6, 16, v245
    v_and_b32 v7, s67, v245
    v_fmac_f32 v46, v71, v6
    v_fmac_f32 v47, v71, v7
    v_lshlrev_b32 v8, 16, v246
    v_and_b32 v9, s67, v246
    v_fmac_f32 v48, v71, v8
    v_fmac_f32 v49, v71, v9
    v_lshlrev_b32 v10, 16, v247
    v_and_b32 v11, s67, v247
    v_fmac_f32 v50, v71, v10
    v_fmac_f32 v51, v71, v11
    s_waitcnt vmcnt(7)
    s_cmp_ge_u32 s101, 3
    s_cbranch_scc1 L_go134
    s_waitcnt vmcnt(6)
    s_cmp_ge_u32 s101, 2
    s_cbranch_scc1 L_go134
    s_waitcnt vmcnt(5)
    s_cmp_ge_u32 s101, 1
    s_cbranch_scc1 L_go134
    s_waitcnt vmcnt(4)
L_go134:
    buffer_load_dwordx4 v[120:123], v2, s[36:39], s66 offen offset:128 nt
    v_lshlrev_b32 v4, 16, v248
    v_and_b32 v5, s67, v248
    v_fmac_f32 v52, v71, v4
    v_fmac_f32 v53, v71, v5
    v_lshlrev_b32 v6, 16, v249
    v_and_b32 v7, s67, v249
    v_fmac_f32 v54, v71, v6
    v_fmac_f32 v55, v71, v7
    v_lshlrev_b32 v8, 16, v250
    v_and_b32 v9, s67, v250
    v_fmac_f32 v56, v71, v8
    v_fmac_f32 v57, v71, v9
    v_lshlrev_b32 v10, 16, v251
    v_and_b32 v11, s67, v251
    v_fmac_f32 v58, v71, v10
    v_fmac_f32 v59, v71, v11
    s_waitcnt vmcnt(7)
    s_cmp_ge_u32 s101, 3
    s_cbranch_scc1 L_go135
    s_waitcnt vmcnt(6)
    s_cmp_ge_u32 s101, 2
    s_cbranch_scc1 L_go135
    s_waitcnt vmcnt(5)
    s_cmp_ge_u32 s101, 1
    s_cbranch_scc1 L_go135
    s_waitcnt vmcnt(4)
L_go135:
    buffer_load_dwordx4 v[124:127], v2, s[36:39], s66 offen offset:256 nt
    v_lshlrev_b32 v4, 16, v92
    v_and_b32 v5, s67, v92
    v_fmac_f32 v36, v72, v4
    v_fmac_f32 v37, v72, v5
    v_lshlrev_b32 v6, 16, v93
    v_and_b32 v7, s67, v93
    v_fmac_f32 v38, v72, v6
    v_fmac_f32 v39, v72, v7
    v_lshlrev_b32 v8, 16, v94
    v_and_b32 v9, s67, v94
    v_fmac_f32 v40, v72, v8
    v_fmac_f32 v41, v72, v9
    v_lshlrev_b32 v10, 16, v95
    v_and_b32 v11, s67, v95
    v_fmac_f32 v42, v72, v10
    v_fmac_f32 v43, v72, v11
    s_waitcnt vmcnt(7)
    s_cmp_ge_u32 s101, 3
    s_cbranch_scc1 L_go136
    s_waitcnt vmcnt(6)
    s_cmp_ge_u32 s101, 2
    s_cbranch_scc1 L_go136
    s_waitcnt vmcnt(5)
    s_cmp_ge_u32 s101, 1
    s_cbranch_scc1 L_go136
    s_waitcnt vmcnt(4)
L_go136:
    s_add_u32 s66, s79, 15
    s_and_b32 s66, s66, 31
    s_mul_i32 s66, s66, 98304
    s_add_u32 s66, s66, s65
    buffer_load_dwordx4 v[128:131], v2, s[36:39], s66 offen offset:0 nt
    v_lshlrev_b32 v4, 16, v96
    v_and_b32 v5, s67, v96
    v_fmac_f32 v44, v72, v4
    v_fmac_f32 v45, v72, v5
    v_lshlrev_b32 v6, 16, v97
    v_and_b32 v7, s67, v97
    v_fmac_f32 v46, v72, v6
    v_fmac_f32 v47, v72, v7
    v_lshlrev_b32 v8, 16, v98
    v_and_b32 v9, s67, v98
    v_fmac_f32 v48, v72, v8
    v_fmac_f32 v49, v72, v9
    v_lshlrev_b32 v10, 16, v99
    v_and_b32 v11, s67, v99
    v_fmac_f32 v50, v72, v10
    v_fmac_f32 v51, v72, v11
    s_waitcnt lgkmcnt(0)
    s_cmp_eq_u32 s76, 0
    s_cbranch_scc1 L_fb3b
    s_mov_b32 s23, 0
    s_min_u32 s4, s4, s20
    s_sub_u32 s4, s22, s4
    s_add_u32 s23, s23, s4
    s_min_u32 s5, s5, s20
    s_sub_u32 s5, s22, s5
    s_add_u32 s23, s23, s5
    s_min_u32 s6, s6, s20
    s_sub_u32 s6, s22, s6
    s_add_u32 s23, s23, s6
    s_min_u32 s7, s7, s20
    s_sub_u32 s7, s22, s7
    s_add_u32 s23, s23, s7
    s_min_u32 s8, s8, s20
    s_sub_u32 s8, s22, s8
    s_add_u32 s23, s23, s8
    s_min_u32 s9, s9, s20
    s_sub_u32 s9, s22, s9
    s_add_u32 s23, s23, s9
    s_min_u32 s10, s10, s20
    s_sub_u32 s10, s22, s10
    s_add_u32 s23, s23, s10
    s_min_u32 s11, s11, s20
    s_sub_u32 s11, s22, s11
    s_add_u32 s23, s23, s11
    s_min_u32 s12, s12, s20
    s_sub_u32 s12, s22, s12
    s_add_u32 s23, s23, s12
    s_min_u32 s13, s13, s20
    s_sub_u32 s13, s22, s13
    s_add_u32 s23, s23, s13
    s_min_u32 s14, s14, s20
    s_sub_u32 s14, s22, s14
    s_add_u32 s23, s23, s14
    s_min_u32 s15, s15, s20
    s_sub_u32 s15, s22, s15
    s_add_u32 s23, s23, s15
    s_min_u32 s16, s16, s20
    s_sub_u32 s16, s22, s16
    s_add_u32 s23, s23, s16
    s_min_u32 s17, s17, s20
    s_sub_u32 s17, s22, s17
    s_add_u32 s23, s23, s17
    s_min_u32 s18, s18, s20
    s_sub_u32 s18, s22, s18
    s_add_u32 s23, s23, s18
    s_min_u32 s19, s19, s20
    s_sub_u32 s19, s22, s19
    s_add_u32 s23, s23, s19
    s_ashr_i32 s23, s23, 4
    s_mov_b32 s101, 0
    s_cmp_ge_i32 s23, -60
    s_cselect_b32 s101, 1, s101
    s_cmp_ge_i32 s23, 20
    s_cselect_b32 s101, 2, s101
    s_cmp_ge_i32 s23, 100
    s_cselect_b32 s101, 3, s101
L_fb3b:
    s_nop 2
    v_readfirstlane_b32 s76, v255
    s_waitcnt vmcnt(7)
    s_cmp_ge_u32 s101, 3
    s_cbranch_scc1 L_go137
    s_waitcnt vmcnt(6)
    s_cmp_ge_u32 s101, 2
    s_cbranch_scc1 L_go137
    s_waitcnt vmcnt(5)
    s_cmp_ge_u32 s101, 1
    s_cbranch_scc1 L_go137
    s_waitcnt vmcnt(4)
L_go137:
    buffer_load_dwordx4 v[132:135], v2, s[36:39], s66 offen offset:128 nt
    v_lshlrev_b32 v4, 16, v100
    v_and_b32 v5, s67, v100
    v_fmac_f32 v52, v72, v4
    v_fmac_f32 v53, v72, v5
    v_lshlrev_b32 v6, 16, v101
    v_and_b32 v7, s67, v101
    v_fmac_f32 v54, v72, v6
    v_fmac_f32 v55, v72, v7
    v_lshlrev_b32 v8, 16, v102
    v_and_b32 v9, s67, v102
    v_fmac_f32 v56, v72, v8
    v_fmac_f32 v57, v72, v9
    v_lshlrev_b32 v10, 16, v103
    v_and_b32 v11, s67, v103
    v_fmac_f32 v58, v72, v10
    v_fmac_f32 v59, v72, v11
    s_waitcnt vmcnt(7)
    s_cmp_ge_u32 s101, 3
    s_cbranch_scc1 L_go138
    s_waitcnt vmcnt(6)
    s_cmp_ge_u32 s101, 2
    s_cbranch_scc1 L_go138
    s_waitcnt vmcnt(5)
    s_cmp_ge_u32 s101, 1
    s_cbranch_scc1 L_go138
    s_waitcnt vmcnt(4)
L_go138:
    buffer_load_dwordx4 v[136:139], v2, s[36:39], s66 offen offset:256 nt
    v_lshlrev_b32 v4, 16, v104
    v_and_b32 v5, s67, v104
    v_fmac_f32 v36, v73, v4
    v_fmac_f32 v37, v73, v5
    v_lshlrev_b32 v6, 16, v105
    v_and_b32 v7, s67, v105
    v_fmac_f32 v38, v73, v6
    v_fmac_f32 v39, v73, v7
    v_lshlrev_b32 v8, 16, v106
    v_and_b32 v9, s67, v106
    v_fmac_f32 v40, v73, v8
    v_fmac_f32 v41, v73, v9
    v_lshlrev_b32 v10, 16, v107
    v_and_b32 v11, s67, v107
    v_fmac_f32 v42, v73, v10
    v_fmac_f32 v43, v73, v11
    s_waitcnt vmcnt(7)
    s_cmp_ge_u32 s101, 3
    s_cbranch_scc1 L_go139
    s_waitcnt vmcnt(6)
    s_cmp_ge_u32 s101, 2
    s_cbranch_scc1 L_go139
    s_waitcnt vmcnt(5)
    s_cmp_ge_u32 s101, 1
    s_cbranch_scc1 L_go139
    s_waitcnt vmcnt(4)
L_go139:
    s_add_u32 s66, s79, 16
    s_and_b32 s66, s66, 31
    s_mul_i32 s66, s66, 98304
    s_add_u32 s66, s66, s65
    buffer_load_dwordx4 v[140:143], v2, s[36:39], s66 offen offset:0 nt
    v_lshlrev_b32 v4, 16, v108
    v_and_b32 v5, s67, v108
    v_fmac_f32 v44, v73, v4
    v_fmac_f32 v45, v73, v5
    v_lshlrev_b32 v6, 16, v109
    v_and_b32 v7, s67, v109
    v_fmac_f32 v46, v73, v6
    v_fmac_f32 v47, v73, v7
    v_lshlrev_b32 v8, 16, v110
    v_and_b32 v9, s67, v110
    v_fmac_f32 v48, v73, v8
    v_fmac_f32 v49, v73, v9
    v_lshlrev_b32 v10, 16, v111
    v_and_b32 v11, s67, v111
    v_fmac_f32 v50, v73, v10
    v_fmac_f32 v51, v73, v11
    s_waitcnt vmcnt(7)
    s_cmp_ge_u32 s101, 3
    s_cbranch_scc1 L_go140
    s_waitcnt vmcnt(6)
    s_cmp_ge_u32 s101, 2
    s_cbranch_scc1 L_go140
    s_waitcnt vmcnt(5)
    s_cmp_ge_u32 s101, 1
    s_cbranch_scc1 L_go140
    s_waitcnt vmcnt(4)
L_go140:
    buffer_load_dwordx4 v[144:147], v2, s[36:39], s66 offen offset:128 nt
    v_lshlrev_b32 v4, 16, v112
    v_and_b32 v5, s67, v112
    v_fmac_f32 v52, v73, v4
    v_fmac_f32 v53, v73, v5
    v_lshlrev_b32 v6, 16, v113
    v_and_b32 v7, s67, v113
    v_fmac_f32 v54, v73, v6
    v_fmac_f32 v55, v73, v7
    v_lshlrev_b32 v8, 16, v114
    v_and_b32 v9, s67, v114
    v_fmac_f32 v56, v73, v8
    v_fmac_f32 v57, v73, v9
    v_lshlrev_b32 v10, 16, v115
    v_and_b32 v11, s67, v115
    v_fmac_f32 v58, v73, v10
    v_fmac_f32 v59, v73, v11
    s_waitcnt vmcnt(7)
    s_cmp_ge_u32 s101, 3
    s_cbranch_scc1 L_go141
    s_waitcnt vmcnt(6)
    s_cmp_ge_u32 s101, 2
    s_cbranch_scc1 L_go141
    s_waitcnt vmcnt(5)
    s_cmp_ge_u32 s101, 1
    s_cbranch_scc1 L_go141
    s_waitcnt vmcnt(4)
L_go141:
    buffer_load_dwordx4 v[148:151], v2, s[36:39], s66 offen offset:256 nt
    v_lshlrev_b32 v4, 16, v116
    v_and_b32 v5, s67, v116
    v_fmac_f32 v36, v74, v4
    v_fmac_f32 v37, v74, v5
    v_lshlrev_b32 v6, 16, v117
    v_and_b32 v7, s67, v117
    v_fmac_f32 v38, v74, v6
    v_fmac_f32 v39, v74, v7
    v_lshlrev_b32 v8, 16, v118
    v_and_b32 v9, s67, v118
    v_fmac_f32 v40, v74, v8
    v_fmac_f32 v41, v74, v9
    v_lshlrev_b32 v10, 16, v119
    v_and_b32 v11, s67, v119
    v_fmac_f32 v42, v74, v10
    v_fmac_f32 v43, v74, v11
    s_waitcnt vmcnt(7)
    s_cmp_ge_u32 s101, 3
    s_cbranch_scc1 L_go142
    s_waitcnt vmcnt(6)
    s_cmp_ge_u32 s101, 2
    s_cbranch_scc1 L_go142
    s_waitcnt vmcnt(5)
    s_cmp_ge_u32 s101, 1
    s_cbranch_scc1 L_go142
    s_waitcnt vmcnt(4)
L_go142:
    s_add_u32 s66, s79, 17
    s_and_b32 s66, s66, 31
    s_mul_i32 s66, s66, 98304
    s_add_u32 s66, s66, s65
    buffer_load_dwordx4 v[152:155], v2, s[36:39], s66 offen offset:0 nt
    v_lshlrev_b32 v4, 16, v120
    v_and_b32 v5, s67, v120
    v_fmac_f32 v44, v74, v4
    v_fmac_f32 v45, v74, v5
    v_lshlrev_b32 v6, 16, v121
    v_and_b32 v7, s67, v121
    v_fmac_f32 v46, v74, v6
    v_fmac_f32 v47, v74, v7
    v_lshlrev_b32 v8, 16, v122
    v_and_b32 v9, s67, v122
    v_fmac_f32 v48, v74, v8
    v_fmac_f32 v49, v74, v9
    v_lshlrev_b32 v10, 16, v123
    v_and_b32 v11, s67, v123
    v_fmac_f32 v50, v74, v10
    v_fmac_f32 v51, v74, v11
    s_waitcnt vmcnt(7)
    s_cmp_ge_u32 s101, 3
    s_cbranch_scc1 L_go143
    s_waitcnt vmcnt(6)
    s_cmp_ge_u32 s101, 2
    s_cbranch_scc1 L_go143
    s_waitcnt vmcnt(5)
    s_cmp_ge_u32 s101, 1
    s_cbranch_scc1 L_go143
    s_waitcnt vmcnt(4)
L_go143:
    buffer_load_dwordx4 v[156:159], v2, s[36:39], s66 offen offset:128 nt
    v_lshlrev_b32 v4, 16, v124
    v_and_b32 v5, s67, v124
    v_fmac_f32 v52, v74, v4
    v_fmac_f32 v53, v74, v5
    v_lshlrev_b32 v6, 16, v125
    v_and_b32 v7, s67, v125
    v_fmac_f32 v54, v74, v6
    v_fmac_f32 v55, v74, v7
    v_lshlrev_b32 v8, 16, v126
    v_and_b32 v9, s67, v126
    v_fmac_f32 v56, v74, v8
    v_fmac_f32 v57, v74, v9
    v_lshlrev_b32 v10, 16, v127
    v_and_b32 v11, s67, v127
    v_fmac_f32 v58, v74, v10
    v_fmac_f32 v59, v74, v11
    s_waitcnt vmcnt(7)
    s_cmp_ge_u32 s101, 3
    s_cbranch_scc1 L_go144
    s_waitcnt vmcnt(6)
    s_cmp_ge_u32 s101, 2
    s_cbranch_scc1 L_go144
    s_waitcnt vmcnt(5)
    s_cmp_ge_u32 s101, 1
    s_cbranch_scc1 L_go144
    s_waitcnt vmcnt(4)
L_go144:
    buffer_load_dwordx4 v[160:163], v2, s[36:39], s66 offen offset:256 nt
    v_lshlrev_b32 v4, 16, v128
    v_and_b32 v5, s67, v128
    v_fmac_f32 v36, v75, v4
    v_fmac_f32 v37, v75, v5
    v_lshlrev_b32 v6, 16, v129
    v_and_b32 v7, s67, v129
    v_fmac_f32 v38, v75, v6
    v_fmac_f32 v39, v75, v7
    v_lshlrev_b32 v8, 16, v130
    v_and_b32 v9, s67, v130
    v_fmac_f32 v40, v75, v8
    v_fmac_f32 v41, v75, v9
    v_lshlrev_b32 v10, 16, v131
    v_and_b32 v11, s67, v131
    v_fmac_f32 v42, v75, v10
    v_fmac_f32 v43, v75, v11
    s_waitcnt vmcnt(7)
    s_cmp_ge_u32 s101, 3
    s_cbranch_scc1 L_go145
    s_waitcnt vmcnt(6)
    s_cmp_ge_u32 s101, 2
    s_cbranch_scc1 L_go145
    s_waitcnt vmcnt(5)
    s_cmp_ge_u32 s101, 1
    s_cbranch_scc1 L_go145
    s_waitcnt vmcnt(4)
L_go145:
    s_add_u32 s66, s79, 18
    s_and_b32 s66, s66, 31
    s_mul_i32 s66, s66, 98304
    s_add_u32 s66, s66, s65
    buffer_load_dwordx4 v[164:167], v2, s[36:39], s66 offen offset:0 nt
    v_lshlrev_b32 v4, 16, v132
    v_and_b32 v5, s67, v132
    v_fmac_f32 v44, v75, v4
    v_fmac_f32 v45, v75, v5
    v_lshlrev_b32 v6, 16, v133
    v_and_b32 v7, s67, v133
    v_fmac_f32 v46, v75, v6
    v_fmac_f32 v47, v75, v7
    v_lshlrev_b32 v8, 16, v134
    v_and_b32 v9, s67, v134
    v_fmac_f32 v48, v75, v8
    v_fmac_f32 v49, v75, v9
    v_lshlrev_b32 v10, 16, v135
    v_and_b32 v11, s67, v135
    v_fmac_f32 v50, v75, v10
    v_fmac_f32 v51, v75, v11
    s_mov_b32 s22, s20
    s_memrealtime s[20:21]
    s_waitcnt vmcnt(7)
    s_cmp_ge_u32 s101, 3
    s_cbranch_scc1 L_go146
    s_waitcnt vmcnt(6)
    s_cmp_ge_u32 s101, 2
    s_cbranch_scc1 L_go146
    s_waitcnt vmcnt(5)
    s_cmp_ge_u32 s101, 1
    s_cbranch_scc1 L_go146
    s_waitcnt vmcnt(4)
L_go146:
    buffer_load_dwordx4 v[168:171], v2, s[36:39], s66 offen offset:128 nt
    v_lshlrev_b32 v4, 16, v136
    v_and_b32 v5, s67, v136
    v_fmac_f32 v52, v75, v4
    v_fmac_f32 v53, v75, v5
    v_lshlrev_b32 v6, 16, v137
    v_and_b32 v7, s67, v137
    v_fmac_f32 v54, v75, v6
    v_fmac_f32 v55, v75, v7
    v_lshlrev_b32 v8, 16, v138
    v_and_b32 v9, s67, v138
    v_fmac_f32 v56, v75, v8
    v_fmac_f32 v57, v75, v9
    v_lshlrev_b32 v10, 16, v139
    v_and_b32 v11, s67, v139
    v_fmac_f32 v58, v75, v10
    v_fmac_f32 v59, v75, v11
    s_waitcnt lgkmcnt(0)
    v_mov_b32 v254, s20
    s_mov_b32 s70, 983552
    buffer_store_dword v254, v253, s[56:59], s70 offen sc1
    s_cmp_eq_u32 s76, 0
    s_cbranch_scc1 L_fb4a
    s_load_dwordx16 s[4:19], s[24:25], 983424
L_fb4a:
    ds_read_b32 v255, v3 offset:8
    s_waitcnt vmcnt(7)
    s_cmp_ge_u32 s101, 3
    s_cbranch_scc1 L_go147
    s_waitcnt vmcnt(6)
    s_cmp_ge_u32 s101, 2
    s_cbranch_scc1 L_go147
    s_waitcnt vmcnt(5)
    s_cmp_ge_u32 s101, 1
    s_cbranch_scc1 L_go147
    s_waitcnt vmcnt(4)
L_go147:
    buffer_load_dwordx4 v[172:175], v2, s[36:39], s66 offen offset:256 nt
    v_lshlrev_b32 v4, 16, v140
    v_and_b32 v5, s67, v140
    v_fmac_f32 v36, v76, v4
    v_fmac_f32 v37, v76, v5
    v_lshlrev_b32 v6, 16, v141
    v_and_b32 v7, s67, v141
    v_fmac_f32 v38, v76, v6
    v_fmac_f32 v39, v76, v7
    v_lshlrev_b32 v8, 16, v142
    v_and_b32 v9, s67, v142
    v_fmac_f32 v40, v76, v8
    v_fmac_f32 v41, v76, v9
    v_lshlrev_b32 v10, 16, v143
    v_and_b32 v11, s67, v143
    v_fmac_f32 v42, v76, v10
    v_fmac_f32 v43, v76, v11
    s_waitcnt vmcnt(7)
    s_cmp_ge_u32 s101, 3
    s_cbranch_scc1 L_go148
    s_waitcnt vmcnt(6)
    s_cmp_ge_u32 s101, 2
    s_cbranch_scc1 L_go148
    s_waitcnt vmcnt(5)
    s_cmp_ge_u32 s101, 1
    s_cbranch_scc1 L_go148
    s_waitcnt vmcnt(4)
L_go148:
    s_add_u32 s66, s79, 19
    s_and_b32 s66, s66, 31
    s_mul_i32 s66, s66, 98304
    s_add_u32 s66, s66, s65
    buffer_load_dwordx4 v[176:179], v2, s[36:39], s66 offen offset:0 nt
    v_lshlrev_b32 v4, 16, v144
    v_and_b32 v5, s67, v144
    v_fmac_f32 v44, v76, v4
    v_fmac_f32 v45, v76, v5
    v_lshlrev_b32 v6, 16, v145
    v_and_b32 v7, s67, v145
    v_fmac_f32 v46, v76, v6
    v_fmac_f32 v47, v76, v7
    v_lshlrev_b32 v8, 16, v146
    v_and_b32 v9, s67, v146
    v_fmac_f32 v48, v76, v8
    v_fmac_f32 v49, v76, v9
    v_lshlrev_b32 v10, 16, v147
    v_and_b32 v11, s67, v147
    v_fmac_f32 v50, v76, v10
    v_fmac_f32 v51, v76, v11
    s_waitcnt vmcnt(7)
    s_cmp_ge_u32 s101, 3
    s_cbranch_scc1 L_go149
    s_waitcnt vmcnt(6)
    s_cmp_ge_u32 s101, 2
    s_cbranch_scc1 L_go149
    s_waitcnt vmcnt(5)
    s_cmp_ge_u32 s101, 1
    s_cbranch_scc1 L_go149
    s_waitcnt vmcnt(4)
L_go149:
    buffer_load_dwordx4 v[180:183], v2, s[36:39], s66 offen offset:128 nt
    v_lshlrev_b32 v4, 16, v148
    v_and_b32 v5, s67, v148
    v_fmac_f32 v52, v76, v4
    v_fmac_f32 v53, v76, v5
    v_lshlrev_b32 v6, 16, v149
    v_and_b32 v7, s67, v149
    v_fmac_f32 v54, v76, v6
    v_fmac_f32 v55, v76, v7
    v_lshlrev_b32 v8, 16, v150
    v_and_b32 v9, s67, v150
    v_fmac_f32 v56, v76, v8
    v_fmac_f32 v57, v76, v9
    v_lshlrev_b32 v10, 16, v151
    v_and_b32 v11, s67, v151
    v_fmac_f32 v58, v76, v10
    v_fmac_f32 v59, v76, v11
    s_waitcnt vmcnt(7)
    s_cmp_ge_u32 s101, 3
    s_cbranch_scc1 L_go150
    s_waitcnt vmcnt(6)
    s_cmp_ge_u32 s101, 2
    s_cbranch_scc1 L_go150
    s_waitcnt vmcnt(5)
    s_cmp_ge_u32 s101, 1
    s_cbranch_scc1 L_go150
    s_waitcnt vmcnt(4)
L_go150:
    buffer_load_dwordx4 v[184:187], v2, s[36:39], s66 offen offset:256 nt
    v_lshlrev_b32 v4, 16, v152
    v_and_b32 v5, s67, v152
    v_fmac_f32 v36, v77, v4
    v_fmac_f32 v37, v77, v5
    v_lshlrev_b32 v6, 16, v153
    v_and_b32 v7, s67, v153
    v_fmac_f32 v38, v77, v6
    v_fmac_f32 v39, v77, v7
    v_lshlrev_b32 v8, 16, v154
    v_and_b32 v9, s67, v154
    v_fmac_f32 v40, v77, v8
    v_fmac_f32 v41, v77, v9
    v_lshlrev_b32 v10, 16, v155
    v_and_b32 v11, s67, v155
    v_fmac_f32 v42, v77, v10
    v_fmac_f32 v43, v77, v11
    s_waitcnt vmcnt(7)
    s_cmp_ge_u32 s101, 3
    s_cbranch_scc1 L_go151
    s_waitcnt vmcnt(6)
    s_cmp_ge_u32 s101, 2
    s_cbranch_scc1 L_go151
    s_waitcnt vmcnt(5)
    s_cmp_ge_u32 s101, 1
    s_cbranch_scc1 L_go151
    s_waitcnt vmcnt(4)
L_go151:
    s_add_u32 s66, s79, 20
    s_and_b32 s66, s66, 31
    s_mul_i32 s66, s66, 98304
    s_add_u32 s66, s66, s65
    buffer_load_dwordx4 v[188:191], v2, s[36:39], s66 offen offset:0 nt
    v_lshlrev_b32 v4, 16, v156
    v_and_b32 v5, s67, v156
    v_fmac_f32 v44, v77, v4
    v_fmac_f32 v45, v77, v5
    v_lshlrev_b32 v6, 16, v157
    v_and_b32 v7, s67, v157
    v_fmac_f32 v46, v77, v6
    v_fmac_f32 v47, v77, v7
    v_lshlrev_b32 v8, 16, v158
    v_and_b32 v9, s67, v158
    v_fmac_f32 v48, v77, v8
    v_fmac_f32 v49, v77, v9
    v_lshlrev_b32 v10, 16, v159
    v_and_b32 v11, s67, v159
    v_fmac_f32 v50, v77, v10
    v_fmac_f32 v51, v77, v11
    s_waitcnt vmcnt(7)
    s_cmp_ge_u32 s101, 3
    s_cbranch_scc1 L_go152
    s_waitcnt vmcnt(6)
    s_cmp_ge_u32 s101, 2
    s_cbranch_scc1 L_go152
    s_waitcnt vmcnt(5)
    s_cmp_ge_u32 s101, 1
    s_cbranch_scc1 L_go152
    s_waitcnt vmcnt(4)
L_go152:
    buffer_load_dwordx4 v[192:195], v2, s[36:39], s66 offen offset:128 nt
    v_lshlrev_b32 v4, 16, v160
    v_and_b32 v5, s67, v160
    v_fmac_f32 v52, v77, v4
    v_fmac_f32 v53, v77, v5
    v_lshlrev_b32 v6, 16, v161
    v_and_b32 v7, s67, v161
    v_fmac_f32 v54, v77, v6
    v_fmac_f32 v55, v77, v7
    v_lshlrev_b32 v8, 16, v162
    v_and_b32 v9, s67, v162
    v_fmac_f32 v56, v77, v8
    v_fmac_f32 v57, v77, v9
    v_lshlrev_b32 v10, 16, v163
    v_and_b32 v11, s67, v163
    v_fmac_f32 v58, v77, v10
    v_fmac_f32 v59, v77, v11
    s_waitcnt vmcnt(7)
    s_cmp_ge_u32 s101, 3
    s_cbranch_scc1 L_go153
    s_waitcnt vmcnt(6)
    s_cmp_ge_u32 s101, 2
    s_cbranch_scc1 L_go153
    s_waitcnt vmcnt(5)
    s_cmp_ge_u32 s101, 1
    s_cbranch_scc1 L_go153
    s_waitcnt vmcnt(4)
L_go153:
    buffer_load_dwordx4 v[196:199], v2, s[36:39], s66 offen offset:256 nt
    v_lshlrev_b32 v4, 16, v164
    v_and_b32 v5, s67, v164
    v_fmac_f32 v36, v78, v4
    v_fmac_f32 v37, v78, v5
    v_lshlrev_b32 v6, 16, v165
    v_and_b32 v7, s67, v165
    v_fmac_f32 v38, v78, v6
    v_fmac_f32 v39, v78, v7
    v_lshlrev_b32 v8, 16, v166
    v_and_b32 v9, s67, v166
    v_fmac_f32 v40, v78, v8
    v_fmac_f32 v41, v78, v9
    v_lshlrev_b32 v10, 16, v167
    v_and_b32 v11, s67, v167
    v_fmac_f32 v42, v78, v10
    v_fmac_f32 v43, v78, v11
    s_waitcnt vmcnt(7)
    s_cmp_ge_u32 s101, 3
    s_cbranch_scc1 L_go154
    s_waitcnt vmcnt(6)
    s_cmp_ge_u32 s101, 2
    s_cbranch_scc1 L_go154
    s_waitcnt vmcnt(5)
    s_cmp_ge_u32 s101, 1
    s_cbranch_scc1 L_go154
    s_waitcnt vmcnt(4)
L_go154:
    s_add_u32 s66, s79, 21
    s_and_b32 s66, s66, 31
    s_mul_i32 s66, s66, 98304
    s_add_u32 s66, s66, s65
    buffer_load_dwordx4 v[200:203], v2, s[36:39], s66 offen offset:0 nt
    v_lshlrev_b32 v4, 16, v168
    v_and_b32 v5, s67, v168
    v_fmac_f32 v44, v78, v4
    v_fmac_f32 v45, v78, v5
    v_lshlrev_b32 v6, 16, v169
    v_and_b32 v7, s67, v169
    v_fmac_f32 v46, v78, v6
    v_fmac_f32 v47, v78, v7
    v_lshlrev_b32 v8, 16, v170
    v_and_b32 v9, s67, v170
    v_fmac_f32 v48, v78, v8
    v_fmac_f32 v49, v78, v9
    v_lshlrev_b32 v10, 16, v171
    v_and_b32 v11, s67, v171
    v_fmac_f32 v50, v78, v10
    v_fmac_f32 v51, v78, v11
    s_waitcnt lgkmcnt(0)
    s_cmp_eq_u32 s76, 0
    s_cbranch_scc1 L_fb4b
    s_mov_b32 s23, 0
    s_min_u32 s4, s4, s20
    s_sub_u32 s4, s22, s4
    s_add_u32 s23, s23, s4
    s_min_u32 s5, s5, s20
    s_sub_u32 s5, s22, s5
    s_add_u32 s23, s23, s5
    s_min_u32 s6, s6, s20
    s_sub_u32 s6, s22, s6
    s_add_u32 s23, s23, s6
    s_min_u32 s7, s7, s20
    s_sub_u32 s7, s22, s7
    s_add_u32 s23, s23, s7
    s_min_u32 s8, s8, s20
    s_sub_u32 s8, s22, s8
    s_add_u32 s23, s23, s8
    s_min_u32 s9, s9, s20
    s_sub_u32 s9, s22, s9
    s_add_u32 s23, s23, s9
    s_min_u32 s10, s10, s20
    s_sub_u32 s10, s22, s10
    s_add_u32 s23, s23, s10
    s_min_u32 s11, s11, s20
    s_sub_u32 s11, s22, s11
    s_add_u32 s23, s23, s11
    s_min_u32 s12, s12, s20
    s_sub_u32 s12, s22, s12
    s_add_u32 s23, s23, s12
    s_min_u32 s13, s13, s20
    s_sub_u32 s13, s22, s13
    s_add_u32 s23, s23, s13
    s_min_u32 s14, s14, s20
    s_sub_u32 s14, s22, s14
    s_add_u32 s23, s23, s14
    s_min_u32 s15, s15, s20
    s_sub_u32 s15, s22, s15
    s_add_u32 s23, s23, s15
    s_min_u32 s16, s16, s20
    s_sub_u32 s16, s22, s16
    s_add_u32 s23, s23, s16
    s_min_u32 s17, s17, s20
    s_sub_u32 s17, s22, s17
    s_add_u32 s23, s23, s17
    s_min_u32 s18, s18, s20
    s_sub_u32 s18, s22, s18
    s_add_u32 s23, s23, s18
    s_min_u32 s19, s19, s20
    s_sub_u32 s19, s22, s19
    s_add_u32 s23, s23, s19
    s_ashr_i32 s23, s23, 4
    s_mov_b32 s101, 0
    s_cmp_ge_i32 s23, -60
    s_cselect_b32 s101, 1, s101
    s_cmp_ge_i32 s23, 20
    s_cselect_b32 s101, 2, s101
    s_cmp_ge_i32 s23, 100
    s_cselect_b32 s101, 3, s101
L_fb4b:
    s_nop 2
    v_readfirstlane_b32 s76, v255
    s_waitcnt vmcnt(7)
    s_cmp_ge_u32 s101, 3
    s_cbranch_scc1 L_go155
    s_waitcnt vmcnt(6)
    s_cmp_ge_u32 s101, 2
    s_cbranch_scc1 L_go155
    s_waitcnt vmcnt(5)
    s_cmp_ge_u32 s101, 1
    s_cbranch_scc1 L_go155
    s_waitcnt vmcnt(4)
L_go155:
    buffer_load_dwordx4 v[204:207], v2, s[36:39], s66 offen offset:128 nt
    v_lshlrev_b32 v4, 16, v172
    v_and_b32 v5, s67, v172
    v_fmac_f32 v52, v78, v4
    v_fmac_f32 v53, v78, v5
    v_lshlrev_b32 v6, 16, v173
    v_and_b32 v7, s67, v173
    v_fmac_f32 v54, v78, v6
    v_fmac_f32 v55, v78, v7
    v_lshlrev_b32 v8, 16, v174
    v_and_b32 v9, s67, v174
    v_fmac_f32 v56, v78, v8
    v_fmac_f32 v57, v78, v9
    v_lshlrev_b32 v10, 16, v175
    v_and_b32 v11, s67, v175
    v_fmac_f32 v58, v78, v10
    v_fmac_f32 v59, v78, v11
    s_waitcnt vmcnt(7)
    s_cmp_ge_u32 s101, 3
    s_cbranch_scc1 L_go156
    s_waitcnt vmcnt(6)
    s_cmp_ge_u32 s101, 2
    s_cbranch_scc1 L_go156
    s_waitcnt vmcnt(5)
    s_cmp_ge_u32 s101, 1
    s_cbranch_scc1 L_go156
    s_waitcnt vmcnt(4)
L_go156:
    buffer_load_dwordx4 v[208:211], v2, s[36:39], s66 offen offset:256 nt
    v_lshlrev_b32 v4, 16, v176
    v_and_b32 v5, s67, v176
    v_fmac_f32 v36, v79, v4
    v_fmac_f32 v37, v79, v5
    v_lshlrev_b32 v6, 16, v177
    v_and_b32 v7, s67, v177
    v_fmac_f32 v38, v79, v6
    v_fmac_f32 v39, v79, v7
    v_lshlrev_b32 v8, 16, v178
    v_and_b32 v9, s67, v178
    v_fmac_f32 v40, v79, v8
    v_fmac_f32 v41, v79, v9
    v_lshlrev_b32 v10, 16, v179
    v_and_b32 v11, s67, v179
    v_fmac_f32 v42, v79, v10
    v_fmac_f32 v43, v79, v11
    s_waitcnt vmcnt(7)
    s_cmp_ge_u32 s101, 3
    s_cbranch_scc1 L_go157
    s_waitcnt vmcnt(6)
    s_cmp_ge_u32 s101, 2
    s_cbranch_scc1 L_go157
    s_waitcnt vmcnt(5)
    s_cmp_ge_u32 s101, 1
    s_cbranch_scc1 L_go157
    s_waitcnt vmcnt(4)
L_go157:
    s_add_u32 s66, s79, 22
    s_and_b32 s66, s66, 31
    s_mul_i32 s66, s66, 98304
    s_add_u32 s66, s66, s65
    buffer_load_dwordx4 v[212:215], v2, s[36:39], s66 offen offset:0 nt
    v_lshlrev_b32 v4, 16, v180
    v_and_b32 v5, s67, v180
    v_fmac_f32 v44, v79, v4
    v_fmac_f32 v45, v79, v5
    v_lshlrev_b32 v6, 16, v181
    v_and_b32 v7, s67, v181
    v_fmac_f32 v46, v79, v6
    v_fmac_f32 v47, v79, v7
    v_lshlrev_b32 v8, 16, v182
    v_and_b32 v9, s67, v182
    v_fmac_f32 v48, v79, v8
    v_fmac_f32 v49, v79, v9
    v_lshlrev_b32 v10, 16, v183
    v_and_b32 v11, s67, v183
    v_fmac_f32 v50, v79, v10
    v_fmac_f32 v51, v79, v11
    s_waitcnt vmcnt(7)
    s_cmp_ge_u32 s101, 3
    s_cbranch_scc1 L_go158
    s_waitcnt vmcnt(6)
    s_cmp_ge_u32 s101, 2
    s_cbranch_scc1 L_go158
    s_waitcnt vmcnt(5)
    s_cmp_ge_u32 s101, 1
    s_cbranch_scc1 L_go158
    s_waitcnt vmcnt(4)
L_go158:
    buffer_load_dwordx4 v[216:219], v2, s[36:39], s66 offen offset:128 nt
    v_lshlrev_b32 v4, 16, v184
    v_and_b32 v5, s67, v184
    v_fmac_f32 v52, v79, v4
    v_fmac_f32 v53, v79, v5
    v_lshlrev_b32 v6, 16, v185
    v_and_b32 v7, s67, v185
    v_fmac_f32 v54, v79, v6
    v_fmac_f32 v55, v79, v7
    v_lshlrev_b32 v8, 16, v186
    v_and_b32 v9, s67, v186
    v_fmac_f32 v56, v79, v8
    v_fmac_f32 v57, v79, v9
    v_lshlrev_b32 v10, 16, v187
    v_and_b32 v11, s67, v187
    v_fmac_f32 v58, v79, v10
    v_fmac_f32 v59, v79, v11
    s_waitcnt vmcnt(7)
    s_cmp_ge_u32 s101, 3
    s_cbranch_scc1 L_go159
    s_waitcnt vmcnt(6)
    s_cmp_ge_u32 s101, 2
    s_cbranch_scc1 L_go159
    s_waitcnt vmcnt(5)
    s_cmp_ge_u32 s101, 1
    s_cbranch_scc1 L_go159
    s_waitcnt vmcnt(4)
L_go159:
    buffer_load_dwordx4 v[220:223], v2, s[36:39], s66 offen offset:256 nt
    v_lshlrev_b32 v4, 16, v188
    v_and_b32 v5, s67, v188
    v_fmac_f32 v36, v80, v4
    v_fmac_f32 v37, v80, v5
    v_lshlrev_b32 v6, 16, v189
    v_and_b32 v7, s67, v189
    v_fmac_f32 v38, v80, v6
    v_fmac_f32 v39, v80, v7
    v_lshlrev_b32 v8, 16, v190
    v_and_b32 v9, s67, v190
    v_fmac_f32 v40, v80, v8
    v_fmac_f32 v41, v80, v9
    v_lshlrev_b32 v10, 16, v191
    v_and_b32 v11, s67, v191
    v_fmac_f32 v42, v80, v10
    v_fmac_f32 v43, v80, v11
    s_waitcnt vmcnt(7)
    s_cmp_ge_u32 s101, 3
    s_cbranch_scc1 L_go160
    s_waitcnt vmcnt(6)
    s_cmp_ge_u32 s101, 2
    s_cbranch_scc1 L_go160
    s_waitcnt vmcnt(5)
    s_cmp_ge_u32 s101, 1
    s_cbranch_scc1 L_go160
    s_waitcnt vmcnt(4)
L_go160:
    s_add_u32 s66, s79, 23
    s_and_b32 s66, s66, 31
    s_mul_i32 s66, s66, 98304
    s_add_u32 s66, s66, s65
    buffer_load_dwordx4 v[224:227], v2, s[36:39], s66 offen offset:0 nt
    v_lshlrev_b32 v4, 16, v192
    v_and_b32 v5, s67, v192
    v_fmac_f32 v44, v80, v4
    v_fmac_f32 v45, v80, v5
    v_lshlrev_b32 v6, 16, v193
    v_and_b32 v7, s67, v193
    v_fmac_f32 v46, v80, v6
    v_fmac_f32 v47, v80, v7
    v_lshlrev_b32 v8, 16, v194
    v_and_b32 v9, s67, v194
    v_fmac_f32 v48, v80, v8
    v_fmac_f32 v49, v80, v9
    v_lshlrev_b32 v10, 16, v195
    v_and_b32 v11, s67, v195
    v_fmac_f32 v50, v80, v10
    v_fmac_f32 v51, v80, v11
    s_waitcnt vmcnt(7)
    s_cmp_ge_u32 s101, 3
    s_cbranch_scc1 L_go161
    s_waitcnt vmcnt(6)
    s_cmp_ge_u32 s101, 2
    s_cbranch_scc1 L_go161
    s_waitcnt vmcnt(5)
    s_cmp_ge_u32 s101, 1
    s_cbranch_scc1 L_go161
    s_waitcnt vmcnt(4)
L_go161:
    buffer_load_dwordx4 v[228:231], v2, s[36:39], s66 offen offset:128 nt
    v_lshlrev_b32 v4, 16, v196
    v_and_b32 v5, s67, v196
    v_fmac_f32 v52, v80, v4
    v_fmac_f32 v53, v80, v5
    v_lshlrev_b32 v6, 16, v197
    v_and_b32 v7, s67, v197
    v_fmac_f32 v54, v80, v6
    v_fmac_f32 v55, v80, v7
    v_lshlrev_b32 v8, 16, v198
    v_and_b32 v9, s67, v198
    v_fmac_f32 v56, v80, v8
    v_fmac_f32 v57, v80, v9
    v_lshlrev_b32 v10, 16, v199
    v_and_b32 v11, s67, v199
    v_fmac_f32 v58, v80, v10
    v_fmac_f32 v59, v80, v11
    s_waitcnt vmcnt(7)
    s_cmp_ge_u32 s101, 3
    s_cbranch_scc1 L_go162
    s_waitcnt vmcnt(6)
    s_cmp_ge_u32 s101, 2
    s_cbranch_scc1 L_go162
    s_waitcnt vmcnt(5)
    s_cmp_ge_u32 s101, 1
    s_cbranch_scc1 L_go162
    s_waitcnt vmcnt(4)
L_go162:
    buffer_load_dwordx4 v[232:235], v2, s[36:39], s66 offen offset:256 nt
    v_lshlrev_b32 v4, 16, v200
    v_and_b32 v5, s67, v200
    v_fmac_f32 v36, v81, v4
    v_fmac_f32 v37, v81, v5
    v_lshlrev_b32 v6, 16, v201
    v_and_b32 v7, s67, v201
    v_fmac_f32 v38, v81, v6
    v_fmac_f32 v39, v81, v7
    v_lshlrev_b32 v8, 16, v202
    v_and_b32 v9, s67, v202
    v_fmac_f32 v40, v81, v8
    v_fmac_f32 v41, v81, v9
    v_lshlrev_b32 v10, 16, v203
    v_and_b32 v11, s67, v203
    v_fmac_f32 v42, v81, v10
    v_fmac_f32 v43, v81, v11
    s_waitcnt vmcnt(7)
    s_cmp_ge_u32 s101, 3
    s_cbranch_scc1 L_go163
    s_waitcnt vmcnt(6)
    s_cmp_ge_u32 s101, 2
    s_cbranch_scc1 L_go163
    s_waitcnt vmcnt(5)
    s_cmp_ge_u32 s101, 1
    s_cbranch_scc1 L_go163
    s_waitcnt vmcnt(4)
L_go163:
    s_add_u32 s66, s79, 24
    s_and_b32 s66, s66, 31
    s_mul_i32 s66, s66, 98304
    s_add_u32 s66, s66, s65
    buffer_load_dwordx4 v[236:239], v2, s[36:39], s66 offen offset:0 nt
    v_lshlrev_b32 v4, 16, v204
    v_and_b32 v5, s67, v204
    v_fmac_f32 v44, v81, v4
    v_fmac_f32 v45, v81, v5
    v_lshlrev_b32 v6, 16, v205
    v_and_b32 v7, s67, v205
    v_fmac_f32 v46, v81, v6
    v_fmac_f32 v47, v81, v7
    v_lshlrev_b32 v8, 16, v206
    v_and_b32 v9, s67, v206
    v_fmac_f32 v48, v81, v8
    v_fmac_f32 v49, v81, v9
    v_lshlrev_b32 v10, 16, v207
    v_and_b32 v11, s67, v207
    v_fmac_f32 v50, v81, v10
    v_fmac_f32 v51, v81, v11
    s_mov_b32 s22, s20
    s_memrealtime s[20:21]
    s_waitcnt vmcnt(7)
    s_cmp_ge_u32 s101, 3
    s_cbranch_scc1 L_go164
    s_waitcnt vmcnt(6)
    s_cmp_ge_u32 s101, 2
    s_cbranch_scc1 L_go164
    s_waitcnt vmcnt(5)
    s_cmp_ge_u32 s101, 1
    s_cbranch_scc1 L_go164
    s_waitcnt vmcnt(4)
L_go164:
    buffer_load_dwordx4 v[240:243], v2, s[36:39], s66 offen offset:128 nt
    v_lshlrev_b32 v4, 16, v208
    v_and_b32 v5, s67, v208
    v_fmac_f32 v52, v81, v4
    v_fmac_f32 v53, v81, v5
    v_lshlrev_b32 v6, 16, v209
    v_and_b32 v7, s67, v209
    v_fmac_f32 v54, v81, v6
    v_fmac_f32 v55, v81, v7
    v_lshlrev_b32 v8, 16, v210
    v_and_b32 v9, s67, v210
    v_fmac_f32 v56, v81, v8
    v_fmac_f32 v57, v81, v9
    v_lshlrev_b32 v10, 16, v211
    v_and_b32 v11, s67, v211
    v_fmac_f32 v58, v81, v10
    v_fmac_f32 v59, v81, v11
    s_waitcnt lgkmcnt(0)
    v_mov_b32 v254, s20
    s_mov_b32 s70, 983680
    buffer_store_dword v254, v253, s[56:59], s70 offen sc1
    s_cmp_eq_u32 s76, 0
    s_cbranch_scc1 L_fb5a
    s_load_dwordx16 s[4:19], s[24:25], 983552
L_fb5a:
    ds_read_b32 v255, v3 offset:8
    s_waitcnt vmcnt(7)
    s_cmp_ge_u32 s101, 3
    s_cbranch_scc1 L_go165
    s_waitcnt vmcnt(6)
    s_cmp_ge_u32 s101, 2
    s_cbranch_scc1 L_go165
    s_waitcnt vmcnt(5)
    s_cmp_ge_u32 s101, 1
    s_cbranch_scc1 L_go165
    s_waitcnt vmcnt(4)
L_go165:
    buffer_load_dwordx4 v[244:247], v2, s[36:39], s66 offen offset:256 nt
    v_lshlrev_b32 v4, 16, v212
    v_and_b32 v5, s67, v212
    v_fmac_f32 v36, v82, v4
    v_fmac_f32 v37, v82, v5
    v_lshlrev_b32 v6, 16, v213
    v_and_b32 v7, s67, v213
    v_fmac_f32 v38, v82, v6
    v_fmac_f32 v39, v82, v7
    v_lshlrev_b32 v8, 16, v214
    v_and_b32 v9, s67, v214
    v_fmac_f32 v40, v82, v8
    v_fmac_f32 v41, v82, v9
    v_lshlrev_b32 v10, 16, v215
    v_and_b32 v11, s67, v215
    v_fmac_f32 v42, v82, v10
    v_fmac_f32 v43, v82, v11
    s_waitcnt vmcnt(7)
    s_cmp_ge_u32 s101, 3
    s_cbranch_scc1 L_go166
    s_waitcnt vmcnt(6)
    s_cmp_ge_u32 s101, 2
    s_cbranch_scc1 L_go166
    s_waitcnt vmcnt(5)
    s_cmp_ge_u32 s101, 1
    s_cbranch_scc1 L_go166
    s_waitcnt vmcnt(4)
L_go166:
    s_add_u32 s66, s79, 25
    s_and_b32 s66, s66, 31
    s_mul_i32 s66, s66, 98304
    s_add_u32 s66, s66, s65
    buffer_load_dwordx4 v[248:251], v2, s[36:39], s66 offen offset:0 nt
    v_lshlrev_b32 v4, 16, v216
    v_and_b32 v5, s67, v216
    v_fmac_f32 v44, v82, v4
    v_fmac_f32 v45, v82, v5
    v_lshlrev_b32 v6, 16, v217
    v_and_b32 v7, s67, v217
    v_fmac_f32 v46, v82, v6
    v_fmac_f32 v47, v82, v7
    v_lshlrev_b32 v8, 16, v218
    v_and_b32 v9, s67, v218
    v_fmac_f32 v48, v82, v8
    v_fmac_f32 v49, v82, v9
    v_lshlrev_b32 v10, 16, v219
    v_and_b32 v11, s67, v219
    v_fmac_f32 v50, v82, v10
    v_fmac_f32 v51, v82, v11
    s_waitcnt vmcnt(7)
    s_cmp_ge_u32 s101, 3
    s_cbranch_scc1 L_go167
    s_waitcnt vmcnt(6)
    s_cmp_ge_u32 s101, 2
    s_cbranch_scc1 L_go167
    s_waitcnt vmcnt(5)
    s_cmp_ge_u32 s101, 1
    s_cbranch_scc1 L_go167
    s_waitcnt vmcnt(4)
L_go167:
    buffer_load_dwordx4 v[92:95], v2, s[36:39], s66 offen offset:128 nt
    v_lshlrev_b32 v4, 16, v220
    v_and_b32 v5, s67, v220
    v_fmac_f32 v52, v82, v4
    v_fmac_f32 v53, v82, v5
    v_lshlrev_b32 v6, 16, v221
    v_and_b32 v7, s67, v221
    v_fmac_f32 v54, v82, v6
    v_fmac_f32 v55, v82, v7
    v_lshlrev_b32 v8, 16, v222
    v_and_b32 v9, s67, v222
    v_fmac_f32 v56, v82, v8
    v_fmac_f32 v57, v82, v9
    v_lshlrev_b32 v10, 16, v223
    v_and_b32 v11, s67, v223
    v_fmac_f32 v58, v82, v10
    v_fmac_f32 v59, v82, v11
    s_waitcnt vmcnt(7)
    s_cmp_ge_u32 s101, 3
    s_cbranch_scc1 L_go168
    s_waitcnt vmcnt(6)
    s_cmp_ge_u32 s101, 2
    s_cbranch_scc1 L_go168
    s_waitcnt vmcnt(5)
    s_cmp_ge_u32 s101, 1
    s_cbranch_scc1 L_go168
    s_waitcnt vmcnt(4)
L_go168:
    buffer_load_dwordx4 v[96:99], v2, s[36:39], s66 offen offset:256 nt
    v_lshlrev_b32 v4, 16, v224
    v_and_b32 v5, s67, v224
    v_fmac_f32 v36, v83, v4
    v_fmac_f32 v37, v83, v5
    v_lshlrev_b32 v6, 16, v225
    v_and_b32 v7, s67, v225
    v_fmac_f32 v38, v83, v6
    v_fmac_f32 v39, v83, v7
    v_lshlrev_b32 v8, 16, v226
    v_and_b32 v9, s67, v226
    v_fmac_f32 v40, v83, v8
    v_fmac_f32 v41, v83, v9
    v_lshlrev_b32 v10, 16, v227
    v_and_b32 v11, s67, v227
    v_fmac_f32 v42, v83, v10
    v_fmac_f32 v43, v83, v11
    s_waitcnt vmcnt(7)
    s_cmp_ge_u32 s101, 3
    s_cbranch_scc1 L_go169
    s_waitcnt vmcnt(6)
    s_cmp_ge_u32 s101, 2
    s_cbranch_scc1 L_go169
    s_waitcnt vmcnt(5)
    s_cmp_ge_u32 s101, 1
    s_cbranch_scc1 L_go169
    s_waitcnt vmcnt(4)
L_go169:
    s_add_u32 s66, s79, 26
    s_and_b32 s66, s66, 31
    s_mul_i32 s66, s66, 98304
    s_add_u32 s66, s66, s65
    buffer_load_dwordx4 v[100:103], v2, s[36:39], s66 offen offset:0 nt
    v_lshlrev_b32 v4, 16, v228
    v_and_b32 v5, s67, v228
    v_fmac_f32 v44, v83, v4
    v_fmac_f32 v45, v83, v5
    v_lshlrev_b32 v6, 16, v229
    v_and_b32 v7, s67, v229
    v_fmac_f32 v46, v83, v6
    v_fmac_f32 v47, v83, v7
    v_lshlrev_b32 v8, 16, v230
    v_and_b32 v9, s67, v230
    v_fmac_f32 v48, v83, v8
    v_fmac_f32 v49, v83, v9
    v_lshlrev_b32 v10, 16, v231
    v_and_b32 v11, s67, v231
    v_fmac_f32 v50, v83, v10
    v_fmac_f32 v51, v83, v11
    s_waitcnt vmcnt(7)
    s_cmp_ge_u32 s101, 3
    s_cbranch_scc1 L_go170
    s_waitcnt vmcnt(6)
    s_cmp_ge_u32 s101, 2
    s_cbranch_scc1 L_go170
    s_waitcnt vmcnt(5)
    s_cmp_ge_u32 s101, 1
    s_cbranch_scc1 L_go170
    s_waitcnt vmcnt(4)
L_go170:
    buffer_load_dwordx4 v[104:107], v2, s[36:39], s66 offen offset:128 nt
    v_lshlrev_b32 v4, 16, v232
    v_and_b32 v5, s67, v232
    v_fmac_f32 v52, v83, v4
    v_fmac_f32 v53, v83, v5
    v_lshlrev_b32 v6, 16, v233
    v_and_b32 v7, s67, v233
    v_fmac_f32 v54, v83, v6
    v_fmac_f32 v55, v83, v7
    v_lshlrev_b32 v8, 16, v234
    v_and_b32 v9, s67, v234
    v_fmac_f32 v56, v83, v8
    v_fmac_f32 v57, v83, v9
    v_lshlrev_b32 v10, 16, v235
    v_and_b32 v11, s67, v235
    v_fmac_f32 v58, v83, v10
    v_fmac_f32 v59, v83, v11
    s_waitcnt vmcnt(7)
    s_cmp_ge_u32 s101, 3
    s_cbranch_scc1 L_go171
    s_waitcnt vmcnt(6)
    s_cmp_ge_u32 s101, 2
    s_cbranch_scc1 L_go171
    s_waitcnt vmcnt(5)
    s_cmp_ge_u32 s101, 1
    s_cbranch_scc1 L_go171
    s_waitcnt vmcnt(4)
L_go171:
    buffer_load_dwordx4 v[108:111], v2, s[36:39], s66 offen offset:256 nt
    v_lshlrev_b32 v4, 16, v236
    v_and_b32 v5, s67, v236
    v_fmac_f32 v36, v84, v4
    v_fmac_f32 v37, v84, v5
    v_lshlrev_b32 v6, 16, v237
    v_and_b32 v7, s67, v237
    v_fmac_f32 v38, v84, v6
    v_fmac_f32 v39, v84, v7
    v_lshlrev_b32 v8, 16, v238
    v_and_b32 v9, s67, v238
    v_fmac_f32 v40, v84, v8
    v_fmac_f32 v41, v84, v9
    v_lshlrev_b32 v10, 16, v239
    v_and_b32 v11, s67, v239
    v_fmac_f32 v42, v84, v10
    v_fmac_f32 v43, v84, v11
    s_waitcnt vmcnt(7)
    s_cmp_ge_u32 s101, 3
    s_cbranch_scc1 L_go172
    s_waitcnt vmcnt(6)
    s_cmp_ge_u32 s101, 2
    s_cbranch_scc1 L_go172
    s_waitcnt vmcnt(5)
    s_cmp_ge_u32 s101, 1
    s_cbranch_scc1 L_go172
    s_waitcnt vmcnt(4)
L_go172:
    s_add_u32 s66, s79, 27
    s_and_b32 s66, s66, 31
    s_mul_i32 s66, s66, 98304
    s_add_u32 s66, s66, s65
    buffer_load_dwordx4 v[112:115], v2, s[36:39], s66 offen offset:0 nt
    v_lshlrev_b32 v4, 16, v240
    v_and_b32 v5, s67, v240
    v_fmac_f32 v44, v84, v4
    v_fmac_f32 v45, v84, v5
    v_lshlrev_b32 v6, 16, v241
    v_and_b32 v7, s67, v241
    v_fmac_f32 v46, v84, v6
    v_fmac_f32 v47, v84, v7
    v_lshlrev_b32 v8, 16, v242
    v_and_b32 v9, s67, v242
    v_fmac_f32 v48, v84, v8
    v_fmac_f32 v49, v84, v9
    v_lshlrev_b32 v10, 16, v243
    v_and_b32 v11, s67, v243
    v_fmac_f32 v50, v84, v10
    v_fmac_f32 v51, v84, v11
    s_waitcnt lgkmcnt(0)
    s_cmp_eq_u32 s76, 0
    s_cbranch_scc1 L_fb5b
    s_mov_b32 s23, 0
    s_min_u32 s4, s4, s20
    s_sub_u32 s4, s22, s4
    s_add_u32 s23, s23, s4
    s_min_u32 s5, s5, s20
    s_sub_u32 s5, s22, s5
    s_add_u32 s23, s23, s5
    s_min_u32 s6, s6, s20
    s_sub_u32 s6, s22, s6
    s_add_u32 s23, s23, s6
    s_min_u32 s7, s7, s20
    s_sub_u32 s7, s22, s7
    s_add_u32 s23, s23, s7
    s_min_u32 s8, s8, s20
    s_sub_u32 s8, s22, s8
    s_add_u32 s23, s23, s8
    s_min_u32 s9, s9, s20
    s_sub_u32 s9, s22, s9
    s_add_u32 s23, s23, s9
    s_min_u32 s10, s10, s20
    s_sub_u32 s10, s22, s10
    s_add_u32 s23, s23, s10
    s_min_u32 s11, s11, s20
    s_sub_u32 s11, s22, s11
    s_add_u32 s23, s23, s11
    s_min_u32 s12, s12, s20
    s_sub_u32 s12, s22, s12
    s_add_u32 s23, s23, s12
    s_min_u32 s13, s13, s20
    s_sub_u32 s13, s22, s13
    s_add_u32 s23, s23, s13
    s_min_u32 s14, s14, s20
    s_sub_u32 s14, s22, s14
    s_add_u32 s23, s23, s14
    s_min_u32 s15, s15, s20
    s_sub_u32 s15, s22, s15
    s_add_u32 s23, s23, s15
    s_min_u32 s16, s16, s20
    s_sub_u32 s16, s22, s16
    s_add_u32 s23, s23, s16
    s_min_u32 s17, s17, s20
    s_sub_u32 s17, s22, s17
    s_add_u32 s23, s23, s17
    s_min_u32 s18, s18, s20
    s_sub_u32 s18, s22, s18
    s_add_u32 s23, s23, s18
    s_min_u32 s19, s19, s20
    s_sub_u32 s19, s22, s19
    s_add_u32 s23, s23, s19
    s_ashr_i32 s23, s23, 4
    s_mov_b32 s101, 0
    s_cmp_ge_i32 s23, -60
    s_cselect_b32 s101, 1, s101
    s_cmp_ge_i32 s23, 20
    s_cselect_b32 s101, 2, s101
    s_cmp_ge_i32 s23, 100
    s_cselect_b32 s101, 3, s101
L_fb5b:
    s_nop 2
    v_readfirstlane_b32 s76, v255
    s_waitcnt vmcnt(7)
    s_cmp_ge_u32 s101, 3
    s_cbranch_scc1 L_go173
    s_waitcnt vmcnt(6)
    s_cmp_ge_u32 s101, 2
    s_cbranch_scc1 L_go173
    s_waitcnt vmcnt(5)
    s_cmp_ge_u32 s101, 1
    s_cbranch_scc1 L_go173
    s_waitcnt vmcnt(4)
L_go173:
    buffer_load_dwordx4 v[116:119], v2, s[36:39], s66 offen offset:128 nt
    v_lshlrev_b32 v4, 16, v244
    v_and_b32 v5, s67, v244
    v_fmac_f32 v52, v84, v4
    v_fmac_f32 v53, v84, v5
    v_lshlrev_b32 v6, 16, v245
    v_and_b32 v7, s67, v245
    v_fmac_f32 v54, v84, v6
    v_fmac_f32 v55, v84, v7
    v_lshlrev_b32 v8, 16, v246
    v_and_b32 v9, s67, v246
    v_fmac_f32 v56, v84, v8
    v_fmac_f32 v57, v84, v9
    v_lshlrev_b32 v10, 16, v247
    v_and_b32 v11, s67, v247
    v_fmac_f32 v58, v84, v10
    v_fmac_f32 v59, v84, v11
    s_waitcnt vmcnt(7)
    s_cmp_ge_u32 s101, 3
    s_cbranch_scc1 L_go174
    s_waitcnt vmcnt(6)
    s_cmp_ge_u32 s101, 2
    s_cbranch_scc1 L_go174
    s_waitcnt vmcnt(5)
    s_cmp_ge_u32 s101, 1
    s_cbranch_scc1 L_go174
    s_waitcnt vmcnt(4)
L_go174:
    buffer_load_dwordx4 v[120:123], v2, s[36:39], s66 offen offset:256 nt
    v_lshlrev_b32 v4, 16, v248
    v_and_b32 v5, s67, v248
    v_fmac_f32 v36, v85, v4
    v_fmac_f32 v37, v85, v5
    v_lshlrev_b32 v6, 16, v249
    v_and_b32 v7, s67, v249
    v_fmac_f32 v38, v85, v6
    v_fmac_f32 v39, v85, v7
    v_lshlrev_b32 v8, 16, v250
    v_and_b32 v9, s67, v250
    v_fmac_f32 v40, v85, v8
    v_fmac_f32 v41, v85, v9
    v_lshlrev_b32 v10, 16, v251
    v_and_b32 v11, s67, v251
    v_fmac_f32 v42, v85, v10
    v_fmac_f32 v43, v85, v11
    s_waitcnt vmcnt(7)
    s_cmp_ge_u32 s101, 3
    s_cbranch_scc1 L_go175
    s_waitcnt vmcnt(6)
    s_cmp_ge_u32 s101, 2
    s_cbranch_scc1 L_go175
    s_waitcnt vmcnt(5)
    s_cmp_ge_u32 s101, 1
    s_cbranch_scc1 L_go175
    s_waitcnt vmcnt(4)
L_go175:
    s_add_u32 s66, s79, 28
    s_and_b32 s66, s66, 31
    s_mul_i32 s66, s66, 98304
    s_add_u32 s66, s66, s65
    buffer_load_dwordx4 v[124:127], v2, s[36:39], s66 offen offset:0 nt
    v_lshlrev_b32 v4, 16, v92
    v_and_b32 v5, s67, v92
    v_fmac_f32 v44, v85, v4
    v_fmac_f32 v45, v85, v5
    v_lshlrev_b32 v6, 16, v93
    v_and_b32 v7, s67, v93
    v_fmac_f32 v46, v85, v6
    v_fmac_f32 v47, v85, v7
    v_lshlrev_b32 v8, 16, v94
    v_and_b32 v9, s67, v94
    v_fmac_f32 v48, v85, v8
    v_fmac_f32 v49, v85, v9
    v_lshlrev_b32 v10, 16, v95
    v_and_b32 v11, s67, v95
    v_fmac_f32 v50, v85, v10
    v_fmac_f32 v51, v85, v11
    s_waitcnt vmcnt(7)
    s_cmp_ge_u32 s101, 3
    s_cbranch_scc1 L_go176
    s_waitcnt vmcnt(6)
    s_cmp_ge_u32 s101, 2
    s_cbranch_scc1 L_go176
    s_waitcnt vmcnt(5)
    s_cmp_ge_u32 s101, 1
    s_cbranch_scc1 L_go176
    s_waitcnt vmcnt(4)
L_go176:
    buffer_load_dwordx4 v[128:131], v2, s[36:39], s66 offen offset:128 nt
    v_lshlrev_b32 v4, 16, v96
    v_and_b32 v5, s67, v96
    v_fmac_f32 v52, v85, v4
    v_fmac_f32 v53, v85, v5
    v_lshlrev_b32 v6, 16, v97
    v_and_b32 v7, s67, v97
    v_fmac_f32 v54, v85, v6
    v_fmac_f32 v55, v85, v7
    v_lshlrev_b32 v8, 16, v98
    v_and_b32 v9, s67, v98
    v_fmac_f32 v56, v85, v8
    v_fmac_f32 v57, v85, v9
    v_lshlrev_b32 v10, 16, v99
    v_and_b32 v11, s67, v99
    v_fmac_f32 v58, v85, v10
    v_fmac_f32 v59, v85, v11
    s_waitcnt vmcnt(7)
    s_cmp_ge_u32 s101, 3
    s_cbranch_scc1 L_go177
    s_waitcnt vmcnt(6)
    s_cmp_ge_u32 s101, 2
    s_cbranch_scc1 L_go177
    s_waitcnt vmcnt(5)
    s_cmp_ge_u32 s101, 1
    s_cbranch_scc1 L_go177
    s_waitcnt vmcnt(4)
L_go177:
    buffer_load_dwordx4 v[132:135], v2, s[36:39], s66 offen offset:256 nt
    v_lshlrev_b32 v4, 16, v100
    v_and_b32 v5, s67, v100
    v_fmac_f32 v36, v86, v4
    v_fmac_f32 v37, v86, v5
    v_lshlrev_b32 v6, 16, v101
    v_and_b32 v7, s67, v101
    v_fmac_f32 v38, v86, v6
    v_fmac_f32 v39, v86, v7
    v_lshlrev_b32 v8, 16, v102
    v_and_b32 v9, s67, v102
    v_fmac_f32 v40, v86, v8
    v_fmac_f32 v41, v86, v9
    v_lshlrev_b32 v10, 16, v103
    v_and_b32 v11, s67, v103
    v_fmac_f32 v42, v86, v10
    v_fmac_f32 v43, v86, v11
    s_waitcnt vmcnt(7)
    s_cmp_ge_u32 s101, 3
    s_cbranch_scc1 L_go178
    s_waitcnt vmcnt(6)
    s_cmp_ge_u32 s101, 2
    s_cbranch_scc1 L_go178
    s_waitcnt vmcnt(5)
    s_cmp_ge_u32 s101, 1
    s_cbranch_scc1 L_go178
    s_waitcnt vmcnt(4)
L_go178:
    s_add_u32 s66, s79, 29
    s_and_b32 s66, s66, 31
    s_mul_i32 s66, s66, 98304
    s_add_u32 s66, s66, s65
    buffer_load_dwordx4 v[136:139], v2, s[36:39], s66 offen offset:0 nt
    v_lshlrev_b32 v4, 16, v104
    v_and_b32 v5, s67, v104
    v_fmac_f32 v44, v86, v4
    v_fmac_f32 v45, v86, v5
    v_lshlrev_b32 v6, 16, v105
    v_and_b32 v7, s67, v105
    v_fmac_f32 v46, v86, v6
    v_fmac_f32 v47, v86, v7
    v_lshlrev_b32 v8, 16, v106
    v_and_b32 v9, s67, v106
    v_fmac_f32 v48, v86, v8
    v_fmac_f32 v49, v86, v9
    v_lshlrev_b32 v10, 16, v107
    v_and_b32 v11, s67, v107
    v_fmac_f32 v50, v86, v10
    v_fmac_f32 v51, v86, v11
    s_waitcnt vmcnt(7)
    s_cmp_ge_u32 s101, 3
    s_cbranch_scc1 L_go179
    s_waitcnt vmcnt(6)
    s_cmp_ge_u32 s101, 2
    s_cbranch_scc1 L_go179
    s_waitcnt vmcnt(5)
    s_cmp_ge_u32 s101, 1
    s_cbranch_scc1 L_go179
    s_waitcnt vmcnt(4)
L_go179:
    buffer_load_dwordx4 v[140:143], v2, s[36:39], s66 offen offset:128 nt
    v_lshlrev_b32 v4, 16, v108
    v_and_b32 v5, s67, v108
    v_fmac_f32 v52, v86, v4
    v_fmac_f32 v53, v86, v5
    v_lshlrev_b32 v6, 16, v109
    v_and_b32 v7, s67, v109
    v_fmac_f32 v54, v86, v6
    v_fmac_f32 v55, v86, v7
    v_lshlrev_b32 v8, 16, v110
    v_and_b32 v9, s67, v110
    v_fmac_f32 v56, v86, v8
    v_fmac_f32 v57, v86, v9
    v_lshlrev_b32 v10, 16, v111
    v_and_b32 v11, s67, v111
    v_fmac_f32 v58, v86, v10
    v_fmac_f32 v59, v86, v11
    s_waitcnt vmcnt(7)
    s_cmp_ge_u32 s101, 3
    s_cbranch_scc1 L_go180
    s_waitcnt vmcnt(6)
    s_cmp_ge_u32 s101, 2
    s_cbranch_scc1 L_go180
    s_waitcnt vmcnt(5)
    s_cmp_ge_u32 s101, 1
    s_cbranch_scc1 L_go180
    s_waitcnt vmcnt(4)
L_go180:
    buffer_load_dwordx4 v[144:147], v2, s[36:39], s66 offen offset:256 nt
    v_lshlrev_b32 v4, 16, v112
    v_and_b32 v5, s67, v112
    v_fmac_f32 v36, v87, v4
    v_fmac_f32 v37, v87, v5
    v_lshlrev_b32 v6, 16, v113
    v_and_b32 v7, s67, v113
    v_fmac_f32 v38, v87, v6
    v_fmac_f32 v39, v87, v7
    v_lshlrev_b32 v8, 16, v114
    v_and_b32 v9, s67, v114
    v_fmac_f32 v40, v87, v8
    v_fmac_f32 v41, v87, v9
    v_lshlrev_b32 v10, 16, v115
    v_and_b32 v11, s67, v115
    v_fmac_f32 v42, v87, v10
    v_fmac_f32 v43, v87, v11
    s_waitcnt vmcnt(7)
    s_cmp_ge_u32 s101, 3
    s_cbranch_scc1 L_go181
    s_waitcnt vmcnt(6)
    s_cmp_ge_u32 s101, 2
    s_cbranch_scc1 L_go181
    s_waitcnt vmcnt(5)
    s_cmp_ge_u32 s101, 1
    s_cbranch_scc1 L_go181
    s_waitcnt vmcnt(4)
L_go181:
    s_add_u32 s66, s79, 30
    s_and_b32 s66, s66, 31
    s_mul_i32 s66, s66, 98304
    s_add_u32 s66, s66, s65
    buffer_load_dwordx4 v[148:151], v2, s[36:39], s66 offen offset:0 nt
    v_lshlrev_b32 v4, 16, v116
    v_and_b32 v5, s67, v116
    v_fmac_f32 v44, v87, v4
    v_fmac_f32 v45, v87, v5
    v_lshlrev_b32 v6, 16, v117
    v_and_b32 v7, s67, v117
    v_fmac_f32 v46, v87, v6
    v_fmac_f32 v47, v87, v7
    v_lshlrev_b32 v8, 16, v118
    v_and_b32 v9, s67, v118
    v_fmac_f32 v48, v87, v8
    v_fmac_f32 v49, v87, v9
    v_lshlrev_b32 v10, 16, v119
    v_and_b32 v11, s67, v119
    v_fmac_f32 v50, v87, v10
    v_fmac_f32 v51, v87, v11
    s_mov_b32 s22, s20
    s_memrealtime s[20:21]
    s_waitcnt vmcnt(7)
    s_cmp_ge_u32 s101, 3
    s_cbranch_scc1 L_go182
    s_waitcnt vmcnt(6)
    s_cmp_ge_u32 s101, 2
    s_cbranch_scc1 L_go182
    s_waitcnt vmcnt(5)
    s_cmp_ge_u32 s101, 1
    s_cbranch_scc1 L_go182
    s_waitcnt vmcnt(4)
L_go182:
    buffer_load_dwordx4 v[152:155], v2, s[36:39], s66 offen offset:128 nt
    v_lshlrev_b32 v4, 16, v120
    v_and_b32 v5, s67, v120
    v_fmac_f32 v52, v87, v4
    v_fmac_f32 v53, v87, v5
    v_lshlrev_b32 v6, 16, v121
    v_and_b32 v7, s67, v121
    v_fmac_f32 v54, v87, v6
    v_fmac_f32 v55, v87, v7
    v_lshlrev_b32 v8, 16, v122
    v_and_b32 v9, s67, v122
    v_fmac_f32 v56, v87, v8
    v_fmac_f32 v57, v87, v9
    v_lshlrev_b32 v10, 16, v123
    v_and_b32 v11, s67, v123
    v_fmac_f32 v58, v87, v10
    v_fmac_f32 v59, v87, v11
    s_waitcnt lgkmcnt(0)
    v_mov_b32 v254, s20
    s_mov_b32 s70, 983808
    buffer_store_dword v254, v253, s[56:59], s70 offen sc1
    s_cmp_eq_u32 s76, 0
    s_cbranch_scc1 L_fb6a
    s_load_dwordx16 s[4:19], s[24:25], 983680
L_fb6a:
    ds_read_b32 v255, v3 offset:8
    s_waitcnt vmcnt(7)
    s_cmp_ge_u32 s101, 3
    s_cbranch_scc1 L_go183
    s_waitcnt vmcnt(6)
    s_cmp_ge_u32 s101, 2
    s_cbranch_scc1 L_go183
    s_waitcnt vmcnt(5)
    s_cmp_ge_u32 s101, 1
    s_cbranch_scc1 L_go183
    s_waitcnt vmcnt(4)
L_go183:
    buffer_load_dwordx4 v[156:159], v2, s[36:39], s66 offen offset:256 nt
    v_lshlrev_b32 v4, 16, v124
    v_and_b32 v5, s67, v124
    v_fmac_f32 v36, v88, v4
    v_fmac_f32 v37, v88, v5
    v_lshlrev_b32 v6, 16, v125
    v_and_b32 v7, s67, v125
    v_fmac_f32 v38, v88, v6
    v_fmac_f32 v39, v88, v7
    v_lshlrev_b32 v8, 16, v126
    v_and_b32 v9, s67, v126
    v_fmac_f32 v40, v88, v8
    v_fmac_f32 v41, v88, v9
    v_lshlrev_b32 v10, 16, v127
    v_and_b32 v11, s67, v127
    v_fmac_f32 v42, v88, v10
    v_fmac_f32 v43, v88, v11
    s_waitcnt vmcnt(7)
    s_cmp_ge_u32 s101, 3
    s_cbranch_scc1 L_go184
    s_waitcnt vmcnt(6)
    s_cmp_ge_u32 s101, 2
    s_cbranch_scc1 L_go184
    s_waitcnt vmcnt(5)
    s_cmp_ge_u32 s101, 1
    s_cbranch_scc1 L_go184
    s_waitcnt vmcnt(4)
L_go184:
    s_add_u32 s66, s79, 31
    s_and_b32 s66, s66, 31
    s_mul_i32 s66, s66, 98304
    s_add_u32 s66, s66, s65
    buffer_load_dwordx4 v[160:163], v2, s[36:39], s66 offen offset:0 nt
    v_lshlrev_b32 v4, 16, v128
    v_and_b32 v5, s67, v128
    v_fmac_f32 v44, v88, v4
    v_fmac_f32 v45, v88, v5
    v_lshlrev_b32 v6, 16, v129
    v_and_b32 v7, s67, v129
    v_fmac_f32 v46, v88, v6
    v_fmac_f32 v47, v88, v7
    v_lshlrev_b32 v8, 16, v130
    v_and_b32 v9, s67, v130
    v_fmac_f32 v48, v88, v8
    v_fmac_f32 v49, v88, v9
    v_lshlrev_b32 v10, 16, v131
    v_and_b32 v11, s67, v131
    v_fmac_f32 v50, v88, v10
    v_fmac_f32 v51, v88, v11
    s_waitcnt vmcnt(7)
    s_cmp_ge_u32 s101, 3
    s_cbranch_scc1 L_go185
    s_waitcnt vmcnt(6)
    s_cmp_ge_u32 s101, 2
    s_cbranch_scc1 L_go185
    s_waitcnt vmcnt(5)
    s_cmp_ge_u32 s101, 1
    s_cbranch_scc1 L_go185
    s_waitcnt vmcnt(4)
L_go185:
    buffer_load_dwordx4 v[164:167], v2, s[36:39], s66 offen offset:128 nt
    v_lshlrev_b32 v4, 16, v132
    v_and_b32 v5, s67, v132
    v_fmac_f32 v52, v88, v4
    v_fmac_f32 v53, v88, v5
    v_lshlrev_b32 v6, 16, v133
    v_and_b32 v7, s67, v133
    v_fmac_f32 v54, v88, v6
    v_fmac_f32 v55, v88, v7
    v_lshlrev_b32 v8, 16, v134
    v_and_b32 v9, s67, v134
    v_fmac_f32 v56, v88, v8
    v_fmac_f32 v57, v88, v9
    v_lshlrev_b32 v10, 16, v135
    v_and_b32 v11, s67, v135
    v_fmac_f32 v58, v88, v10
    v_fmac_f32 v59, v88, v11
    s_waitcnt vmcnt(7)
    s_cmp_ge_u32 s101, 3
    s_cbranch_scc1 L_go186
    s_waitcnt vmcnt(6)
    s_cmp_ge_u32 s101, 2
    s_cbranch_scc1 L_go186
    s_waitcnt vmcnt(5)
    s_cmp_ge_u32 s101, 1
    s_cbranch_scc1 L_go186
    s_waitcnt vmcnt(4)
L_go186:
    buffer_load_dwordx4 v[168:171], v2, s[36:39], s66 offen offset:256 nt
    v_lshlrev_b32 v4, 16, v136
    v_and_b32 v5, s67, v136
    v_fmac_f32 v36, v89, v4
    v_fmac_f32 v37, v89, v5
    v_lshlrev_b32 v6, 16, v137
    v_and_b32 v7, s67, v137
    v_fmac_f32 v38, v89, v6
    v_fmac_f32 v39, v89, v7
    v_lshlrev_b32 v8, 16, v138
    v_and_b32 v9, s67, v138
    v_fmac_f32 v40, v89, v8
    v_fmac_f32 v41, v89, v9
    v_lshlrev_b32 v10, 16, v139
    v_and_b32 v11, s67, v139
    v_fmac_f32 v42, v89, v10
    v_fmac_f32 v43, v89, v11
    s_lshl_b32 s70, s63, 2
    v_mov_b32 v12, s70
    s_mov_b32 s74, 0
L_mx0_spin:
    ds_read_b32 v22, v12 offset:32
    ds_read_b32 v16, v3 offset:8
    s_waitcnt lgkmcnt(0)
    v_subrev_u32 v16, 1, v16
    v_max_u32 v16, v16, v22
    v_cmp_eq_u32 vcc, -1, v16
    s_cbranch_vccz L_mx0_done
    s_add_u32 s74, s74, 1
    s_cmp_ge_u32 s74, s100
    s_cbranch_scc1 L_mx0_done
    s_sleep 1
    s_branch L_mx0_spin
L_mx0_done:
    s_waitcnt vmcnt(7)
    s_cmp_ge_u32 s101, 3
    s_cbranch_scc1 L_go187
    s_waitcnt vmcnt(6)
    s_cmp_ge_u32 s101, 2
    s_cbranch_scc1 L_go187
    s_waitcnt vmcnt(5)
    s_cmp_ge_u32 s101, 1
    s_cbranch_scc1 L_go187
    s_waitcnt vmcnt(4)
L_go187:
    s_add_u32 s66, s79, 0
    s_and_b32 s66, s66, 31
    s_mul_i32 s66, s66, 98304
    s_add_u32 s66, s66, s75
    buffer_load_dwordx4 v[172:175], v2, s[32:35], s66 offen offset:0 nt
    v_lshlrev_b32 v4, 16, v140
    v_and_b32 v5, s67, v140
    v_fmac_f32 v44, v89, v4
    v_fmac_f32 v45, v89, v5
    v_lshlrev_b32 v6, 16, v141
    v_and_b32 v7, s67, v141
    v_fmac_f32 v46, v89, v6
    v_fmac_f32 v47, v89, v7
    v_lshlrev_b32 v8, 16, v142
    v_and_b32 v9, s67, v142
    v_fmac_f32 v48, v89, v8
    v_fmac_f32 v49, v89, v9
    v_lshlrev_b32 v10, 16, v143
    v_and_b32 v11, s67, v143
    v_fmac_f32 v50, v89, v10
    v_fmac_f32 v51, v89, v11
    s_waitcnt vmcnt(7)
    s_cmp_ge_u32 s101, 3
    s_cbranch_scc1 L_go188
    s_waitcnt vmcnt(6)
    s_cmp_ge_u32 s101, 2
    s_cbranch_scc1 L_go188
    s_waitcnt vmcnt(5)
    s_cmp_ge_u32 s101, 1
    s_cbranch_scc1 L_go188
    s_waitcnt vmcnt(4)
L_go188:
    buffer_load_dwordx4 v[176:179], v2, s[32:35], s66 offen offset:128 nt
    v_lshlrev_b32 v4, 16, v144
    v_and_b32 v5, s67, v144
    v_fmac_f32 v52, v89, v4
    v_fmac_f32 v53, v89, v5
    v_lshlrev_b32 v6, 16, v145
    v_and_b32 v7, s67, v145
    v_fmac_f32 v54, v89, v6
    v_fmac_f32 v55, v89, v7
    v_lshlrev_b32 v8, 16, v146
    v_and_b32 v9, s67, v146
    v_fmac_f32 v56, v89, v8
    v_fmac_f32 v57, v89, v9
    v_lshlrev_b32 v10, 16, v147
    v_and_b32 v11, s67, v147
    v_fmac_f32 v58, v89, v10
    v_fmac_f32 v59, v89, v11
    s_waitcnt vmcnt(7)
    s_cmp_ge_u32 s101, 3
    s_cbranch_scc1 L_go189
    s_waitcnt vmcnt(6)
    s_cmp_ge_u32 s101, 2
    s_cbranch_scc1 L_go189
    s_waitcnt vmcnt(5)
    s_cmp_ge_u32 s101, 1
    s_cbranch_scc1 L_go189
    s_waitcnt vmcnt(4)
L_go189:
    buffer_load_dwordx4 v[180:183], v2, s[32:35], s66 offen offset:256 nt
    v_lshlrev_b32 v4, 16, v148
    v_and_b32 v5, s67, v148
    v_fmac_f32 v36, v90, v4
    v_fmac_f32 v37, v90, v5
    v_lshlrev_b32 v6, 16, v149
    v_and_b32 v7, s67, v149
    v_fmac_f32 v38, v90, v6
    v_fmac_f32 v39, v90, v7
    v_lshlrev_b32 v8, 16, v150
    v_and_b32 v9, s67, v150
    v_fmac_f32 v40, v90, v8
    v_fmac_f32 v41, v90, v9
    v_lshlrev_b32 v10, 16, v151
    v_and_b32 v11, s67, v151
    v_fmac_f32 v42, v90, v10
    v_fmac_f32 v43, v90, v11
    s_waitcnt vmcnt(7)
    s_cmp_ge_u32 s101, 3
    s_cbranch_scc1 L_go190
    s_waitcnt vmcnt(6)
    s_cmp_ge_u32 s101, 2
    s_cbranch_scc1 L_go190
    s_waitcnt vmcnt(5)
    s_cmp_ge_u32 s101, 1
    s_cbranch_scc1 L_go190
    s_waitcnt vmcnt(4)
L_go190:
    s_add_u32 s66, s79, 1
    s_and_b32 s66, s66, 31
    s_mul_i32 s66, s66, 98304
    s_add_u32 s66, s66, s75
    buffer_load_dwordx4 v[184:187], v2, s[32:35], s66 offen offset:0 nt
    v_lshlrev_b32 v4, 16, v152
    v_and_b32 v5, s67, v152
    v_fmac_f32 v44, v90, v4
    v_fmac_f32 v45, v90, v5
    v_lshlrev_b32 v6, 16, v153
    v_and_b32 v7, s67, v153
    v_fmac_f32 v46, v90, v6
    v_fmac_f32 v47, v90, v7
    v_lshlrev_b32 v8, 16, v154
    v_and_b32 v9, s67, v154
    v_fmac_f32 v48, v90, v8
    v_fmac_f32 v49, v90, v9
    v_lshlrev_b32 v10, 16, v155
    v_and_b32 v11, s67, v155
    v_fmac_f32 v50, v90, v10
    v_fmac_f32 v51, v90, v11
    s_waitcnt lgkmcnt(0)
    s_cmp_eq_u32 s76, 0
    s_cbranch_scc1 L_fb6b
    s_mov_b32 s23, 0
    s_min_u32 s4, s4, s20
    s_sub_u32 s4, s22, s4
    s_add_u32 s23, s23, s4
    s_min_u32 s5, s5, s20
    s_sub_u32 s5, s22, s5
    s_add_u32 s23, s23, s5
    s_min_u32 s6, s6, s20
    s_sub_u32 s6, s22, s6
    s_add_u32 s23, s23, s6
    s_min_u32 s7, s7, s20
    s_sub_u32 s7, s22, s7
    s_add_u32 s23, s23, s7
    s_min_u32 s8, s8, s20
    s_sub_u32 s8, s22, s8
    s_add_u32 s23, s23, s8
    s_min_u32 s9, s9, s20
    s_sub_u32 s9, s22, s9
    s_add_u32 s23, s23, s9
    s_min_u32 s10, s10, s20
    s_sub_u32 s10, s22, s10
    s_add_u32 s23, s23, s10
    s_min_u32 s11, s11, s20
    s_sub_u32 s11, s22, s11
    s_add_u32 s23, s23, s11
    s_min_u32 s12, s12, s20
    s_sub_u32 s12, s22, s12
    s_add_u32 s23, s23, s12
    s_min_u32 s13, s13, s20
    s_sub_u32 s13, s22, s13
    s_add_u32 s23, s23, s13
    s_min_u32 s14, s14, s20
    s_sub_u32 s14, s22, s14
    s_add_u32 s23, s23, s14
    s_min_u32 s15, s15, s20
    s_sub_u32 s15, s22, s15
    s_add_u32 s23, s23, s15
    s_min_u32 s16, s16, s20
    s_sub_u32 s16, s22, s16
    s_add_u32 s23, s23, s16
    s_min_u32 s17, s17, s20
    s_sub_u32 s17, s22, s17
    s_add_u32 s23, s23, s17
    s_min_u32 s18, s18, s20
    s_sub_u32 s18, s22, s18
    s_add_u32 s23, s23, s18
    s_min_u32 s19, s19, s20
    s_sub_u32 s19, s22, s19
    s_add_u32 s23, s23, s19
    s_ashr_i32 s23, s23, 4
    s_mov_b32 s101, 0
    s_cmp_ge_i32 s23, -60
    s_cselect_b32 s101, 1, s101
    s_cmp_ge_i32 s23, 20
    s_cselect_b32 s101, 2, s101
    s_cmp_ge_i32 s23, 100
    s_cselect_b32 s101, 3, s101
L_fb6b:
    s_nop 2
    v_readfirstlane_b32 s76, v255
    s_waitcnt vmcnt(7)
    s_cmp_ge_u32 s101, 3
    s_cbranch_scc1 L_go191
    s_waitcnt vmcnt(6)
    s_cmp_ge_u32 s101, 2
    s_cbranch_scc1 L_go191
    s_waitcnt vmcnt(5)
    s_cmp_ge_u32 s101, 1
    s_cbranch_scc1 L_go191
    s_waitcnt vmcnt(4)
L_go191:
    buffer_load_dwordx4 v[188:191], v2, s[32:35], s66 offen offset:128 nt
    v_lshlrev_b32 v4, 16, v156
    v_and_b32 v5, s67, v156
    v_fmac_f32 v52, v90, v4
    v_fmac_f32 v53, v90, v5
    v_lshlrev_b32 v6, 16, v157
    v_and_b32 v7, s67, v157
    v_fmac_f32 v54, v90, v6
    v_fmac_f32 v55, v90, v7
    v_lshlrev_b32 v8, 16, v158
    v_and_b32 v9, s67, v158
    v_fmac_f32 v56, v90, v8
    v_fmac_f32 v57, v90, v9
    v_lshlrev_b32 v10, 16, v159
    v_and_b32 v11, s67, v159
    v_fmac_f32 v58, v90, v10
    v_fmac_f32 v59, v90, v11
    s_waitcnt vmcnt(7)
    s_cmp_ge_u32 s101, 3
    s_cbranch_scc1 L_go192
    s_waitcnt vmcnt(6)
    s_cmp_ge_u32 s101, 2
    s_cbranch_scc1 L_go192
    s_waitcnt vmcnt(5)
    s_cmp_ge_u32 s101, 1
    s_cbranch_scc1 L_go192
    s_waitcnt vmcnt(4)
L_go192:
    buffer_load_dwordx4 v[192:195], v2, s[32:35], s66 offen offset:256 nt
    v_lshlrev_b32 v4, 16, v160
    v_and_b32 v5, s67, v160
    v_fmac_f32 v36, v91, v4
    v_fmac_f32 v37, v91, v5
    v_lshlrev_b32 v6, 16, v161
    v_and_b32 v7, s67, v161
    v_fmac_f32 v38, v91, v6
    v_fmac_f32 v39, v91, v7
    v_lshlrev_b32 v8, 16, v162
    v_and_b32 v9, s67, v162
    v_fmac_f32 v40, v91, v8
    v_fmac_f32 v41, v91, v9
    v_lshlrev_b32 v10, 16, v163
    v_and_b32 v11, s67, v163
    v_fmac_f32 v42, v91, v10
    v_fmac_f32 v43, v91, v11
    s_waitcnt vmcnt(7)
    s_cmp_ge_u32 s101, 3
    s_cbranch_scc1 L_go193
    s_waitcnt vmcnt(6)
    s_cmp_ge_u32 s101, 2
    s_cbranch_scc1 L_go193
    s_waitcnt vmcnt(5)
    s_cmp_ge_u32 s101, 1
    s_cbranch_scc1 L_go193
    s_waitcnt vmcnt(4)
L_go193:
    s_add_u32 s66, s79, 2
    s_and_b32 s66, s66, 31
    s_mul_i32 s66, s66, 98304
    s_add_u32 s66, s66, s75
    buffer_load_dwordx4 v[196:199], v2, s[32:35], s66 offen offset:0 nt
    v_lshlrev_b32 v4, 16, v164
    v_and_b32 v5, s67, v164
    v_fmac_f32 v44, v91, v4
    v_fmac_f32 v45, v91, v5
    v_lshlrev_b32 v6, 16, v165
    v_and_b32 v7, s67, v165
    v_fmac_f32 v46, v91, v6
    v_fmac_f32 v47, v91, v7
    v_lshlrev_b32 v8, 16, v166
    v_and_b32 v9, s67, v166
    v_fmac_f32 v48, v91, v8
    v_fmac_f32 v49, v91, v9
    v_lshlrev_b32 v10, 16, v167
    v_and_b32 v11, s67, v167
    v_fmac_f32 v50, v91, v10
    v_fmac_f32 v51, v91, v11
    s_waitcnt vmcnt(7)
    s_cmp_ge_u32 s101, 3
    s_cbranch_scc1 L_go194
    s_waitcnt vmcnt(6)
    s_cmp_ge_u32 s101, 2
    s_cbranch_scc1 L_go194
    s_waitcnt vmcnt(5)
    s_cmp_ge_u32 s101, 1
    s_cbranch_scc1 L_go194
    s_waitcnt vmcnt(4)
L_go194:
    buffer_load_dwordx4 v[200:203], v2, s[32:35], s66 offen offset:128 nt
    v_lshlrev_b32 v4, 16, v168
    v_and_b32 v5, s67, v168
    v_fmac_f32 v52, v91, v4
    v_fmac_f32 v53, v91, v5
    v_lshlrev_b32 v6, 16, v169
    v_and_b32 v7, s67, v169
    v_fmac_f32 v54, v91, v6
    v_fmac_f32 v55, v91, v7
    v_lshlrev_b32 v8, 16, v170
    v_and_b32 v9, s67, v170
    v_fmac_f32 v56, v91, v8
    v_fmac_f32 v57, v91, v9
    v_lshlrev_b32 v10, 16, v171
    v_and_b32 v11, s67, v171
    v_fmac_f32 v58, v91, v10
    v_fmac_f32 v59, v91, v11
    v_permlane32_swap_b32 v36, v48
    v_permlane32_swap_b32 v37, v49
    v_permlane32_swap_b32 v38, v50
    v_permlane32_swap_b32 v39, v51
    v_permlane32_swap_b32 v40, v52
    v_permlane32_swap_b32 v41, v53
    v_permlane32_swap_b32 v42, v54
    v_permlane32_swap_b32 v43, v55
    v_permlane32_swap_b32 v44, v56
    v_permlane32_swap_b32 v45, v57
    v_permlane32_swap_b32 v46, v58
    v_permlane32_swap_b32 v47, v59
    v_add_f32 v36, v36, v48
    v_add_f32 v37, v37, v49
    v_add_f32 v38, v38, v50
    v_add_f32 v39, v39, v51
    v_add_f32 v40, v40, v52
    v_add_f32 v41, v41, v53
    v_add_f32 v42, v42, v54
    v_add_f32 v43, v43, v55
    v_add_f32 v44, v44, v56
    v_add_f32 v45, v45, v57
    v_add_f32 v46, v46, v58
    v_add_f32 v47, v47, v59
    s_waitcnt vmcnt(7)
    s_cmp_ge_u32 s101, 3
    s_cbranch_scc1 L_go195
    s_waitcnt vmcnt(6)
    s_cmp_ge_u32 s101, 2
    s_cbranch_scc1 L_go195
    s_waitcnt vmcnt(5)
    s_cmp_ge_u32 s101, 1
    s_cbranch_scc1 L_go195
    s_waitcnt vmcnt(4)
L_go195:
    buffer_load_dwordx4 v[204:207], v2, s[32:35], s66 offen offset:256 nt
    v_permlane16_swap_b32 v36, v42
    v_permlane16_swap_b32 v37, v43
    v_permlane16_swap_b32 v38, v44
    v_permlane16_swap_b32 v39, v45
    v_permlane16_swap_b32 v40, v46
    v_permlane16_swap_b32 v41, v47
    v_add_f32 v36, v36, v42
    v_add_f32 v37, v37, v43
    v_add_f32 v38, v38, v44
    v_add_f32 v39, v39, v45
    v_add_f32 v40, v40, v46
    v_add_f32 v41, v41, v47
    v_add_f32_dpp v48, v36, v36 row_ror:8 row_mask:0xf bank_mask:0x3
    v_add_f32_dpp v49, v37, v37 row_ror:8 row_mask:0xf bank_mask:0x3
    v_add_f32_dpp v50, v38, v38 row_ror:8 row_mask:0xf bank_mask:0x3
    v_add_f32_dpp v48, v39, v39 row_ror:8 row_mask:0xf bank_mask:0xc
    v_add_f32_dpp v49, v40, v40 row_ror:8 row_mask:0xf bank_mask:0xc
    v_add_f32_dpp v50, v41, v41 row_ror:8 row_mask:0xf bank_mask:0xc
    v_mul_f32 v48, v48, v22
    v_mul_f32 v49, v49, v22
    v_mul_f32 v50, v50, v22
    ds_write_b32 v252, v48 offset:1024
    ds_write_b32 v252, v49 offset:1028
    ds_write_b32 v252, v50 offset:1032
    s_mov_b64 exec, 1
    ds_add_rtn_u32 v16, v3, v17 offset:4
    s_mov_b64 exec, -1
    s_waitcnt vmcnt(7)
    s_cmp_ge_u32 s101, 3
    s_cbranch_scc1 L_go196
    s_waitcnt vmcnt(6)
    s_cmp_ge_u32 s101, 2
    s_cbranch_scc1 L_go196
    s_waitcnt vmcnt(5)
    s_cmp_ge_u32 s101, 1
    s_cbranch_scc1 L_go196
    s_waitcnt vmcnt(4)
L_go196:
    s_add_u32 s66, s79, 3
    s_and_b32 s66, s66, 31
    s_mul_i32 s66, s66, 98304
    s_add_u32 s66, s66, s75
    buffer_load_dwordx4 v[208:211], v2, s[32:35], s66 offen offset:0 nt
    s_lshl_b32 s71, s3, 10
    s_add_u32 s71, s71, 1572864
    s_waitcnt lgkmcnt(0)
    v_readfirstlane_b32 s77, v16
    s_nop 0
    s_cmp_lg_u32 s77, 3
    s_cselect_b32 s71, 4194304, s71
    s_cbranch_scc1 L_fl0
    ds_read_b128 v[36:39], v18 offset:1024
    ds_read_b128 v[40:43], v18 offset:1792
    ds_read_b128 v[44:47], v18 offset:2560
    ds_read_b128 v[48:51], v18 offset:3328
    s_waitcnt lgkmcnt(0)
    v_pk_add_f32 v[36:37], v[36:37], v[40:41]
    v_pk_add_f32 v[44:45], v[44:45], v[48:49]
    v_pk_add_f32 v[38:39], v[38:39], v[42:43]
    v_pk_add_f32 v[46:47], v[46:47], v[50:51]
    v_pk_add_f32 v[36:37], v[36:37], v[44:45]
    v_pk_add_f32 v[38:39], v[38:39], v[46:47]
L_fl0:
    buffer_store_dwordx4 v[36:39], v19, s[56:59], s71 offen sc1
    v_lshlrev_b32 v12, 4, v21
    s_mov_b32 s74, 0
L_ql1_spin:
    ds_read_b128 v[24:27], v12 offset:512
    ds_read_b128 v[28:31], v12 offset:640
    ds_read_b128 v[32:35], v12 offset:768
    s_waitcnt lgkmcnt(0)
    v_max3_u32 v13, v24, v25, v26
    v_max3_u32 v13, v13, v27, v28
    v_max3_u32 v13, v13, v29, v30
    v_max3_u32 v13, v13, v31, v32
    v_max3_u32 v13, v13, v33, v34
    v_max_u32 v13, v13, v35
    v_cmp_eq_u32 vcc, -1, v13
    s_cbranch_vccz L_ql1_done
    s_add_u32 s74, s74, 1
    s_cmp_ge_u32 s74, s100
    s_cbranch_scc1 L_ql1_done
    s_sleep 1
    s_branch L_ql1_spin
L_ql1_done:
    v_dot2_f32_bf16 v4, v172, v24, 0
    v_dot2_f32_bf16 v4, v173, v25, v4
    v_dot2_f32_bf16 v4, v174, v26, v4
    v_dot2_f32_bf16 v4, v175, v27, v4
    v_dot2_f32_bf16 v5, v176, v28, 0
    v_dot2_f32_bf16 v5, v177, v29, v5
    v_dot2_f32_bf16 v5, v178, v30, v5
    v_dot2_f32_bf16 v5, v179, v31, v5
    s_waitcnt vmcnt(7)
    s_cmp_ge_u32 s101, 3
    s_cbranch_scc1 L_go197
    s_waitcnt vmcnt(6)
    s_cmp_ge_u32 s101, 2
    s_cbranch_scc1 L_go197
    s_waitcnt vmcnt(5)
    s_cmp_ge_u32 s101, 1
    s_cbranch_scc1 L_go197
    s_waitcnt vmcnt(4)
L_go197:
    buffer_load_dwordx4 v[212:215], v2, s[32:35], s66 offen offset:128 nt
    v_dot2_f32_bf16 v6, v180, v32, 0
    v_dot2_f32_bf16 v6, v181, v33, v6
    v_dot2_f32_bf16 v6, v182, v34, v6
    v_dot2_f32_bf16 v6, v183, v35, v6
    v_add_f32 v60, v4, v5
    s_nop 1
    v_add_f32 v60, v60, v6
    s_nop 1
    v_add_f32_dpp v60, v60, v60 quad_perm:[1,0,3,2] row_mask:0xf bank_mask:0xf
    s_nop 1
    v_add_f32_dpp v60, v60, v60 quad_perm:[2,3,0,1] row_mask:0xf bank_mask:0xf
    s_nop 1
    v_add_f32_dpp v60, v60, v60 row_half_mirror row_mask:0xf bank_mask:0xf
    v_cvt_pk_bf16_f32 v60, v60, v60
    v_lshlrev_b32 v60, 16, v60
    v_mul_f32 v60, 0x3d93cd3a, v60
    v_cvt_pk_bf16_f32 v60, v60, v60
    v_lshlrev_b32 v60, 16, v60
    v_mov_b32 v22, v60
    s_waitcnt vmcnt(7)
    s_cmp_ge_u32 s101, 3
    s_cbranch_scc1 L_go198
    s_waitcnt vmcnt(6)
    s_cmp_ge_u32 s101, 2
    s_cbranch_scc1 L_go198
    s_waitcnt vmcnt(5)
    s_cmp_ge_u32 s101, 1
    s_cbranch_scc1 L_go198
    s_waitcnt vmcnt(4)
L_go198:
    buffer_load_dwordx4 v[216:219], v2, s[32:35], s66 offen offset:256 nt
    v_dot2_f32_bf16 v4, v184, v24, 0
    v_dot2_f32_bf16 v4, v185, v25, v4
    v_dot2_f32_bf16 v4, v186, v26, v4
    v_dot2_f32_bf16 v4, v187, v27, v4
    s_waitcnt vmcnt(7)
    s_cmp_ge_u32 s101, 3
    s_cbranch_scc1 L_go199
    s_waitcnt vmcnt(6)
    s_cmp_ge_u32 s101, 2
    s_cbranch_scc1 L_go199
    s_waitcnt vmcnt(5)
    s_cmp_ge_u32 s101, 1
    s_cbranch_scc1 L_go199
    s_waitcnt vmcnt(4)
L_go199:
    s_add_u32 s66, s79, 4
    s_and_b32 s66, s66, 31
    s_mul_i32 s66, s66, 98304
    s_add_u32 s66, s66, s75
    buffer_load_dwordx4 v[220:223], v2, s[32:35], s66 offen offset:0 nt
    v_dot2_f32_bf16 v5, v188, v28, 0
    v_dot2_f32_bf16 v5, v189, v29, v5
    v_dot2_f32_bf16 v5, v190, v30, v5
    v_dot2_f32_bf16 v5, v191, v31, v5
    s_mov_b32 s22, s20
    s_memrealtime s[20:21]
    s_waitcnt vmcnt(7)
    s_cmp_ge_u32 s101, 3
    s_cbranch_scc1 L_go200
    s_waitcnt vmcnt(6)
    s_cmp_ge_u32 s101, 2
    s_cbranch_scc1 L_go200
    s_waitcnt vmcnt(5)
    s_cmp_ge_u32 s101, 1
    s_cbranch_scc1 L_go200
    s_waitcnt vmcnt(4)
L_go200:
    buffer_load_dwordx4 v[224:227], v2, s[32:35], s66 offen offset:128 nt
    v_dot2_f32_bf16 v6, v192, v32, 0
    v_dot2_f32_bf16 v6, v193, v33, v6
    v_dot2_f32_bf16 v6, v194, v34, v6
    v_dot2_f32_bf16 v6, v195, v35, v6
    s_waitcnt lgkmcnt(0)
    v_mov_b32 v254, s20
    s_mov_b32 s70, 983936
    buffer_store_dword v254, v253, s[56:59], s70 offen sc1
    s_cmp_eq_u32 s76, 0
    s_cbranch_scc1 L_fb7a
    s_load_dwordx16 s[4:19], s[24:25], 983808
L_fb7a:
    ds_read_b32 v255, v3 offset:8
    v_add_f32 v61, v4, v5
    v_add_f32 v61, v61, v6
    s_nop 1
    v_add_f32_dpp v61, v61, v61 quad_perm:[1,0,3,2] row_mask:0xf bank_mask:0xf
    s_nop 1
    v_add_f32_dpp v61, v61, v61 quad_perm:[2,3,0,1] row_mask:0xf bank_mask:0xf
    s_nop 1
    v_add_f32_dpp v61, v61, v61 row_half_mirror row_mask:0xf bank_mask:0xf
    v_cvt_pk_bf16_f32 v61, v61, v61
    v_lshlrev_b32 v61, 16, v61
    v_mul_f32 v61, 0x3d93cd3a, v61
    v_cvt_pk_bf16_f32 v61, v61, v61
    v_lshlrev_b32 v61, 16, v61
    v_max_f32 v22, v22, v61
    s_waitcnt vmcnt(7)
    s_cmp_ge_u32 s101, 3
    s_cbranch_scc1 L_go201
    s_waitcnt vmcnt(6)
    s_cmp_ge_u32 s101, 2
    s_cbranch_scc1 L_go201
    s_waitcnt vmcnt(5)
    s_cmp_ge_u32 s101, 1
    s_cbranch_scc1 L_go201
    s_waitcnt vmcnt(4)
L_go201:
    buffer_load_dwordx4 v[228:231], v2, s[32:35], s66 offen offset:256 nt
    v_dot2_f32_bf16 v4, v196, v24, 0
    v_dot2_f32_bf16 v4, v197, v25, v4
    v_dot2_f32_bf16 v4, v198, v26, v4
    v_dot2_f32_bf16 v4, v199, v27, v4
    s_waitcnt vmcnt(7)
    s_cmp_ge_u32 s101, 3
    s_cbranch_scc1 L_go202
    s_waitcnt vmcnt(6)
    s_cmp_ge_u32 s101, 2
    s_cbranch_scc1 L_go202
    s_waitcnt vmcnt(5)
    s_cmp_ge_u32 s101, 1
    s_cbranch_scc1 L_go202
    s_waitcnt vmcnt(4)
L_go202:
    s_add_u32 s66, s79, 5
    s_and_b32 s66, s66, 31
    s_mul_i32 s66, s66, 98304
    s_add_u32 s66, s66, s75
    buffer_load_dwordx4 v[232:235], v2, s[32:35], s66 offen offset:0 nt
    v_dot2_f32_bf16 v5, v200, v28, 0
    v_dot2_f32_bf16 v5, v201, v29, v5
    v_dot2_f32_bf16 v5, v202, v30, v5
    v_dot2_f32_bf16 v5, v203, v31, v5
    s_waitcnt vmcnt(7)
    s_cmp_ge_u32 s101, 3
    s_cbranch_scc1 L_go203
    s_waitcnt vmcnt(6)
    s_cmp_ge_u32 s101, 2
    s_cbranch_scc1 L_go203
    s_waitcnt vmcnt(5)
    s_cmp_ge_u32 s101, 1
    s_cbranch_scc1 L_go203
    s_waitcnt vmcnt(4)
L_go203:
    buffer_load_dwordx4 v[236:239], v2, s[32:35], s66 offen offset:128 nt
    v_dot2_f32_bf16 v6, v204, v32, 0
    v_dot2_f32_bf16 v6, v205, v33, v6
    v_dot2_f32_bf16 v6, v206, v34, v6
    v_dot2_f32_bf16 v6, v207, v35, v6
    s_cmp_lg_u32 s77, 3
    s_cbranch_scc1 L_p0f
    ds_write_b32 v3, v17 offset:20
L_p0f:
    v_add_f32 v62, v4, v5
    v_add_f32 v62, v62, v6
    s_nop 1
    v_add_f32_dpp v62, v62, v62 quad_perm:[1,0,3,2] row_mask:0xf bank_mask:0xf
    s_nop 1
    v_add_f32_dpp v62, v62, v62 quad_perm:[2,3,0,1] row_mask:0xf bank_mask:0xf
    s_nop 1
    v_add_f32_dpp v62, v62, v62 row_half_mirror row_mask:0xf bank_mask:0xf
    v_cvt_pk_bf16_f32 v62, v62, v62
    v_lshlrev_b32 v62, 16, v62
    v_mul_f32 v62, 0x3d93cd3a, v62
    v_cvt_pk_bf16_f32 v62, v62, v62
    v_lshlrev_b32 v62, 16, v62
    v_max_f32 v22, v22, v62
    s_waitcnt vmcnt(7)
    s_cmp_ge_u32 s101, 3
    s_cbranch_scc1 L_go204
    s_waitcnt vmcnt(6)
    s_cmp_ge_u32 s101, 2
    s_cbranch_scc1 L_go204
    s_waitcnt vmcnt(5)
    s_cmp_ge_u32 s101, 1
    s_cbranch_scc1 L_go204
    s_waitcnt vmcnt(4)
L_go204:
    buffer_load_dwordx4 v[240:243], v2, s[32:35], s66 offen offset:256 nt
    v_dot2_f32_bf16 v4, v208, v24, 0
    v_dot2_f32_bf16 v4, v209, v25, v4
    v_dot2_f32_bf16 v4, v210, v26, v4
    v_dot2_f32_bf16 v4, v211, v27, v4
    s_waitcnt vmcnt(7)
    s_cmp_ge_u32 s101, 3
    s_cbranch_scc1 L_go205
    s_waitcnt vmcnt(6)
    s_cmp_ge_u32 s101, 2
    s_cbranch_scc1 L_go205
    s_waitcnt vmcnt(5)
    s_cmp_ge_u32 s101, 1
    s_cbranch_scc1 L_go205
    s_waitcnt vmcnt(4)
L_go205:
    s_add_u32 s66, s79, 6
    s_and_b32 s66, s66, 31
    s_mul_i32 s66, s66, 98304
    s_add_u32 s66, s66, s75
    buffer_load_dwordx4 v[244:247], v2, s[32:35], s66 offen offset:0 nt
    v_dot2_f32_bf16 v5, v212, v28, 0
    v_dot2_f32_bf16 v5, v213, v29, v5
    v_dot2_f32_bf16 v5, v214, v30, v5
    v_dot2_f32_bf16 v5, v215, v31, v5
    s_waitcnt vmcnt(7)
    s_cmp_ge_u32 s101, 3
    s_cbranch_scc1 L_go206
    s_waitcnt vmcnt(6)
    s_cmp_ge_u32 s101, 2
    s_cbranch_scc1 L_go206
    s_waitcnt vmcnt(5)
    s_cmp_ge_u32 s101, 1
    s_cbranch_scc1 L_go206
    s_waitcnt vmcnt(4)
L_go206:
    buffer_load_dwordx4 v[248:251], v2, s[32:35], s66 offen offset:128 nt
    v_dot2_f32_bf16 v6, v216, v32, 0
    v_dot2_f32_bf16 v6, v217, v33, v6
    v_dot2_f32_bf16 v6, v218, v34, v6
    v_dot2_f32_bf16 v6, v219, v35, v6
    v_add_f32 v63, v4, v5
    s_nop 1
    v_add_f32 v63, v63, v6
    s_nop 1
    v_add_f32_dpp v63, v63, v63 quad_perm:[1,0,3,2] row_mask:0xf bank_mask:0xf
    s_nop 1
    v_add_f32_dpp v63, v63, v63 quad_perm:[2,3,0,1] row_mask:0xf bank_mask:0xf
    s_nop 1
    v_add_f32_dpp v63, v63, v63 row_half_mirror row_mask:0xf bank_mask:0xf
    v_cvt_pk_bf16_f32 v63, v63, v63
    v_lshlrev_b32 v63, 16, v63
    v_mul_f32 v63, 0x3d93cd3a, v63
    v_cvt_pk_bf16_f32 v63, v63, v63
    v_lshlrev_b32 v63, 16, v63
    v_max_f32 v22, v22, v63
    s_waitcnt vmcnt(7)
    s_cmp_ge_u32 s101, 3
    s_cbranch_scc1 L_go207
    s_waitcnt vmcnt(6)
    s_cmp_ge_u32 s101, 2
    s_cbranch_scc1 L_go207
    s_waitcnt vmcnt(5)
    s_cmp_ge_u32 s101, 1
    s_cbranch_scc1 L_go207
    s_waitcnt vmcnt(4)
L_go207:
    buffer_load_dwordx4 v[92:95], v2, s[32:35], s66 offen offset:256 nt
    v_dot2_f32_bf16 v4, v220, v24, 0
    v_dot2_f32_bf16 v4, v221, v25, v4
    v_dot2_f32_bf16 v4, v222, v26, v4
    v_dot2_f32_bf16 v4, v223, v27, v4
    s_waitcnt vmcnt(7)
    s_cmp_ge_u32 s101, 3
    s_cbranch_scc1 L_go208
    s_waitcnt vmcnt(6)
    s_cmp_ge_u32 s101, 2
    s_cbranch_scc1 L_go208
    s_waitcnt vmcnt(5)
    s_cmp_ge_u32 s101, 1
    s_cbranch_scc1 L_go208
    s_waitcnt vmcnt(4)
L_go208:
    s_add_u32 s66, s79, 7
    s_and_b32 s66, s66, 31
    s_mul_i32 s66, s66, 98304
    s_add_u32 s66, s66, s75
    buffer_load_dwordx4 v[96:99], v2, s[32:35], s66 offen offset:0 nt
    v_dot2_f32_bf16 v5, v224, v28, 0
    v_dot2_f32_bf16 v5, v225, v29, v5
    v_dot2_f32_bf16 v5, v226, v30, v5
    v_dot2_f32_bf16 v5, v227, v31, v5
    s_waitcnt lgkmcnt(0)
    s_cmp_eq_u32 s76, 0
    s_cbranch_scc1 L_fb7b
    s_mov_b32 s23, 0
    s_min_u32 s4, s4, s20
    s_sub_u32 s4, s22, s4
    s_add_u32 s23, s23, s4
    s_min_u32 s5, s5, s20
    s_sub_u32 s5, s22, s5
    s_add_u32 s23, s23, s5
    s_min_u32 s6, s6, s20
    s_sub_u32 s6, s22, s6
    s_add_u32 s23, s23, s6
    s_min_u32 s7, s7, s20
    s_sub_u32 s7, s22, s7
    s_add_u32 s23, s23, s7
    s_min_u32 s8, s8, s20
    s_sub_u32 s8, s22, s8
    s_add_u32 s23, s23, s8
    s_min_u32 s9, s9, s20
    s_sub_u32 s9, s22, s9
    s_add_u32 s23, s23, s9
    s_min_u32 s10, s10, s20
    s_sub_u32 s10, s22, s10
    s_add_u32 s23, s23, s10
    s_min_u32 s11, s11, s20
    s_sub_u32 s11, s22, s11
    s_add_u32 s23, s23, s11
    s_min_u32 s12, s12, s20
    s_sub_u32 s12, s22, s12
    s_add_u32 s23, s23, s12
    s_min_u32 s13, s13, s20
    s_sub_u32 s13, s22, s13
    s_add_u32 s23, s23, s13
    s_min_u32 s14, s14, s20
    s_sub_u32 s14, s22, s14
    s_add_u32 s23, s23, s14
    s_min_u32 s15, s15, s20
    s_sub_u32 s15, s22, s15
    s_add_u32 s23, s23, s15
    s_min_u32 s16, s16, s20
    s_sub_u32 s16, s22, s16
    s_add_u32 s23, s23, s16
    s_min_u32 s17, s17, s20
    s_sub_u32 s17, s22, s17
    s_add_u32 s23, s23, s17
    s_min_u32 s18, s18, s20
    s_sub_u32 s18, s22, s18
    s_add_u32 s23, s23, s18
    s_min_u32 s19, s19, s20
    s_sub_u32 s19, s22, s19
    s_add_u32 s23, s23, s19
    s_ashr_i32 s23, s23, 4
    s_mov_b32 s101, 0
    s_cmp_ge_i32 s23, -60
    s_cselect_b32 s101, 1, s101
    s_cmp_ge_i32 s23, 20
    s_cselect_b32 s101, 2, s101
    s_cmp_ge_i32 s23, 100
    s_cselect_b32 s101, 3, s101
L_fb7b:
    s_nop 2
    v_readfirstlane_b32 s76, v255
    s_waitcnt vmcnt(7)
    s_cmp_ge_u32 s101, 3
    s_cbranch_scc1 L_go209
    s_waitcnt vmcnt(6)
    s_cmp_ge_u32 s101, 2
    s_cbranch_scc1 L_go209
    s_waitcnt vmcnt(5)
    s_cmp_ge_u32 s101, 1
    s_cbranch_scc1 L_go209
    s_waitcnt vmcnt(4)
L_go209:
    buffer_load_dwordx4 v[100:103], v2, s[32:35], s66 offen offset:128 nt
    v_dot2_f32_bf16 v6, v228, v32, 0
    v_dot2_f32_bf16 v6, v229, v33, v6
    v_dot2_f32_bf16 v6, v230, v34, v6
    v_dot2_f32_bf16 v6, v231, v35, v6
    v_add_f32 v64, v4, v5
    s_nop 1
    v_add_f32 v64, v64, v6
    s_nop 1
    v_add_f32_dpp v64, v64, v64 quad_perm:[1,0,3,2] row_mask:0xf bank_mask:0xf
    s_nop 1
    v_add_f32_dpp v64, v64, v64 quad_perm:[2,3,0,1] row_mask:0xf bank_mask:0xf
    s_nop 1
    v_add_f32_dpp v64, v64, v64 row_half_mirror row_mask:0xf bank_mask:0xf
    v_cvt_pk_bf16_f32 v64, v64, v64
    v_lshlrev_b32 v64, 16, v64
    v_mul_f32 v64, 0x3d93cd3a, v64
    v_cvt_pk_bf16_f32 v64, v64, v64
    v_lshlrev_b32 v64, 16, v64
    v_max_f32 v22, v22, v64
    s_waitcnt vmcnt(7)
    s_cmp_ge_u32 s101, 3
    s_cbranch_scc1 L_go210
    s_waitcnt vmcnt(6)
    s_cmp_ge_u32 s101, 2
    s_cbranch_scc1 L_go210
    s_waitcnt vmcnt(5)
    s_cmp_ge_u32 s101, 1
    s_cbranch_scc1 L_go210
    s_waitcnt vmcnt(4)
L_go210:
    buffer_load_dwordx4 v[104:107], v2, s[32:35], s66 offen offset:256 nt
    v_dot2_f32_bf16 v4, v232, v24, 0
    v_dot2_f32_bf16 v4, v233, v25, v4
    v_dot2_f32_bf16 v4, v234, v26, v4
    v_dot2_f32_bf16 v4, v235, v27, v4
    s_waitcnt vmcnt(7)
    s_cmp_ge_u32 s101, 3
    s_cbranch_scc1 L_go211
    s_waitcnt vmcnt(6)
    s_cmp_ge_u32 s101, 2
    s_cbranch_scc1 L_go211
    s_waitcnt vmcnt(5)
    s_cmp_ge_u32 s101, 1
    s_cbranch_scc1 L_go211
    s_waitcnt vmcnt(4)
L_go211:
    s_add_u32 s66, s79, 8
    s_and_b32 s66, s66, 31
    s_mul_i32 s66, s66, 98304
    s_add_u32 s66, s66, s75
    buffer_load_dwordx4 v[108:111], v2, s[32:35], s66 offen offset:0 nt
    v_dot2_f32_bf16 v5, v236, v28, 0
    v_dot2_f32_bf16 v5, v237, v29, v5
    v_dot2_f32_bf16 v5, v238, v30, v5
    v_dot2_f32_bf16 v5, v239, v31, v5
    s_waitcnt vmcnt(7)
    s_cmp_ge_u32 s101, 3
    s_cbranch_scc1 L_go212
    s_waitcnt vmcnt(6)
    s_cmp_ge_u32 s101, 2
    s_cbranch_scc1 L_go212
    s_waitcnt vmcnt(5)
    s_cmp_ge_u32 s101, 1
    s_cbranch_scc1 L_go212
    s_waitcnt vmcnt(4)
L_go212:
    buffer_load_dwordx4 v[112:115], v2, s[32:35], s66 offen offset:128 nt
    v_dot2_f32_bf16 v6, v240, v32, 0
    v_dot2_f32_bf16 v6, v241, v33, v6
    v_dot2_f32_bf16 v6, v242, v34, v6
    v_dot2_f32_bf16 v6, v243, v35, v6
    v_add_f32 v65, v4, v5
    s_nop 1
    v_add_f32 v65, v65, v6
    s_nop 1
    v_add_f32_dpp v65, v65, v65 quad_perm:[1,0,3,2] row_mask:0xf bank_mask:0xf
    s_nop 1
    v_add_f32_dpp v65, v65, v65 quad_perm:[2,3,0,1] row_mask:0xf bank_mask:0xf
    s_nop 1
    v_add_f32_dpp v65, v65, v65 row_half_mirror row_mask:0xf bank_mask:0xf
    v_cvt_pk_bf16_f32 v65, v65, v65
    v_lshlrev_b32 v65, 16, v65
    v_mul_f32 v65, 0x3d93cd3a, v65
    v_cvt_pk_bf16_f32 v65, v65, v65
    v_lshlrev_b32 v65, 16, v65
    v_max_f32 v22, v22, v65
    s_waitcnt vmcnt(7)
    s_cmp_ge_u32 s101, 3
    s_cbranch_scc1 L_go213
    s_waitcnt vmcnt(6)
    s_cmp_ge_u32 s101, 2
    s_cbranch_scc1 L_go213
    s_waitcnt vmcnt(5)
    s_cmp_ge_u32 s101, 1
    s_cbranch_scc1 L_go213
    s_waitcnt vmcnt(4)
L_go213:
    buffer_load_dwordx4 v[116:119], v2, s[32:35], s66 offen offset:256 nt
    v_dot2_f32_bf16 v4, v244, v24, 0
    v_dot2_f32_bf16 v4, v245, v25, v4
    v_dot2_f32_bf16 v4, v246, v26, v4
    v_dot2_f32_bf16 v4, v247, v27, v4
    s_waitcnt vmcnt(7)
    s_cmp_ge_u32 s101, 3
    s_cbranch_scc1 L_go214
    s_waitcnt vmcnt(6)
    s_cmp_ge_u32 s101, 2
    s_cbranch_scc1 L_go214
    s_waitcnt vmcnt(5)
    s_cmp_ge_u32 s101, 1
    s_cbranch_scc1 L_go214
    s_waitcnt vmcnt(4)
L_go214:
    s_add_u32 s66, s79, 9
    s_and_b32 s66, s66, 31
    s_mul_i32 s66, s66, 98304
    s_add_u32 s66, s66, s75
    buffer_load_dwordx4 v[120:123], v2, s[32:35], s66 offen offset:0 nt
    v_dot2_f32_bf16 v5, v248, v28, 0
    v_dot2_f32_bf16 v5, v249, v29, v5
    v_dot2_f32_bf16 v5, v250, v30, v5
    v_dot2_f32_bf16 v5, v251, v31, v5
    s_waitcnt vmcnt(7)
    s_cmp_ge_u32 s101, 3
    s_cbranch_scc1 L_go215
    s_waitcnt vmcnt(6)
    s_cmp_ge_u32 s101, 2
    s_cbranch_scc1 L_go215
    s_waitcnt vmcnt(5)
    s_cmp_ge_u32 s101, 1
    s_cbranch_scc1 L_go215
    s_waitcnt vmcnt(4)
L_go215:
    buffer_load_dwordx4 v[124:127], v2, s[32:35], s66 offen offset:128 nt
    v_dot2_f32_bf16 v6, v92, v32, 0
    v_dot2_f32_bf16 v6, v93, v33, v6
    v_dot2_f32_bf16 v6, v94, v34, v6
    v_dot2_f32_bf16 v6, v95, v35, v6
    v_add_f32 v66, v4, v5
    s_nop 1
    v_add_f32 v66, v66, v6
    s_nop 1
    v_add_f32_dpp v66, v66, v66 quad_perm:[1,0,3,2] row_mask:0xf bank_mask:0xf
    s_nop 1
    v_add_f32_dpp v66, v66, v66 quad_perm:[2,3,0,1] row_mask:0xf bank_mask:0xf
    s_nop 1
    v_add_f32_dpp v66, v66, v66 row_half_mirror row_mask:0xf bank_mask:0xf
    v_cvt_pk_bf16_f32 v66, v66, v66
    v_lshlrev_b32 v66, 16, v66
    v_mul_f32 v66, 0x3d93cd3a, v66
    v_cvt_pk_bf16_f32 v66, v66, v66
    v_lshlrev_b32 v66, 16, v66
    v_max_f32 v22, v22, v66
    s_waitcnt vmcnt(7)
    s_cmp_ge_u32 s101, 3
    s_cbranch_scc1 L_go216
    s_waitcnt vmcnt(6)
    s_cmp_ge_u32 s101, 2
    s_cbranch_scc1 L_go216
    s_waitcnt vmcnt(5)
    s_cmp_ge_u32 s101, 1
    s_cbranch_scc1 L_go216
    s_waitcnt vmcnt(4)
L_go216:
    buffer_load_dwordx4 v[128:131], v2, s[32:35], s66 offen offset:256 nt
    v_dot2_f32_bf16 v4, v96, v24, 0
    v_dot2_f32_bf16 v4, v97, v25, v4
    v_dot2_f32_bf16 v4, v98, v26, v4
    v_dot2_f32_bf16 v4, v99, v27, v4
    s_waitcnt vmcnt(7)
    s_cmp_ge_u32 s101, 3
    s_cbranch_scc1 L_go217
    s_waitcnt vmcnt(6)
    s_cmp_ge_u32 s101, 2
    s_cbranch_scc1 L_go217
    s_waitcnt vmcnt(5)
    s_cmp_ge_u32 s101, 1
    s_cbranch_scc1 L_go217
    s_waitcnt vmcnt(4)
L_go217:
    s_add_u32 s66, s79, 10
    s_and_b32 s66, s66, 31
    s_mul_i32 s66, s66, 98304
    s_add_u32 s66, s66, s75
    buffer_load_dwordx4 v[132:135], v2, s[32:35], s66 offen offset:0 nt
    v_dot2_f32_bf16 v5, v100, v28, 0
    v_dot2_f32_bf16 v5, v101, v29, v5
    v_dot2_f32_bf16 v5, v102, v30, v5
    v_dot2_f32_bf16 v5, v103, v31, v5
    s_mov_b32 s22, s20
    s_memrealtime s[20:21]
    s_waitcnt vmcnt(7)
    s_cmp_ge_u32 s101, 3
    s_cbranch_scc1 L_go218
    s_waitcnt vmcnt(6)
    s_cmp_ge_u32 s101, 2
    s_cbranch_scc1 L_go218
    s_waitcnt vmcnt(5)
    s_cmp_ge_u32 s101, 1
    s_cbranch_scc1 L_go218
    s_waitcnt vmcnt(4)
L_go218:
    buffer_load_dwordx4 v[136:139], v2, s[32:35], s66 offen offset:128 nt
    v_dot2_f32_bf16 v6, v104, v32, 0
    v_dot2_f32_bf16 v6, v105, v33, v6
    v_dot2_f32_bf16 v6, v106, v34, v6
    v_dot2_f32_bf16 v6, v107, v35, v6
    s_waitcnt lgkmcnt(0)
    v_mov_b32 v254, s20
    s_mov_b32 s70, 984064
    buffer_store_dword v254, v253, s[56:59], s70 offen sc1
    s_cmp_eq_u32 s76, 0
    s_cbranch_scc1 L_fb8a
    s_load_dwordx16 s[4:19], s[24:25], 983936
L_fb8a:
    ds_read_b32 v255, v3 offset:8
    v_add_f32 v67, v4, v5
    v_add_f32 v67, v67, v6
    s_nop 1
    v_add_f32_dpp v67, v67, v67 quad_perm:[1,0,3,2] row_mask:0xf bank_mask:0xf
    s_nop 1
    v_add_f32_dpp v67, v67, v67 quad_perm:[2,3,0,1] row_mask:0xf bank_mask:0xf
    s_nop 1
    v_add_f32_dpp v67, v67, v67 row_half_mirror row_mask:0xf bank_mask:0xf
    v_cvt_pk_bf16_f32 v67, v67, v67
    v_lshlrev_b32 v67, 16, v67
    v_mul_f32 v67, 0x3d93cd3a, v67
    v_cvt_pk_bf16_f32 v67, v67, v67
    v_lshlrev_b32 v67, 16, v67
    v_max_f32 v22, v22, v67
    s_waitcnt vmcnt(7)
    s_cmp_ge_u32 s101, 3
    s_cbranch_scc1 L_go219
    s_waitcnt vmcnt(6)
    s_cmp_ge_u32 s101, 2
    s_cbranch_scc1 L_go219
    s_waitcnt vmcnt(5)
    s_cmp_ge_u32 s101, 1
    s_cbranch_scc1 L_go219
    s_waitcnt vmcnt(4)
L_go219:
    buffer_load_dwordx4 v[140:143], v2, s[32:35], s66 offen offset:256 nt
    v_dot2_f32_bf16 v4, v108, v24, 0
    v_dot2_f32_bf16 v4, v109, v25, v4
    v_dot2_f32_bf16 v4, v110, v26, v4
    v_dot2_f32_bf16 v4, v111, v27, v4
    s_waitcnt vmcnt(7)
    s_cmp_ge_u32 s101, 3
    s_cbranch_scc1 L_go220
    s_waitcnt vmcnt(6)
    s_cmp_ge_u32 s101, 2
    s_cbranch_scc1 L_go220
    s_waitcnt vmcnt(5)
    s_cmp_ge_u32 s101, 1
    s_cbranch_scc1 L_go220
    s_waitcnt vmcnt(4)
L_go220:
    s_add_u32 s66, s79, 11
    s_and_b32 s66, s66, 31
    s_mul_i32 s66, s66, 98304
    s_add_u32 s66, s66, s75
    buffer_load_dwordx4 v[144:147], v2, s[32:35], s66 offen offset:0 nt
    v_dot2_f32_bf16 v5, v112, v28, 0
    v_dot2_f32_bf16 v5, v113, v29, v5
    v_dot2_f32_bf16 v5, v114, v30, v5
    v_dot2_f32_bf16 v5, v115, v31, v5
    s_waitcnt vmcnt(7)
    s_cmp_ge_u32 s101, 3
    s_cbranch_scc1 L_go221
    s_waitcnt vmcnt(6)
    s_cmp_ge_u32 s101, 2
    s_cbranch_scc1 L_go221
    s_waitcnt vmcnt(5)
    s_cmp_ge_u32 s101, 1
    s_cbranch_scc1 L_go221
    s_waitcnt vmcnt(4)
L_go221:
    buffer_load_dwordx4 v[148:151], v2, s[32:35], s66 offen offset:128 nt
    v_dot2_f32_bf16 v6, v116, v32, 0
    v_dot2_f32_bf16 v6, v117, v33, v6
    v_dot2_f32_bf16 v6, v118, v34, v6
    v_dot2_f32_bf16 v6, v119, v35, v6
    v_add_f32 v68, v4, v5
    s_nop 1
    v_add_f32 v68, v68, v6
    s_nop 1
    v_add_f32_dpp v68, v68, v68 quad_perm:[1,0,3,2] row_mask:0xf bank_mask:0xf
    s_nop 1
    v_add_f32_dpp v68, v68, v68 quad_perm:[2,3,0,1] row_mask:0xf bank_mask:0xf
    s_nop 1
    v_add_f32_dpp v68, v68, v68 row_half_mirror row_mask:0xf bank_mask:0xf
    v_cvt_pk_bf16_f32 v68, v68, v68
    v_lshlrev_b32 v68, 16, v68
    v_mul_f32 v68, 0x3d93cd3a, v68
    v_cvt_pk_bf16_f32 v68, v68, v68
    v_lshlrev_b32 v68, 16, v68
    v_max_f32 v22, v22, v68
    s_waitcnt vmcnt(7)
    s_cmp_ge_u32 s101, 3
    s_cbranch_scc1 L_go222
    s_waitcnt vmcnt(6)
    s_cmp_ge_u32 s101, 2
    s_cbranch_scc1 L_go222
    s_waitcnt vmcnt(5)
    s_cmp_ge_u32 s101, 1
    s_cbranch_scc1 L_go222
    s_waitcnt vmcnt(4)
L_go222:
    buffer_load_dwordx4 v[152:155], v2, s[32:35], s66 offen offset:256 nt
    v_dot2_f32_bf16 v4, v120, v24, 0
    v_dot2_f32_bf16 v4, v121, v25, v4
    v_dot2_f32_bf16 v4, v122, v26, v4
    v_dot2_f32_bf16 v4, v123, v27, v4
    s_waitcnt vmcnt(7)
    s_cmp_ge_u32 s101, 3
    s_cbranch_scc1 L_go223
    s_waitcnt vmcnt(6)
    s_cmp_ge_u32 s101, 2
    s_cbranch_scc1 L_go223
    s_waitcnt vmcnt(5)
    s_cmp_ge_u32 s101, 1
    s_cbranch_scc1 L_go223
    s_waitcnt vmcnt(4)
L_go223:
    s_add_u32 s66, s79, 12
    s_and_b32 s66, s66, 31
    s_mul_i32 s66, s66, 98304
    s_add_u32 s66, s66, s75
    buffer_load_dwordx4 v[156:159], v2, s[32:35], s66 offen offset:0 nt
    v_dot2_f32_bf16 v5, v124, v28, 0
    v_dot2_f32_bf16 v5, v125, v29, v5
    v_dot2_f32_bf16 v5, v126, v30, v5
    v_dot2_f32_bf16 v5, v127, v31, v5
    s_waitcnt vmcnt(7)
    s_cmp_ge_u32 s101, 3
    s_cbranch_scc1 L_go224
    s_waitcnt vmcnt(6)
    s_cmp_ge_u32 s101, 2
    s_cbranch_scc1 L_go224
    s_waitcnt vmcnt(5)
    s_cmp_ge_u32 s101, 1
    s_cbranch_scc1 L_go224
    s_waitcnt vmcnt(4)
L_go224:
    buffer_load_dwordx4 v[160:163], v2, s[32:35], s66 offen offset:128 nt
    v_dot2_f32_bf16 v6, v128, v32, 0
    v_dot2_f32_bf16 v6, v129, v33, v6
    v_dot2_f32_bf16 v6, v130, v34, v6
    v_dot2_f32_bf16 v6, v131, v35, v6
    v_add_f32 v69, v4, v5
    s_nop 1
    v_add_f32 v69, v69, v6
    s_nop 1
    v_add_f32_dpp v69, v69, v69 quad_perm:[1,0,3,2] row_mask:0xf bank_mask:0xf
    s_nop 1
    v_add_f32_dpp v69, v69, v69 quad_perm:[2,3,0,1] row_mask:0xf bank_mask:0xf
    s_nop 1
    v_add_f32_dpp v69, v69, v69 row_half_mirror row_mask:0xf bank_mask:0xf
    v_cvt_pk_bf16_f32 v69, v69, v69
    v_lshlrev_b32 v69, 16, v69
    v_mul_f32 v69, 0x3d93cd3a, v69
    v_cvt_pk_bf16_f32 v69, v69, v69
    v_lshlrev_b32 v69, 16, v69
    v_max_f32 v22, v22, v69
    s_waitcnt vmcnt(7)
    s_cmp_ge_u32 s101, 3
    s_cbranch_scc1 L_go225
    s_waitcnt vmcnt(6)
    s_cmp_ge_u32 s101, 2
    s_cbranch_scc1 L_go225
    s_waitcnt vmcnt(5)
    s_cmp_ge_u32 s101, 1
    s_cbranch_scc1 L_go225
    s_waitcnt vmcnt(4)
L_go225:
    buffer_load_dwordx4 v[164:167], v2, s[32:35], s66 offen offset:256 nt
    v_dot2_f32_bf16 v4, v132, v24, 0
    v_dot2_f32_bf16 v4, v133, v25, v4
    v_dot2_f32_bf16 v4, v134, v26, v4
    v_dot2_f32_bf16 v4, v135, v27, v4
    s_waitcnt vmcnt(7)
    s_cmp_ge_u32 s101, 3
    s_cbranch_scc1 L_go226
    s_waitcnt vmcnt(6)
    s_cmp_ge_u32 s101, 2
    s_cbranch_scc1 L_go226
    s_waitcnt vmcnt(5)
    s_cmp_ge_u32 s101, 1
    s_cbranch_scc1 L_go226
    s_waitcnt vmcnt(4)
L_go226:
    s_add_u32 s66, s79, 13
    s_and_b32 s66, s66, 31
    s_mul_i32 s66, s66, 98304
    s_add_u32 s66, s66, s75
    buffer_load_dwordx4 v[168:171], v2, s[32:35], s66 offen offset:0 nt
    v_dot2_f32_bf16 v5, v136, v28, 0
    v_dot2_f32_bf16 v5, v137, v29, v5
    v_dot2_f32_bf16 v5, v138, v30, v5
    v_dot2_f32_bf16 v5, v139, v31, v5
    s_waitcnt lgkmcnt(0)
    s_cmp_eq_u32 s76, 0
    s_cbranch_scc1 L_fb8b
    s_mov_b32 s23, 0
    s_min_u32 s4, s4, s20
    s_sub_u32 s4, s22, s4
    s_add_u32 s23, s23, s4
    s_min_u32 s5, s5, s20
    s_sub_u32 s5, s22, s5
    s_add_u32 s23, s23, s5
    s_min_u32 s6, s6, s20
    s_sub_u32 s6, s22, s6
    s_add_u32 s23, s23, s6
    s_min_u32 s7, s7, s20
    s_sub_u32 s7, s22, s7
    s_add_u32 s23, s23, s7
    s_min_u32 s8, s8, s20
    s_sub_u32 s8, s22, s8
    s_add_u32 s23, s23, s8
    s_min_u32 s9, s9, s20
    s_sub_u32 s9, s22, s9
    s_add_u32 s23, s23, s9
    s_min_u32 s10, s10, s20
    s_sub_u32 s10, s22, s10
    s_add_u32 s23, s23, s10
    s_min_u32 s11, s11, s20
    s_sub_u32 s11, s22, s11
    s_add_u32 s23, s23, s11
    s_min_u32 s12, s12, s20
    s_sub_u32 s12, s22, s12
    s_add_u32 s23, s23, s12
    s_min_u32 s13, s13, s20
    s_sub_u32 s13, s22, s13
    s_add_u32 s23, s23, s13
    s_min_u32 s14, s14, s20
    s_sub_u32 s14, s22, s14
    s_add_u32 s23, s23, s14
    s_min_u32 s15, s15, s20
    s_sub_u32 s15, s22, s15
    s_add_u32 s23, s23, s15
    s_min_u32 s16, s16, s20
    s_sub_u32 s16, s22, s16
    s_add_u32 s23, s23, s16
    s_min_u32 s17, s17, s20
    s_sub_u32 s17, s22, s17
    s_add_u32 s23, s23, s17
    s_min_u32 s18, s18, s20
    s_sub_u32 s18, s22, s18
    s_add_u32 s23, s23, s18
    s_min_u32 s19, s19, s20
    s_sub_u32 s19, s22, s19
    s_add_u32 s23, s23, s19
    s_ashr_i32 s23, s23, 4
    s_mov_b32 s101, 0
    s_cmp_ge_i32 s23, -60
    s_cselect_b32 s101, 1, s101
    s_cmp_ge_i32 s23, 20
    s_cselect_b32 s101, 2, s101
    s_cmp_ge_i32 s23, 100
    s_cselect_b32 s101, 3, s101
L_fb8b:
    s_nop 2
    v_readfirstlane_b32 s76, v255
    s_waitcnt vmcnt(7)
    s_cmp_ge_u32 s101, 3
    s_cbranch_scc1 L_go227
    s_waitcnt vmcnt(6)
    s_cmp_ge_u32 s101, 2
    s_cbranch_scc1 L_go227
    s_waitcnt vmcnt(5)
    s_cmp_ge_u32 s101, 1
    s_cbranch_scc1 L_go227
    s_waitcnt vmcnt(4)
L_go227:
    buffer_load_dwordx4 v[172:175], v2, s[32:35], s66 offen offset:128 nt
    v_dot2_f32_bf16 v6, v140, v32, 0
    v_dot2_f32_bf16 v6, v141, v33, v6
    v_dot2_f32_bf16 v6, v142, v34, v6
    v_dot2_f32_bf16 v6, v143, v35, v6
    v_add_f32 v70, v4, v5
    s_nop 1
    v_add_f32 v70, v70, v6
    s_nop 1
    v_add_f32_dpp v70, v70, v70 quad_perm:[1,0,3,2] row_mask:0xf bank_mask:0xf
    s_nop 1
    v_add_f32_dpp v70, v70, v70 quad_perm:[2,3,0,1] row_mask:0xf bank_mask:0xf
    s_nop 1
    v_add_f32_dpp v70, v70, v70 row_half_mirror row_mask:0xf bank_mask:0xf
    v_cvt_pk_bf16_f32 v70, v70, v70
    v_lshlrev_b32 v70, 16, v70
    v_mul_f32 v70, 0x3d93cd3a, v70
    v_cvt_pk_bf16_f32 v70, v70, v70
    v_lshlrev_b32 v70, 16, v70
    v_max_f32 v22, v22, v70
    s_waitcnt vmcnt(7)
    s_cmp_ge_u32 s101, 3
    s_cbranch_scc1 L_go228
    s_waitcnt vmcnt(6)
    s_cmp_ge_u32 s101, 2
    s_cbranch_scc1 L_go228
    s_waitcnt vmcnt(5)
    s_cmp_ge_u32 s101, 1
    s_cbranch_scc1 L_go228
    s_waitcnt vmcnt(4)
L_go228:
    buffer_load_dwordx4 v[176:179], v2, s[32:35], s66 offen offset:256 nt
    v_dot2_f32_bf16 v4, v144, v24, 0
    v_dot2_f32_bf16 v4, v145, v25, v4
    v_dot2_f32_bf16 v4, v146, v26, v4
    v_dot2_f32_bf16 v4, v147, v27, v4
    s_waitcnt vmcnt(7)
    s_cmp_ge_u32 s101, 3
    s_cbranch_scc1 L_go229
    s_waitcnt vmcnt(6)
    s_cmp_ge_u32 s101, 2
    s_cbranch_scc1 L_go229
    s_waitcnt vmcnt(5)
    s_cmp_ge_u32 s101, 1
    s_cbranch_scc1 L_go229
    s_waitcnt vmcnt(4)
L_go229:
    s_add_u32 s66, s79, 14
    s_and_b32 s66, s66, 31
    s_mul_i32 s66, s66, 98304
    s_add_u32 s66, s66, s75
    buffer_load_dwordx4 v[180:183], v2, s[32:35], s66 offen offset:0 nt
    v_dot2_f32_bf16 v5, v148, v28, 0
    v_dot2_f32_bf16 v5, v149, v29, v5
    v_dot2_f32_bf16 v5, v150, v30, v5
    v_dot2_f32_bf16 v5, v151, v31, v5
    s_waitcnt vmcnt(7)
    s_cmp_ge_u32 s101, 3
    s_cbranch_scc1 L_go230
    s_waitcnt vmcnt(6)
    s_cmp_ge_u32 s101, 2
    s_cbranch_scc1 L_go230
    s_waitcnt vmcnt(5)
    s_cmp_ge_u32 s101, 1
    s_cbranch_scc1 L_go230
    s_waitcnt vmcnt(4)
L_go230:
    buffer_load_dwordx4 v[184:187], v2, s[32:35], s66 offen offset:128 nt
    v_dot2_f32_bf16 v6, v152, v32, 0
    v_dot2_f32_bf16 v6, v153, v33, v6
    v_dot2_f32_bf16 v6, v154, v34, v6
    v_dot2_f32_bf16 v6, v155, v35, v6
    v_add_f32 v71, v4, v5
    s_nop 1
    v_add_f32 v71, v71, v6
    s_nop 1
    v_add_f32_dpp v71, v71, v71 quad_perm:[1,0,3,2] row_mask:0xf bank_mask:0xf
    s_nop 1
    v_add_f32_dpp v71, v71, v71 quad_perm:[2,3,0,1] row_mask:0xf bank_mask:0xf
    s_nop 1
    v_add_f32_dpp v71, v71, v71 row_half_mirror row_mask:0xf bank_mask:0xf
    v_cvt_pk_bf16_f32 v71, v71, v71
    v_lshlrev_b32 v71, 16, v71
    v_mul_f32 v71, 0x3d93cd3a, v71
    v_cvt_pk_bf16_f32 v71, v71, v71
    v_lshlrev_b32 v71, 16, v71
    v_max_f32 v22, v22, v71
    s_waitcnt vmcnt(7)
    s_cmp_ge_u32 s101, 3
    s_cbranch_scc1 L_go231
    s_waitcnt vmcnt(6)
    s_cmp_ge_u32 s101, 2
    s_cbranch_scc1 L_go231
    s_waitcnt vmcnt(5)
    s_cmp_ge_u32 s101, 1
    s_cbranch_scc1 L_go231
    s_waitcnt vmcnt(4)
L_go231:
    buffer_load_dwordx4 v[188:191], v2, s[32:35], s66 offen offset:256 nt
    v_dot2_f32_bf16 v4, v156, v24, 0
    v_dot2_f32_bf16 v4, v157, v25, v4
    v_dot2_f32_bf16 v4, v158, v26, v4
    v_dot2_f32_bf16 v4, v159, v27, v4
    s_waitcnt vmcnt(7)
    s_cmp_ge_u32 s101, 3
    s_cbranch_scc1 L_go232
    s_waitcnt vmcnt(6)
    s_cmp_ge_u32 s101, 2
    s_cbranch_scc1 L_go232
    s_waitcnt vmcnt(5)
    s_cmp_ge_u32 s101, 1
    s_cbranch_scc1 L_go232
    s_waitcnt vmcnt(4)
L_go232:
    s_add_u32 s66, s79, 15
    s_and_b32 s66, s66, 31
    s_mul_i32 s66, s66, 98304
    s_add_u32 s66, s66, s75
    buffer_load_dwordx4 v[192:195], v2, s[32:35], s66 offen offset:0 nt
    v_dot2_f32_bf16 v5, v160, v28, 0
    v_dot2_f32_bf16 v5, v161, v29, v5
    v_dot2_f32_bf16 v5, v162, v30, v5
    v_dot2_f32_bf16 v5, v163, v31, v5
    s_waitcnt vmcnt(7)
    s_cmp_ge_u32 s101, 3
    s_cbranch_scc1 L_go233
    s_waitcnt vmcnt(6)
    s_cmp_ge_u32 s101, 2
    s_cbranch_scc1 L_go233
    s_waitcnt vmcnt(5)
    s_cmp_ge_u32 s101, 1
    s_cbranch_scc1 L_go233
    s_waitcnt vmcnt(4)
L_go233:
    buffer_load_dwordx4 v[196:199], v2, s[32:35], s66 offen offset:128 nt
    v_dot2_f32_bf16 v6, v164, v32, 0
    v_dot2_f32_bf16 v6, v165, v33, v6
    v_dot2_f32_bf16 v6, v166, v34, v6
    v_dot2_f32_bf16 v6, v167, v35, v6
    v_add_f32 v72, v4, v5
    s_nop 1
    v_add_f32 v72, v72, v6
    s_nop 1
    v_add_f32_dpp v72, v72, v72 quad_perm:[1,0,3,2] row_mask:0xf bank_mask:0xf
    s_nop 1
    v_add_f32_dpp v72, v72, v72 quad_perm:[2,3,0,1] row_mask:0xf bank_mask:0xf
    s_nop 1
    v_add_f32_dpp v72, v72, v72 row_half_mirror row_mask:0xf bank_mask:0xf
    v_cvt_pk_bf16_f32 v72, v72, v72
    v_lshlrev_b32 v72, 16, v72
    v_mul_f32 v72, 0x3d93cd3a, v72
    v_cvt_pk_bf16_f32 v72, v72, v72
    v_lshlrev_b32 v72, 16, v72
    v_max_f32 v22, v22, v72
    s_waitcnt vmcnt(7)
    s_cmp_ge_u32 s101, 3
    s_cbranch_scc1 L_go234
    s_waitcnt vmcnt(6)
    s_cmp_ge_u32 s101, 2
    s_cbranch_scc1 L_go234
    s_waitcnt vmcnt(5)
    s_cmp_ge_u32 s101, 1
    s_cbranch_scc1 L_go234
    s_waitcnt vmcnt(4)
L_go234:
    buffer_load_dwordx4 v[200:203], v2, s[32:35], s66 offen offset:256 nt
    v_dot2_f32_bf16 v4, v168, v24, 0
    v_dot2_f32_bf16 v4, v169, v25, v4
    v_dot2_f32_bf16 v4, v170, v26, v4
    v_dot2_f32_bf16 v4, v171, v27, v4
    s_waitcnt vmcnt(7)
    s_cmp_ge_u32 s101, 3
    s_cbranch_scc1 L_go235
    s_waitcnt vmcnt(6)
    s_cmp_ge_u32 s101, 2
    s_cbranch_scc1 L_go235
    s_waitcnt vmcnt(5)
    s_cmp_ge_u32 s101, 1
    s_cbranch_scc1 L_go235
    s_waitcnt vmcnt(4)
L_go235:
    s_add_u32 s66, s79, 16
    s_and_b32 s66, s66, 31
    s_mul_i32 s66, s66, 98304
    s_add_u32 s66, s66, s75
    buffer_load_dwordx4 v[204:207], v2, s[32:35], s66 offen offset:0 nt
    v_dot2_f32_bf16 v5, v172, v28, 0
    v_dot2_f32_bf16 v5, v173, v29, v5
    v_dot2_f32_bf16 v5, v174, v30, v5
    v_dot2_f32_bf16 v5, v175, v31, v5
    s_mov_b32 s22, s20
    s_memrealtime s[20:21]
    s_waitcnt vmcnt(7)
    s_cmp_ge_u32 s101, 3
    s_cbranch_scc1 L_go236
    s_waitcnt vmcnt(6)
    s_cmp_ge_u32 s101, 2
    s_cbranch_scc1 L_go236
    s_waitcnt vmcnt(5)
    s_cmp_ge_u32 s101, 1
    s_cbranch_scc1 L_go236
    s_waitcnt vmcnt(4)
L_go236:
    buffer_load_dwordx4 v[208:211], v2, s[32:35], s66 offen offset:128 nt
    v_dot2_f32_bf16 v6, v176, v32, 0
    v_dot2_f32_bf16 v6, v177, v33, v6
    v_dot2_f32_bf16 v6, v178, v34, v6
    v_dot2_f32_bf16 v6, v179, v35, v6
    s_waitcnt lgkmcnt(0)
    v_mov_b32 v254, s20
    s_mov_b32 s70, 984192
    buffer_store_dword v254, v253, s[56:59], s70 offen sc1
    s_cmp_eq_u32 s76, 0
    s_cbranch_scc1 L_fb9a
    s_load_dwordx16 s[4:19], s[24:25], 984064
L_fb9a:
    ds_read_b32 v255, v3 offset:8
    v_add_f32 v73, v4, v5
    v_add_f32 v73, v73, v6
    s_nop 1
    v_add_f32_dpp v73, v73, v73 quad_perm:[1,0,3,2] row_mask:0xf bank_mask:0xf
    s_nop 1
    v_add_f32_dpp v73, v73, v73 quad_perm:[2,3,0,1] row_mask:0xf bank_mask:0xf
    s_nop 1
    v_add_f32_dpp v73, v73, v73 row_half_mirror row_mask:0xf bank_mask:0xf
    v_cvt_pk_bf16_f32 v73, v73, v73
    v_lshlrev_b32 v73, 16, v73
    v_mul_f32 v73, 0x3d93cd3a, v73
    v_cvt_pk_bf16_f32 v73, v73, v73
    v_lshlrev_b32 v73, 16, v73
    v_max_f32 v22, v22, v73
    s_waitcnt vmcnt(7)
    s_cmp_ge_u32 s101, 3
    s_cbranch_scc1 L_go237
    s_waitcnt vmcnt(6)
    s_cmp_ge_u32 s101, 2
    s_cbranch_scc1 L_go237
    s_waitcnt vmcnt(5)
    s_cmp_ge_u32 s101, 1
    s_cbranch_scc1 L_go237
    s_waitcnt vmcnt(4)
L_go237:
    buffer_load_dwordx4 v[212:215], v2, s[32:35], s66 offen offset:256 nt
    v_dot2_f32_bf16 v4, v180, v24, 0
    v_dot2_f32_bf16 v4, v181, v25, v4
    v_dot2_f32_bf16 v4, v182, v26, v4
    v_dot2_f32_bf16 v4, v183, v27, v4
    s_waitcnt vmcnt(7)
    s_cmp_ge_u32 s101, 3
    s_cbranch_scc1 L_go238
    s_waitcnt vmcnt(6)
    s_cmp_ge_u32 s101, 2
    s_cbranch_scc1 L_go238
    s_waitcnt vmcnt(5)
    s_cmp_ge_u32 s101, 1
    s_cbranch_scc1 L_go238
    s_waitcnt vmcnt(4)
L_go238:
    s_add_u32 s66, s79, 17
    s_and_b32 s66, s66, 31
    s_mul_i32 s66, s66, 98304
    s_add_u32 s66, s66, s75
    buffer_load_dwordx4 v[216:219], v2, s[32:35], s66 offen offset:0 nt
    v_dot2_f32_bf16 v5, v184, v28, 0
    v_dot2_f32_bf16 v5, v185, v29, v5
    v_dot2_f32_bf16 v5, v186, v30, v5
    v_dot2_f32_bf16 v5, v187, v31, v5
    s_waitcnt vmcnt(7)
    s_cmp_ge_u32 s101, 3
    s_cbranch_scc1 L_go239
    s_waitcnt vmcnt(6)
    s_cmp_ge_u32 s101, 2
    s_cbranch_scc1 L_go239
    s_waitcnt vmcnt(5)
    s_cmp_ge_u32 s101, 1
    s_cbranch_scc1 L_go239
    s_waitcnt vmcnt(4)
L_go239:
    buffer_load_dwordx4 v[220:223], v2, s[32:35], s66 offen offset:128 nt
    v_dot2_f32_bf16 v6, v188, v32, 0
    v_dot2_f32_bf16 v6, v189, v33, v6
    v_dot2_f32_bf16 v6, v190, v34, v6
    v_dot2_f32_bf16 v6, v191, v35, v6
    v_add_f32 v74, v4, v5
    s_nop 1
    v_add_f32 v74, v74, v6
    s_nop 1
    v_add_f32_dpp v74, v74, v74 quad_perm:[1,0,3,2] row_mask:0xf bank_mask:0xf
    s_nop 1
    v_add_f32_dpp v74, v74, v74 quad_perm:[2,3,0,1] row_mask:0xf bank_mask:0xf
    s_nop 1
    v_add_f32_dpp v74, v74, v74 row_half_mirror row_mask:0xf bank_mask:0xf
    v_cvt_pk_bf16_f32 v74, v74, v74
    v_lshlrev_b32 v74, 16, v74
    v_mul_f32 v74, 0x3d93cd3a, v74
    v_cvt_pk_bf16_f32 v74, v74, v74
    v_lshlrev_b32 v74, 16, v74
    v_max_f32 v22, v22, v74
    s_waitcnt vmcnt(7)
    s_cmp_ge_u32 s101, 3
    s_cbranch_scc1 L_go240
    s_waitcnt vmcnt(6)
    s_cmp_ge_u32 s101, 2
    s_cbranch_scc1 L_go240
    s_waitcnt vmcnt(5)
    s_cmp_ge_u32 s101, 1
    s_cbranch_scc1 L_go240
    s_waitcnt vmcnt(4)
L_go240:
    buffer_load_dwordx4 v[224:227], v2, s[32:35], s66 offen offset:256 nt
    v_dot2_f32_bf16 v4, v192, v24, 0
    v_dot2_f32_bf16 v4, v193, v25, v4
    v_dot2_f32_bf16 v4, v194, v26, v4
    v_dot2_f32_bf16 v4, v195, v27, v4
    s_waitcnt vmcnt(7)
    s_cmp_ge_u32 s101, 3
    s_cbranch_scc1 L_go241
    s_waitcnt vmcnt(6)
    s_cmp_ge_u32 s101, 2
    s_cbranch_scc1 L_go241
    s_waitcnt vmcnt(5)
    s_cmp_ge_u32 s101, 1
    s_cbranch_scc1 L_go241
    s_waitcnt vmcnt(4)
L_go241:
    s_add_u32 s66, s79, 18
    s_and_b32 s66, s66, 31
    s_mul_i32 s66, s66, 98304
    s_add_u32 s66, s66, s75
    buffer_load_dwordx4 v[228:231], v2, s[32:35], s66 offen offset:0 nt
    v_dot2_f32_bf16 v5, v196, v28, 0
    v_dot2_f32_bf16 v5, v197, v29, v5
    v_dot2_f32_bf16 v5, v198, v30, v5
    v_dot2_f32_bf16 v5, v199, v31, v5
    s_waitcnt vmcnt(7)
    s_cmp_ge_u32 s101, 3
    s_cbranch_scc1 L_go242
    s_waitcnt vmcnt(6)
    s_cmp_ge_u32 s101, 2
    s_cbranch_scc1 L_go242
    s_waitcnt vmcnt(5)
    s_cmp_ge_u32 s101, 1
    s_cbranch_scc1 L_go242
    s_waitcnt vmcnt(4)
L_go242:
    buffer_load_dwordx4 v[232:235], v2, s[32:35], s66 offen offset:128 nt
    v_dot2_f32_bf16 v6, v200, v32, 0
    v_dot2_f32_bf16 v6, v201, v33, v6
    v_dot2_f32_bf16 v6, v202, v34, v6
    v_dot2_f32_bf16 v6, v203, v35, v6
    v_add_f32 v75, v4, v5
    s_nop 1
    v_add_f32 v75, v75, v6
    s_nop 1
    v_add_f32_dpp v75, v75, v75 quad_perm:[1,0,3,2] row_mask:0xf bank_mask:0xf
    s_nop 1
    v_add_f32_dpp v75, v75, v75 quad_perm:[2,3,0,1] row_mask:0xf bank_mask:0xf
    s_nop 1
    v_add_f32_dpp v75, v75, v75 row_half_mirror row_mask:0xf bank_mask:0xf
    v_cvt_pk_bf16_f32 v75, v75, v75
    v_lshlrev_b32 v75, 16, v75
    v_mul_f32 v75, 0x3d93cd3a, v75
    v_cvt_pk_bf16_f32 v75, v75, v75
    v_lshlrev_b32 v75, 16, v75
    v_max_f32 v22, v22, v75
    s_waitcnt vmcnt(7)
    s_cmp_ge_u32 s101, 3
    s_cbranch_scc1 L_go243
    s_waitcnt vmcnt(6)
    s_cmp_ge_u32 s101, 2
    s_cbranch_scc1 L_go243
    s_waitcnt vmcnt(5)
    s_cmp_ge_u32 s101, 1
    s_cbranch_scc1 L_go243
    s_waitcnt vmcnt(4)
L_go243:
    buffer_load_dwordx4 v[236:239], v2, s[32:35], s66 offen offset:256 nt
    v_dot2_f32_bf16 v4, v204, v24, 0
    v_dot2_f32_bf16 v4, v205, v25, v4
    v_dot2_f32_bf16 v4, v206, v26, v4
    v_dot2_f32_bf16 v4, v207, v27, v4
    s_waitcnt vmcnt(7)
    s_cmp_ge_u32 s101, 3
    s_cbranch_scc1 L_go244
    s_waitcnt vmcnt(6)
    s_cmp_ge_u32 s101, 2
    s_cbranch_scc1 L_go244
    s_waitcnt vmcnt(5)
    s_cmp_ge_u32 s101, 1
    s_cbranch_scc1 L_go244
    s_waitcnt vmcnt(4)
L_go244:
    s_add_u32 s66, s79, 19
    s_and_b32 s66, s66, 31
    s_mul_i32 s66, s66, 98304
    s_add_u32 s66, s66, s75
    buffer_load_dwordx4 v[240:243], v2, s[32:35], s66 offen offset:0 nt
    v_dot2_f32_bf16 v5, v208, v28, 0
    v_dot2_f32_bf16 v5, v209, v29, v5
    v_dot2_f32_bf16 v5, v210, v30, v5
    v_dot2_f32_bf16 v5, v211, v31, v5
    s_waitcnt lgkmcnt(0)
    s_cmp_eq_u32 s76, 0
    s_cbranch_scc1 L_fb9b
    s_mov_b32 s23, 0
    s_min_u32 s4, s4, s20
    s_sub_u32 s4, s22, s4
    s_add_u32 s23, s23, s4
    s_min_u32 s5, s5, s20
    s_sub_u32 s5, s22, s5
    s_add_u32 s23, s23, s5
    s_min_u32 s6, s6, s20
    s_sub_u32 s6, s22, s6
    s_add_u32 s23, s23, s6
    s_min_u32 s7, s7, s20
    s_sub_u32 s7, s22, s7
    s_add_u32 s23, s23, s7
    s_min_u32 s8, s8, s20
    s_sub_u32 s8, s22, s8
    s_add_u32 s23, s23, s8
    s_min_u32 s9, s9, s20
    s_sub_u32 s9, s22, s9
    s_add_u32 s23, s23, s9
    s_min_u32 s10, s10, s20
    s_sub_u32 s10, s22, s10
    s_add_u32 s23, s23, s10
    s_min_u32 s11, s11, s20
    s_sub_u32 s11, s22, s11
    s_add_u32 s23, s23, s11
    s_min_u32 s12, s12, s20
    s_sub_u32 s12, s22, s12
    s_add_u32 s23, s23, s12
    s_min_u32 s13, s13, s20
    s_sub_u32 s13, s22, s13
    s_add_u32 s23, s23, s13
    s_min_u32 s14, s14, s20
    s_sub_u32 s14, s22, s14
    s_add_u32 s23, s23, s14
    s_min_u32 s15, s15, s20
    s_sub_u32 s15, s22, s15
    s_add_u32 s23, s23, s15
    s_min_u32 s16, s16, s20
    s_sub_u32 s16, s22, s16
    s_add_u32 s23, s23, s16
    s_min_u32 s17, s17, s20
    s_sub_u32 s17, s22, s17
    s_add_u32 s23, s23, s17
    s_min_u32 s18, s18, s20
    s_sub_u32 s18, s22, s18
    s_add_u32 s23, s23, s18
    s_min_u32 s19, s19, s20
    s_sub_u32 s19, s22, s19
    s_add_u32 s23, s23, s19
    s_ashr_i32 s23, s23, 4
    s_mov_b32 s101, 0
    s_cmp_ge_i32 s23, -60
    s_cselect_b32 s101, 1, s101
    s_cmp_ge_i32 s23, 20
    s_cselect_b32 s101, 2, s101
    s_cmp_ge_i32 s23, 100
    s_cselect_b32 s101, 3, s101
L_fb9b:
    s_nop 2
    v_readfirstlane_b32 s76, v255
    s_waitcnt vmcnt(7)
    s_cmp_ge_u32 s101, 3
    s_cbranch_scc1 L_go245
    s_waitcnt vmcnt(6)
    s_cmp_ge_u32 s101, 2
    s_cbranch_scc1 L_go245
    s_waitcnt vmcnt(5)
    s_cmp_ge_u32 s101, 1
    s_cbranch_scc1 L_go245
    s_waitcnt vmcnt(4)
L_go245:
    buffer_load_dwordx4 v[244:247], v2, s[32:35], s66 offen offset:128 nt
    v_dot2_f32_bf16 v6, v212, v32, 0
    v_dot2_f32_bf16 v6, v213, v33, v6
    v_dot2_f32_bf16 v6, v214, v34, v6
    v_dot2_f32_bf16 v6, v215, v35, v6
    v_add_f32 v76, v4, v5
    s_nop 1
    v_add_f32 v76, v76, v6
    s_nop 1
    v_add_f32_dpp v76, v76, v76 quad_perm:[1,0,3,2] row_mask:0xf bank_mask:0xf
    s_nop 1
    v_add_f32_dpp v76, v76, v76 quad_perm:[2,3,0,1] row_mask:0xf bank_mask:0xf
    s_nop 1
    v_add_f32_dpp v76, v76, v76 row_half_mirror row_mask:0xf bank_mask:0xf
    v_cvt_pk_bf16_f32 v76, v76, v76
    v_lshlrev_b32 v76, 16, v76
    v_mul_f32 v76, 0x3d93cd3a, v76
    v_cvt_pk_bf16_f32 v76, v76, v76
    v_lshlrev_b32 v76, 16, v76
    v_max_f32 v22, v22, v76
    s_waitcnt vmcnt(7)
    s_cmp_ge_u32 s101, 3
    s_cbranch_scc1 L_go246
    s_waitcnt vmcnt(6)
    s_cmp_ge_u32 s101, 2
    s_cbranch_scc1 L_go246
    s_waitcnt vmcnt(5)
    s_cmp_ge_u32 s101, 1
    s_cbranch_scc1 L_go246
    s_waitcnt vmcnt(4)
L_go246:
    buffer_load_dwordx4 v[248:251], v2, s[32:35], s66 offen offset:256 nt
    v_dot2_f32_bf16 v4, v216, v24, 0
    v_dot2_f32_bf16 v4, v217, v25, v4
    v_dot2_f32_bf16 v4, v218, v26, v4
    v_dot2_f32_bf16 v4, v219, v27, v4
    s_waitcnt vmcnt(7)
    s_cmp_ge_u32 s101, 3
    s_cbranch_scc1 L_go247
    s_waitcnt vmcnt(6)
    s_cmp_ge_u32 s101, 2
    s_cbranch_scc1 L_go247
    s_waitcnt vmcnt(5)
    s_cmp_ge_u32 s101, 1
    s_cbranch_scc1 L_go247
    s_waitcnt vmcnt(4)
L_go247:
    s_add_u32 s66, s79, 20
    s_and_b32 s66, s66, 31
    s_mul_i32 s66, s66, 98304
    s_add_u32 s66, s66, s75
    buffer_load_dwordx4 v[92:95], v2, s[32:35], s66 offen offset:0 nt
    v_dot2_f32_bf16 v5, v220, v28, 0
    v_dot2_f32_bf16 v5, v221, v29, v5
    v_dot2_f32_bf16 v5, v222, v30, v5
    v_dot2_f32_bf16 v5, v223, v31, v5
    s_waitcnt vmcnt(7)
    s_cmp_ge_u32 s101, 3
    s_cbranch_scc1 L_go248
    s_waitcnt vmcnt(6)
    s_cmp_ge_u32 s101, 2
    s_cbranch_scc1 L_go248
    s_waitcnt vmcnt(5)
    s_cmp_ge_u32 s101, 1
    s_cbranch_scc1 L_go248
    s_waitcnt vmcnt(4)
L_go248:
    buffer_load_dwordx4 v[96:99], v2, s[32:35], s66 offen offset:128 nt
    v_dot2_f32_bf16 v6, v224, v32, 0
    v_dot2_f32_bf16 v6, v225, v33, v6
    v_dot2_f32_bf16 v6, v226, v34, v6
    v_dot2_f32_bf16 v6, v227, v35, v6
    v_add_f32 v77, v4, v5
    s_nop 1
    v_add_f32 v77, v77, v6
    s_nop 1
    v_add_f32_dpp v77, v77, v77 quad_perm:[1,0,3,2] row_mask:0xf bank_mask:0xf
    s_nop 1
    v_add_f32_dpp v77, v77, v77 quad_perm:[2,3,0,1] row_mask:0xf bank_mask:0xf
    s_nop 1
    v_add_f32_dpp v77, v77, v77 row_half_mirror row_mask:0xf bank_mask:0xf
    v_cvt_pk_bf16_f32 v77, v77, v77
    v_lshlrev_b32 v77, 16, v77
    v_mul_f32 v77, 0x3d93cd3a, v77
    v_cvt_pk_bf16_f32 v77, v77, v77
    v_lshlrev_b32 v77, 16, v77
    v_max_f32 v22, v22, v77
    s_waitcnt vmcnt(7)
    s_cmp_ge_u32 s101, 3
    s_cbranch_scc1 L_go249
    s_waitcnt vmcnt(6)
    s_cmp_ge_u32 s101, 2
    s_cbranch_scc1 L_go249
    s_waitcnt vmcnt(5)
    s_cmp_ge_u32 s101, 1
    s_cbranch_scc1 L_go249
    s_waitcnt vmcnt(4)
L_go249:
    buffer_load_dwordx4 v[100:103], v2, s[32:35], s66 offen offset:256 nt
    v_dot2_f32_bf16 v4, v228, v24, 0
    v_dot2_f32_bf16 v4, v229, v25, v4
    v_dot2_f32_bf16 v4, v230, v26, v4
    v_dot2_f32_bf16 v4, v231, v27, v4
    s_waitcnt vmcnt(7)
    s_cmp_ge_u32 s101, 3
    s_cbranch_scc1 L_go250
    s_waitcnt vmcnt(6)
    s_cmp_ge_u32 s101, 2
    s_cbranch_scc1 L_go250
    s_waitcnt vmcnt(5)
    s_cmp_ge_u32 s101, 1
    s_cbranch_scc1 L_go250
    s_waitcnt vmcnt(4)
L_go250:
    s_add_u32 s66, s79, 21
    s_and_b32 s66, s66, 31
    s_mul_i32 s66, s66, 98304
    s_add_u32 s66, s66, s75
    buffer_load_dwordx4 v[104:107], v2, s[32:35], s66 offen offset:0 nt
    v_dot2_f32_bf16 v5, v232, v28, 0
    v_dot2_f32_bf16 v5, v233, v29, v5
    v_dot2_f32_bf16 v5, v234, v30, v5
    v_dot2_f32_bf16 v5, v235, v31, v5
    s_waitcnt vmcnt(7)
    s_cmp_ge_u32 s101, 3
    s_cbranch_scc1 L_go251
    s_waitcnt vmcnt(6)
    s_cmp_ge_u32 s101, 2
    s_cbranch_scc1 L_go251
    s_waitcnt vmcnt(5)
    s_cmp_ge_u32 s101, 1
    s_cbranch_scc1 L_go251
    s_waitcnt vmcnt(4)
L_go251:
    buffer_load_dwordx4 v[108:111], v2, s[32:35], s66 offen offset:128 nt
    v_dot2_f32_bf16 v6, v236, v32, 0
    v_dot2_f32_bf16 v6, v237, v33, v6
    v_dot2_f32_bf16 v6, v238, v34, v6
    v_dot2_f32_bf16 v6, v239, v35, v6
    v_add_f32 v78, v4, v5
    s_nop 1
    v_add_f32 v78, v78, v6
    s_nop 1
    v_add_f32_dpp v78, v78, v78 quad_perm:[1,0,3,2] row_mask:0xf bank_mask:0xf
    s_nop 1
    v_add_f32_dpp v78, v78, v78 quad_perm:[2,3,0,1] row_mask:0xf bank_mask:0xf
    s_nop 1
    v_add_f32_dpp v78, v78, v78 row_half_mirror row_mask:0xf bank_mask:0xf
    v_cvt_pk_bf16_f32 v78, v78, v78
    v_lshlrev_b32 v78, 16, v78
    v_mul_f32 v78, 0x3d93cd3a, v78
    v_cvt_pk_bf16_f32 v78, v78, v78
    v_lshlrev_b32 v78, 16, v78
    v_max_f32 v22, v22, v78
    s_waitcnt vmcnt(7)
    s_cmp_ge_u32 s101, 3
    s_cbranch_scc1 L_go252
    s_waitcnt vmcnt(6)
    s_cmp_ge_u32 s101, 2
    s_cbranch_scc1 L_go252
    s_waitcnt vmcnt(5)
    s_cmp_ge_u32 s101, 1
    s_cbranch_scc1 L_go252
    s_waitcnt vmcnt(4)
L_go252:
    buffer_load_dwordx4 v[112:115], v2, s[32:35], s66 offen offset:256 nt
    v_dot2_f32_bf16 v4, v240, v24, 0
    v_dot2_f32_bf16 v4, v241, v25, v4
    v_dot2_f32_bf16 v4, v242, v26, v4
    v_dot2_f32_bf16 v4, v243, v27, v4
    s_waitcnt vmcnt(7)
    s_cmp_ge_u32 s101, 3
    s_cbranch_scc1 L_go253
    s_waitcnt vmcnt(6)
    s_cmp_ge_u32 s101, 2
    s_cbranch_scc1 L_go253
    s_waitcnt vmcnt(5)
    s_cmp_ge_u32 s101, 1
    s_cbranch_scc1 L_go253
    s_waitcnt vmcnt(4)
L_go253:
    s_add_u32 s66, s79, 22
    s_and_b32 s66, s66, 31
    s_mul_i32 s66, s66, 98304
    s_add_u32 s66, s66, s75
    buffer_load_dwordx4 v[116:119], v2, s[32:35], s66 offen offset:0 nt
    v_dot2_f32_bf16 v5, v244, v28, 0
    v_dot2_f32_bf16 v5, v245, v29, v5
    v_dot2_f32_bf16 v5, v246, v30, v5
    v_dot2_f32_bf16 v5, v247, v31, v5
    s_mov_b32 s22, s20
    s_memrealtime s[20:21]
    s_waitcnt vmcnt(7)
    s_cmp_ge_u32 s101, 3
    s_cbranch_scc1 L_go254
    s_waitcnt vmcnt(6)
    s_cmp_ge_u32 s101, 2
    s_cbranch_scc1 L_go254
    s_waitcnt vmcnt(5)
    s_cmp_ge_u32 s101, 1
    s_cbranch_scc1 L_go254
    s_waitcnt vmcnt(4)
L_go254:
    buffer_load_dwordx4 v[120:123], v2, s[32:35], s66 offen offset:128 nt
    v_dot2_f32_bf16 v6, v248, v32, 0
    v_dot2_f32_bf16 v6, v249, v33, v6
    v_dot2_f32_bf16 v6, v250, v34, v6
    v_dot2_f32_bf16 v6, v251, v35, v6
    s_waitcnt lgkmcnt(0)
    v_mov_b32 v254, s20
    s_mov_b32 s70, 984320
    buffer_store_dword v254, v253, s[56:59], s70 offen sc1
    s_cmp_eq_u32 s76, 0
    s_cbranch_scc1 L_fb10a
    s_load_dwordx16 s[4:19], s[24:25], 984192
L_fb10a:
    ds_read_b32 v255, v3 offset:8
    v_add_f32 v79, v4, v5
    v_add_f32 v79, v79, v6
    s_nop 1
    v_add_f32_dpp v79, v79, v79 quad_perm:[1,0,3,2] row_mask:0xf bank_mask:0xf
    s_nop 1
    v_add_f32_dpp v79, v79, v79 quad_perm:[2,3,0,1] row_mask:0xf bank_mask:0xf
    s_nop 1
    v_add_f32_dpp v79, v79, v79 row_half_mirror row_mask:0xf bank_mask:0xf
    v_cvt_pk_bf16_f32 v79, v79, v79
    v_lshlrev_b32 v79, 16, v79
    v_mul_f32 v79, 0x3d93cd3a, v79
    v_cvt_pk_bf16_f32 v79, v79, v79
    v_lshlrev_b32 v79, 16, v79
    v_max_f32 v22, v22, v79
    s_waitcnt vmcnt(7)
    s_cmp_ge_u32 s101, 3
    s_cbranch_scc1 L_go255
    s_waitcnt vmcnt(6)
    s_cmp_ge_u32 s101, 2
    s_cbranch_scc1 L_go255
    s_waitcnt vmcnt(5)
    s_cmp_ge_u32 s101, 1
    s_cbranch_scc1 L_go255
    s_waitcnt vmcnt(4)
L_go255:
    buffer_load_dwordx4 v[124:127], v2, s[32:35], s66 offen offset:256 nt
    v_dot2_f32_bf16 v4, v92, v24, 0
    v_dot2_f32_bf16 v4, v93, v25, v4
    v_dot2_f32_bf16 v4, v94, v26, v4
    v_dot2_f32_bf16 v4, v95, v27, v4
    s_waitcnt vmcnt(7)
    s_cmp_ge_u32 s101, 3
    s_cbranch_scc1 L_go256
    s_waitcnt vmcnt(6)
    s_cmp_ge_u32 s101, 2
    s_cbranch_scc1 L_go256
    s_waitcnt vmcnt(5)
    s_cmp_ge_u32 s101, 1
    s_cbranch_scc1 L_go256
    s_waitcnt vmcnt(4)
L_go256:
    s_add_u32 s66, s79, 23
    s_and_b32 s66, s66, 31
    s_mul_i32 s66, s66, 98304
    s_add_u32 s66, s66, s75
    buffer_load_dwordx4 v[128:131], v2, s[32:35], s66 offen offset:0 nt
    v_dot2_f32_bf16 v5, v96, v28, 0
    v_dot2_f32_bf16 v5, v97, v29, v5
    v_dot2_f32_bf16 v5, v98, v30, v5
    v_dot2_f32_bf16 v5, v99, v31, v5
    s_waitcnt vmcnt(7)
    s_cmp_ge_u32 s101, 3
    s_cbranch_scc1 L_go257
    s_waitcnt vmcnt(6)
    s_cmp_ge_u32 s101, 2
    s_cbranch_scc1 L_go257
    s_waitcnt vmcnt(5)
    s_cmp_ge_u32 s101, 1
    s_cbranch_scc1 L_go257
    s_waitcnt vmcnt(4)
L_go257:
    buffer_load_dwordx4 v[132:135], v2, s[32:35], s66 offen offset:128 nt
    v_dot2_f32_bf16 v6, v100, v32, 0
    v_dot2_f32_bf16 v6, v101, v33, v6
    v_dot2_f32_bf16 v6, v102, v34, v6
    v_dot2_f32_bf16 v6, v103, v35, v6
    v_add_f32 v80, v4, v5
    s_nop 1
    v_add_f32 v80, v80, v6
    s_nop 1
    v_add_f32_dpp v80, v80, v80 quad_perm:[1,0,3,2] row_mask:0xf bank_mask:0xf
    s_nop 1
    v_add_f32_dpp v80, v80, v80 quad_perm:[2,3,0,1] row_mask:0xf bank_mask:0xf
    s_nop 1
    v_add_f32_dpp v80, v80, v80 row_half_mirror row_mask:0xf bank_mask:0xf
    v_cvt_pk_bf16_f32 v80, v80, v80
    v_lshlrev_b32 v80, 16, v80
    v_mul_f32 v80, 0x3d93cd3a, v80
    v_cvt_pk_bf16_f32 v80, v80, v80
    v_lshlrev_b32 v80, 16, v80
    v_max_f32 v22, v22, v80
    s_waitcnt vmcnt(7)
    s_cmp_ge_u32 s101, 3
    s_cbranch_scc1 L_go258
    s_waitcnt vmcnt(6)
    s_cmp_ge_u32 s101, 2
    s_cbranch_scc1 L_go258
    s_waitcnt vmcnt(5)
    s_cmp_ge_u32 s101, 1
    s_cbranch_scc1 L_go258
    s_waitcnt vmcnt(4)
L_go258:
    buffer_load_dwordx4 v[136:139], v2, s[32:35], s66 offen offset:256 nt
    v_dot2_f32_bf16 v4, v104, v24, 0
    v_dot2_f32_bf16 v4, v105, v25, v4
    v_dot2_f32_bf16 v4, v106, v26, v4
    v_dot2_f32_bf16 v4, v107, v27, v4
    s_waitcnt vmcnt(7)
    s_cmp_ge_u32 s101, 3
    s_cbranch_scc1 L_go259
    s_waitcnt vmcnt(6)
    s_cmp_ge_u32 s101, 2
    s_cbranch_scc1 L_go259
    s_waitcnt vmcnt(5)
    s_cmp_ge_u32 s101, 1
    s_cbranch_scc1 L_go259
    s_waitcnt vmcnt(4)
L_go259:
    s_add_u32 s66, s79, 24
    s_and_b32 s66, s66, 31
    s_mul_i32 s66, s66, 98304
    s_add_u32 s66, s66, s75
    buffer_load_dwordx4 v[140:143], v2, s[32:35], s66 offen offset:0 nt
    v_dot2_f32_bf16 v5, v108, v28, 0
    v_dot2_f32_bf16 v5, v109, v29, v5
    v_dot2_f32_bf16 v5, v110, v30, v5
    v_dot2_f32_bf16 v5, v111, v31, v5
    s_waitcnt vmcnt(7)
    s_cmp_ge_u32 s101, 3
    s_cbranch_scc1 L_go260
    s_waitcnt vmcnt(6)
    s_cmp_ge_u32 s101, 2
    s_cbranch_scc1 L_go260
    s_waitcnt vmcnt(5)
    s_cmp_ge_u32 s101, 1
    s_cbranch_scc1 L_go260
    s_waitcnt vmcnt(4)
L_go260:
    buffer_load_dwordx4 v[144:147], v2, s[32:35], s66 offen offset:128 nt
    v_dot2_f32_bf16 v6, v112, v32, 0
    v_dot2_f32_bf16 v6, v113, v33, v6
    v_dot2_f32_bf16 v6, v114, v34, v6
    v_dot2_f32_bf16 v6, v115, v35, v6
    v_add_f32 v81, v4, v5
    s_nop 1
    v_add_f32 v81, v81, v6
    s_nop 1
    v_add_f32_dpp v81, v81, v81 quad_perm:[1,0,3,2] row_mask:0xf bank_mask:0xf
    s_nop 1
    v_add_f32_dpp v81, v81, v81 quad_perm:[2,3,0,1] row_mask:0xf bank_mask:0xf
    s_nop 1
    v_add_f32_dpp v81, v81, v81 row_half_mirror row_mask:0xf bank_mask:0xf
    v_cvt_pk_bf16_f32 v81, v81, v81
    v_lshlrev_b32 v81, 16, v81
    v_mul_f32 v81, 0x3d93cd3a, v81
    v_cvt_pk_bf16_f32 v81, v81, v81
    v_lshlrev_b32 v81, 16, v81
    v_max_f32 v22, v22, v81
    s_waitcnt vmcnt(7)
    s_cmp_ge_u32 s101, 3
    s_cbranch_scc1 L_go261
    s_waitcnt vmcnt(6)
    s_cmp_ge_u32 s101, 2
    s_cbranch_scc1 L_go261
    s_waitcnt vmcnt(5)
    s_cmp_ge_u32 s101, 1
    s_cbranch_scc1 L_go261
    s_waitcnt vmcnt(4)
L_go261:
    buffer_load_dwordx4 v[148:151], v2, s[32:35], s66 offen offset:256 nt
    v_dot2_f32_bf16 v4, v116, v24, 0
    v_dot2_f32_bf16 v4, v117, v25, v4
    v_dot2_f32_bf16 v4, v118, v26, v4
    v_dot2_f32_bf16 v4, v119, v27, v4
    s_waitcnt vmcnt(7)
    s_cmp_ge_u32 s101, 3
    s_cbranch_scc1 L_go262
    s_waitcnt vmcnt(6)
    s_cmp_ge_u32 s101, 2
    s_cbranch_scc1 L_go262
    s_waitcnt vmcnt(5)
    s_cmp_ge_u32 s101, 1
    s_cbranch_scc1 L_go262
    s_waitcnt vmcnt(4)
L_go262:
    s_add_u32 s66, s79, 25
    s_and_b32 s66, s66, 31
    s_mul_i32 s66, s66, 98304
    s_add_u32 s66, s66, s75
    buffer_load_dwordx4 v[152:155], v2, s[32:35], s66 offen offset:0 nt
    v_dot2_f32_bf16 v5, v120, v28, 0
    v_dot2_f32_bf16 v5, v121, v29, v5
    v_dot2_f32_bf16 v5, v122, v30, v5
    v_dot2_f32_bf16 v5, v123, v31, v5
    s_waitcnt lgkmcnt(0)
    s_cmp_eq_u32 s76, 0
    s_cbranch_scc1 L_fb10b
    s_mov_b32 s23, 0
    s_min_u32 s4, s4, s20
    s_sub_u32 s4, s22, s4
    s_add_u32 s23, s23, s4
    s_min_u32 s5, s5, s20
    s_sub_u32 s5, s22, s5
    s_add_u32 s23, s23, s5
    s_min_u32 s6, s6, s20
    s_sub_u32 s6, s22, s6
    s_add_u32 s23, s23, s6
    s_min_u32 s7, s7, s20
    s_sub_u32 s7, s22, s7
    s_add_u32 s23, s23, s7
    s_min_u32 s8, s8, s20
    s_sub_u32 s8, s22, s8
    s_add_u32 s23, s23, s8
    s_min_u32 s9, s9, s20
    s_sub_u32 s9, s22, s9
    s_add_u32 s23, s23, s9
    s_min_u32 s10, s10, s20
    s_sub_u32 s10, s22, s10
    s_add_u32 s23, s23, s10
    s_min_u32 s11, s11, s20
    s_sub_u32 s11, s22, s11
    s_add_u32 s23, s23, s11
    s_min_u32 s12, s12, s20
    s_sub_u32 s12, s22, s12
    s_add_u32 s23, s23, s12
    s_min_u32 s13, s13, s20
    s_sub_u32 s13, s22, s13
    s_add_u32 s23, s23, s13
    s_min_u32 s14, s14, s20
    s_sub_u32 s14, s22, s14
    s_add_u32 s23, s23, s14
    s_min_u32 s15, s15, s20
    s_sub_u32 s15, s22, s15
    s_add_u32 s23, s23, s15
    s_min_u32 s16, s16, s20
    s_sub_u32 s16, s22, s16
    s_add_u32 s23, s23, s16
    s_min_u32 s17, s17, s20
    s_sub_u32 s17, s22, s17
    s_add_u32 s23, s23, s17
    s_min_u32 s18, s18, s20
    s_sub_u32 s18, s22, s18
    s_add_u32 s23, s23, s18
    s_min_u32 s19, s19, s20
    s_sub_u32 s19, s22, s19
    s_add_u32 s23, s23, s19
    s_ashr_i32 s23, s23, 4
    s_mov_b32 s101, 0
    s_cmp_ge_i32 s23, -60
    s_cselect_b32 s101, 1, s101
    s_cmp_ge_i32 s23, 20
    s_cselect_b32 s101, 2, s101
    s_cmp_ge_i32 s23, 100
    s_cselect_b32 s101, 3, s101
L_fb10b:
    s_nop 2
    v_readfirstlane_b32 s76, v255
    s_waitcnt vmcnt(7)
    s_cmp_ge_u32 s101, 3
    s_cbranch_scc1 L_go263
    s_waitcnt vmcnt(6)
    s_cmp_ge_u32 s101, 2
    s_cbranch_scc1 L_go263
    s_waitcnt vmcnt(5)
    s_cmp_ge_u32 s101, 1
    s_cbranch_scc1 L_go263
    s_waitcnt vmcnt(4)
L_go263:
    buffer_load_dwordx4 v[156:159], v2, s[32:35], s66 offen offset:128 nt
    v_dot2_f32_bf16 v6, v124, v32, 0
    v_dot2_f32_bf16 v6, v125, v33, v6
    v_dot2_f32_bf16 v6, v126, v34, v6
    v_dot2_f32_bf16 v6, v127, v35, v6
    v_add_f32 v82, v4, v5
    s_nop 1
    v_add_f32 v82, v82, v6
    s_nop 1
    v_add_f32_dpp v82, v82, v82 quad_perm:[1,0,3,2] row_mask:0xf bank_mask:0xf
    s_nop 1
    v_add_f32_dpp v82, v82, v82 quad_perm:[2,3,0,1] row_mask:0xf bank_mask:0xf
    s_nop 1
    v_add_f32_dpp v82, v82, v82 row_half_mirror row_mask:0xf bank_mask:0xf
    v_cvt_pk_bf16_f32 v82, v82, v82
    v_lshlrev_b32 v82, 16, v82
    v_mul_f32 v82, 0x3d93cd3a, v82
    v_cvt_pk_bf16_f32 v82, v82, v82
    v_lshlrev_b32 v82, 16, v82
    v_max_f32 v22, v22, v82
    s_waitcnt vmcnt(7)
    s_cmp_ge_u32 s101, 3
    s_cbranch_scc1 L_go264
    s_waitcnt vmcnt(6)
    s_cmp_ge_u32 s101, 2
    s_cbranch_scc1 L_go264
    s_waitcnt vmcnt(5)
    s_cmp_ge_u32 s101, 1
    s_cbranch_scc1 L_go264
    s_waitcnt vmcnt(4)
L_go264:
    buffer_load_dwordx4 v[160:163], v2, s[32:35], s66 offen offset:256 nt
    v_dot2_f32_bf16 v4, v128, v24, 0
    v_dot2_f32_bf16 v4, v129, v25, v4
    v_dot2_f32_bf16 v4, v130, v26, v4
    v_dot2_f32_bf16 v4, v131, v27, v4
    s_waitcnt vmcnt(7)
    s_cmp_ge_u32 s101, 3
    s_cbranch_scc1 L_go265
    s_waitcnt vmcnt(6)
    s_cmp_ge_u32 s101, 2
    s_cbranch_scc1 L_go265
    s_waitcnt vmcnt(5)
    s_cmp_ge_u32 s101, 1
    s_cbranch_scc1 L_go265
    s_waitcnt vmcnt(4)
L_go265:
    s_add_u32 s66, s79, 26
    s_and_b32 s66, s66, 31
    s_mul_i32 s66, s66, 98304
    s_add_u32 s66, s66, s75
    buffer_load_dwordx4 v[164:167], v2, s[32:35], s66 offen offset:0 nt
    v_dot2_f32_bf16 v5, v132, v28, 0
    v_dot2_f32_bf16 v5, v133, v29, v5
    v_dot2_f32_bf16 v5, v134, v30, v5
    v_dot2_f32_bf16 v5, v135, v31, v5
    s_waitcnt vmcnt(7)
    s_cmp_ge_u32 s101, 3
    s_cbranch_scc1 L_go266
    s_waitcnt vmcnt(6)
    s_cmp_ge_u32 s101, 2
    s_cbranch_scc1 L_go266
    s_waitcnt vmcnt(5)
    s_cmp_ge_u32 s101, 1
    s_cbranch_scc1 L_go266
    s_waitcnt vmcnt(4)
L_go266:
    buffer_load_dwordx4 v[168:171], v2, s[32:35], s66 offen offset:128 nt
    v_dot2_f32_bf16 v6, v136, v32, 0
    v_dot2_f32_bf16 v6, v137, v33, v6
    v_dot2_f32_bf16 v6, v138, v34, v6
    v_dot2_f32_bf16 v6, v139, v35, v6
    v_add_f32 v83, v4, v5
    s_nop 1
    v_add_f32 v83, v83, v6
    s_nop 1
    v_add_f32_dpp v83, v83, v83 quad_perm:[1,0,3,2] row_mask:0xf bank_mask:0xf
    s_nop 1
    v_add_f32_dpp v83, v83, v83 quad_perm:[2,3,0,1] row_mask:0xf bank_mask:0xf
    s_nop 1
    v_add_f32_dpp v83, v83, v83 row_half_mirror row_mask:0xf bank_mask:0xf
    v_cvt_pk_bf16_f32 v83, v83, v83
    v_lshlrev_b32 v83, 16, v83
    v_mul_f32 v83, 0x3d93cd3a, v83
    v_cvt_pk_bf16_f32 v83, v83, v83
    v_lshlrev_b32 v83, 16, v83
    v_max_f32 v22, v22, v83
    s_waitcnt vmcnt(7)
    s_cmp_ge_u32 s101, 3
    s_cbranch_scc1 L_go267
    s_waitcnt vmcnt(6)
    s_cmp_ge_u32 s101, 2
    s_cbranch_scc1 L_go267
    s_waitcnt vmcnt(5)
    s_cmp_ge_u32 s101, 1
    s_cbranch_scc1 L_go267
    s_waitcnt vmcnt(4)
L_go267:
    buffer_load_dwordx4 v[172:175], v2, s[32:35], s66 offen offset:256 nt
    v_dot2_f32_bf16 v4, v140, v24, 0
    v_dot2_f32_bf16 v4, v141, v25, v4
    v_dot2_f32_bf16 v4, v142, v26, v4
    v_dot2_f32_bf16 v4, v143, v27, v4
    s_waitcnt vmcnt(7)
    s_cmp_ge_u32 s101, 3
    s_cbranch_scc1 L_go268
    s_waitcnt vmcnt(6)
    s_cmp_ge_u32 s101, 2
    s_cbranch_scc1 L_go268
    s_waitcnt vmcnt(5)
    s_cmp_ge_u32 s101, 1
    s_cbranch_scc1 L_go268
    s_waitcnt vmcnt(4)
L_go268:
    s_add_u32 s66, s79, 27
    s_and_b32 s66, s66, 31
    s_mul_i32 s66, s66, 98304
    s_add_u32 s66, s66, s75
    buffer_load_dwordx4 v[176:179], v2, s[32:35], s66 offen offset:0 nt
    v_dot2_f32_bf16 v5, v144, v28, 0
    v_dot2_f32_bf16 v5, v145, v29, v5
    v_dot2_f32_bf16 v5, v146, v30, v5
    v_dot2_f32_bf16 v5, v147, v31, v5
    s_waitcnt vmcnt(7)
    s_cmp_ge_u32 s101, 3
    s_cbranch_scc1 L_go269
    s_waitcnt vmcnt(6)
    s_cmp_ge_u32 s101, 2
    s_cbranch_scc1 L_go269
    s_waitcnt vmcnt(5)
    s_cmp_ge_u32 s101, 1
    s_cbranch_scc1 L_go269
    s_waitcnt vmcnt(4)
L_go269:
    buffer_load_dwordx4 v[180:183], v2, s[32:35], s66 offen offset:128 nt
    v_dot2_f32_bf16 v6, v148, v32, 0
    v_dot2_f32_bf16 v6, v149, v33, v6
    v_dot2_f32_bf16 v6, v150, v34, v6
    v_dot2_f32_bf16 v6, v151, v35, v6
    v_add_f32 v84, v4, v5
    s_nop 1
    v_add_f32 v84, v84, v6
    s_nop 1
    v_add_f32_dpp v84, v84, v84 quad_perm:[1,0,3,2] row_mask:0xf bank_mask:0xf
    s_nop 1
    v_add_f32_dpp v84, v84, v84 quad_perm:[2,3,0,1] row_mask:0xf bank_mask:0xf
    s_nop 1
    v_add_f32_dpp v84, v84, v84 row_half_mirror row_mask:0xf bank_mask:0xf
    v_cvt_pk_bf16_f32 v84, v84, v84
    v_lshlrev_b32 v84, 16, v84
    v_mul_f32 v84, 0x3d93cd3a, v84
    v_cvt_pk_bf16_f32 v84, v84, v84
    v_lshlrev_b32 v84, 16, v84
    v_max_f32 v22, v22, v84
    s_waitcnt vmcnt(7)
    s_cmp_ge_u32 s101, 3
    s_cbranch_scc1 L_go270
    s_waitcnt vmcnt(6)
    s_cmp_ge_u32 s101, 2
    s_cbranch_scc1 L_go270
    s_waitcnt vmcnt(5)
    s_cmp_ge_u32 s101, 1
    s_cbranch_scc1 L_go270
    s_waitcnt vmcnt(4)
L_go270:
    buffer_load_dwordx4 v[184:187], v2, s[32:35], s66 offen offset:256 nt
    v_dot2_f32_bf16 v4, v152, v24, 0
    v_dot2_f32_bf16 v4, v153, v25, v4
    v_dot2_f32_bf16 v4, v154, v26, v4
    v_dot2_f32_bf16 v4, v155, v27, v4
    s_waitcnt vmcnt(7)
    s_cmp_ge_u32 s101, 3
    s_cbranch_scc1 L_go271
    s_waitcnt vmcnt(6)
    s_cmp_ge_u32 s101, 2
    s_cbranch_scc1 L_go271
    s_waitcnt vmcnt(5)
    s_cmp_ge_u32 s101, 1
    s_cbranch_scc1 L_go271
    s_waitcnt vmcnt(4)
L_go271:
    s_add_u32 s66, s79, 28
    s_and_b32 s66, s66, 31
    s_mul_i32 s66, s66, 98304
    s_add_u32 s66, s66, s75
    buffer_load_dwordx4 v[188:191], v2, s[32:35], s66 offen offset:0 nt
    v_dot2_f32_bf16 v5, v156, v28, 0
    v_dot2_f32_bf16 v5, v157, v29, v5
    v_dot2_f32_bf16 v5, v158, v30, v5
    v_dot2_f32_bf16 v5, v159, v31, v5
    s_mov_b32 s22, s20
    s_memrealtime s[20:21]
    s_waitcnt vmcnt(7)
    s_cmp_ge_u32 s101, 3
    s_cbranch_scc1 L_go272
    s_waitcnt vmcnt(6)
    s_cmp_ge_u32 s101, 2
    s_cbranch_scc1 L_go272
    s_waitcnt vmcnt(5)
    s_cmp_ge_u32 s101, 1
    s_cbranch_scc1 L_go272
    s_waitcnt vmcnt(4)
L_go272:
    buffer_load_dwordx4 v[192:195], v2, s[32:35], s66 offen offset:128 nt
    v_dot2_f32_bf16 v6, v160, v32, 0
    v_dot2_f32_bf16 v6, v161, v33, v6
    v_dot2_f32_bf16 v6, v162, v34, v6
    v_dot2_f32_bf16 v6, v163, v35, v6
    s_waitcnt lgkmcnt(0)
    v_mov_b32 v254, s20
    s_mov_b32 s70, 984448
    buffer_store_dword v254, v253, s[56:59], s70 offen sc1
    s_cmp_eq_u32 s76, 0
    s_cbranch_scc1 L_fb11a
    s_load_dwordx16 s[4:19], s[24:25], 984320
L_fb11a:
    ds_read_b32 v255, v3 offset:8
    v_add_f32 v85, v4, v5
    v_add_f32 v85, v85, v6
    s_nop 1
    v_add_f32_dpp v85, v85, v85 quad_perm:[1,0,3,2] row_mask:0xf bank_mask:0xf
    s_nop 1
    v_add_f32_dpp v85, v85, v85 quad_perm:[2,3,0,1] row_mask:0xf bank_mask:0xf
    s_nop 1
    v_add_f32_dpp v85, v85, v85 row_half_mirror row_mask:0xf bank_mask:0xf
    v_cvt_pk_bf16_f32 v85, v85, v85
    v_lshlrev_b32 v85, 16, v85
    v_mul_f32 v85, 0x3d93cd3a, v85
    v_cvt_pk_bf16_f32 v85, v85, v85
    v_lshlrev_b32 v85, 16, v85
    v_max_f32 v22, v22, v85
    s_waitcnt vmcnt(7)
    s_cmp_ge_u32 s101, 3
    s_cbranch_scc1 L_go273
    s_waitcnt vmcnt(6)
    s_cmp_ge_u32 s101, 2
    s_cbranch_scc1 L_go273
    s_waitcnt vmcnt(5)
    s_cmp_ge_u32 s101, 1
    s_cbranch_scc1 L_go273
    s_waitcnt vmcnt(4)
L_go273:
    buffer_load_dwordx4 v[196:199], v2, s[32:35], s66 offen offset:256 nt
    v_dot2_f32_bf16 v4, v164, v24, 0
    v_dot2_f32_bf16 v4, v165, v25, v4
    v_dot2_f32_bf16 v4, v166, v26, v4
    v_dot2_f32_bf16 v4, v167, v27, v4
    s_waitcnt vmcnt(7)
    s_cmp_ge_u32 s101, 3
    s_cbranch_scc1 L_go274
    s_waitcnt vmcnt(6)
    s_cmp_ge_u32 s101, 2
    s_cbranch_scc1 L_go274
    s_waitcnt vmcnt(5)
    s_cmp_ge_u32 s101, 1
    s_cbranch_scc1 L_go274
    s_waitcnt vmcnt(4)
L_go274:
    s_add_u32 s66, s79, 29
    s_and_b32 s66, s66, 31
    s_mul_i32 s66, s66, 98304
    s_add_u32 s66, s66, s75
    buffer_load_dwordx4 v[200:203], v2, s[32:35], s66 offen offset:0 nt
    v_dot2_f32_bf16 v5, v168, v28, 0
    v_dot2_f32_bf16 v5, v169, v29, v5
    v_dot2_f32_bf16 v5, v170, v30, v5
    v_dot2_f32_bf16 v5, v171, v31, v5
    s_waitcnt vmcnt(7)
    s_cmp_ge_u32 s101, 3
    s_cbranch_scc1 L_go275
    s_waitcnt vmcnt(6)
    s_cmp_ge_u32 s101, 2
    s_cbranch_scc1 L_go275
    s_waitcnt vmcnt(5)
    s_cmp_ge_u32 s101, 1
    s_cbranch_scc1 L_go275
    s_waitcnt vmcnt(4)
L_go275:
    buffer_load_dwordx4 v[204:207], v2, s[32:35], s66 offen offset:128 nt
    v_dot2_f32_bf16 v6, v172, v32, 0
    v_dot2_f32_bf16 v6, v173, v33, v6
    v_dot2_f32_bf16 v6, v174, v34, v6
    v_dot2_f32_bf16 v6, v175, v35, v6
    v_add_f32 v86, v4, v5
    s_nop 1
    v_add_f32 v86, v86, v6
    s_nop 1
    v_add_f32_dpp v86, v86, v86 quad_perm:[1,0,3,2] row_mask:0xf bank_mask:0xf
    s_nop 1
    v_add_f32_dpp v86, v86, v86 quad_perm:[2,3,0,1] row_mask:0xf bank_mask:0xf
    s_nop 1
    v_add_f32_dpp v86, v86, v86 row_half_mirror row_mask:0xf bank_mask:0xf
    v_cvt_pk_bf16_f32 v86, v86, v86
    v_lshlrev_b32 v86, 16, v86
    v_mul_f32 v86, 0x3d93cd3a, v86
    v_cvt_pk_bf16_f32 v86, v86, v86
    v_lshlrev_b32 v86, 16, v86
    v_max_f32 v22, v22, v86
    s_waitcnt vmcnt(7)
    s_cmp_ge_u32 s101, 3
    s_cbranch_scc1 L_go276
    s_waitcnt vmcnt(6)
    s_cmp_ge_u32 s101, 2
    s_cbranch_scc1 L_go276
    s_waitcnt vmcnt(5)
    s_cmp_ge_u32 s101, 1
    s_cbranch_scc1 L_go276
    s_waitcnt vmcnt(4)
L_go276:
    buffer_load_dwordx4 v[208:211], v2, s[32:35], s66 offen offset:256 nt
    v_dot2_f32_bf16 v4, v176, v24, 0
    v_dot2_f32_bf16 v4, v177, v25, v4
    v_dot2_f32_bf16 v4, v178, v26, v4
    v_dot2_f32_bf16 v4, v179, v27, v4
    s_waitcnt vmcnt(7)
    s_cmp_ge_u32 s101, 3
    s_cbranch_scc1 L_go277
    s_waitcnt vmcnt(6)
    s_cmp_ge_u32 s101, 2
    s_cbranch_scc1 L_go277
    s_waitcnt vmcnt(5)
    s_cmp_ge_u32 s101, 1
    s_cbranch_scc1 L_go277
    s_waitcnt vmcnt(4)
L_go277:
    s_add_u32 s66, s79, 30
    s_and_b32 s66, s66, 31
    s_mul_i32 s66, s66, 98304
    s_add_u32 s66, s66, s75
    buffer_load_dwordx4 v[212:215], v2, s[32:35], s66 offen offset:0 nt
    v_dot2_f32_bf16 v5, v180, v28, 0
    v_dot2_f32_bf16 v5, v181, v29, v5
    v_dot2_f32_bf16 v5, v182, v30, v5
    v_dot2_f32_bf16 v5, v183, v31, v5
    s_waitcnt vmcnt(7)
    s_cmp_ge_u32 s101, 3
    s_cbranch_scc1 L_go278
    s_waitcnt vmcnt(6)
    s_cmp_ge_u32 s101, 2
    s_cbranch_scc1 L_go278
    s_waitcnt vmcnt(5)
    s_cmp_ge_u32 s101, 1
    s_cbranch_scc1 L_go278
    s_waitcnt vmcnt(4)
L_go278:
    buffer_load_dwordx4 v[216:219], v2, s[32:35], s66 offen offset:128 nt
    v_dot2_f32_bf16 v6, v184, v32, 0
    v_dot2_f32_bf16 v6, v185, v33, v6
    v_dot2_f32_bf16 v6, v186, v34, v6
    v_dot2_f32_bf16 v6, v187, v35, v6
    v_add_f32 v87, v4, v5
    s_nop 1
    v_add_f32 v87, v87, v6
    s_nop 1
    v_add_f32_dpp v87, v87, v87 quad_perm:[1,0,3,2] row_mask:0xf bank_mask:0xf
    s_nop 1
    v_add_f32_dpp v87, v87, v87 quad_perm:[2,3,0,1] row_mask:0xf bank_mask:0xf
    s_nop 1
    v_add_f32_dpp v87, v87, v87 row_half_mirror row_mask:0xf bank_mask:0xf
    v_cvt_pk_bf16_f32 v87, v87, v87
    v_lshlrev_b32 v87, 16, v87
    v_mul_f32 v87, 0x3d93cd3a, v87
    v_cvt_pk_bf16_f32 v87, v87, v87
    v_lshlrev_b32 v87, 16, v87
    v_max_f32 v22, v22, v87
    s_waitcnt vmcnt(7)
    s_cmp_ge_u32 s101, 3
    s_cbranch_scc1 L_go279
    s_waitcnt vmcnt(6)
    s_cmp_ge_u32 s101, 2
    s_cbranch_scc1 L_go279
    s_waitcnt vmcnt(5)
    s_cmp_ge_u32 s101, 1
    s_cbranch_scc1 L_go279
    s_waitcnt vmcnt(4)
L_go279:
    buffer_load_dwordx4 v[220:223], v2, s[32:35], s66 offen offset:256 nt
    v_dot2_f32_bf16 v4, v188, v24, 0
    v_dot2_f32_bf16 v4, v189, v25, v4
    v_dot2_f32_bf16 v4, v190, v26, v4
    v_dot2_f32_bf16 v4, v191, v27, v4
    s_waitcnt vmcnt(7)
    s_cmp_ge_u32 s101, 3
    s_cbranch_scc1 L_go280
    s_waitcnt vmcnt(6)
    s_cmp_ge_u32 s101, 2
    s_cbranch_scc1 L_go280
    s_waitcnt vmcnt(5)
    s_cmp_ge_u32 s101, 1
    s_cbranch_scc1 L_go280
    s_waitcnt vmcnt(4)
L_go280:
    s_add_u32 s66, s79, 31
    s_and_b32 s66, s66, 31
    s_mul_i32 s66, s66, 98304
    s_add_u32 s66, s66, s75
    buffer_load_dwordx4 v[224:227], v2, s[32:35], s66 offen offset:0 nt
    v_dot2_f32_bf16 v5, v192, v28, 0
    v_dot2_f32_bf16 v5, v193, v29, v5
    v_dot2_f32_bf16 v5, v194, v30, v5
    v_dot2_f32_bf16 v5, v195, v31, v5
    s_waitcnt lgkmcnt(0)
    s_cmp_eq_u32 s76, 0
    s_cbranch_scc1 L_fb11b
    s_mov_b32 s23, 0
    s_min_u32 s4, s4, s20
    s_sub_u32 s4, s22, s4
    s_add_u32 s23, s23, s4
    s_min_u32 s5, s5, s20
    s_sub_u32 s5, s22, s5
    s_add_u32 s23, s23, s5
    s_min_u32 s6, s6, s20
    s_sub_u32 s6, s22, s6
    s_add_u32 s23, s23, s6
    s_min_u32 s7, s7, s20
    s_sub_u32 s7, s22, s7
    s_add_u32 s23, s23, s7
    s_min_u32 s8, s8, s20
    s_sub_u32 s8, s22, s8
    s_add_u32 s23, s23, s8
    s_min_u32 s9, s9, s20
    s_sub_u32 s9, s22, s9
    s_add_u32 s23, s23, s9
    s_min_u32 s10, s10, s20
    s_sub_u32 s10, s22, s10
    s_add_u32 s23, s23, s10
    s_min_u32 s11, s11, s20
    s_sub_u32 s11, s22, s11
    s_add_u32 s23, s23, s11
    s_min_u32 s12, s12, s20
    s_sub_u32 s12, s22, s12
    s_add_u32 s23, s23, s12
    s_min_u32 s13, s13, s20
    s_sub_u32 s13, s22, s13
    s_add_u32 s23, s23, s13
    s_min_u32 s14, s14, s20
    s_sub_u32 s14, s22, s14
    s_add_u32 s23, s23, s14
    s_min_u32 s15, s15, s20
    s_sub_u32 s15, s22, s15
    s_add_u32 s23, s23, s15
    s_min_u32 s16, s16, s20
    s_sub_u32 s16, s22, s16
    s_add_u32 s23, s23, s16
    s_min_u32 s17, s17, s20
    s_sub_u32 s17, s22, s17
    s_add_u32 s23, s23, s17
    s_min_u32 s18, s18, s20
    s_sub_u32 s18, s22, s18
    s_add_u32 s23, s23, s18
    s_min_u32 s19, s19, s20
    s_sub_u32 s19, s22, s19
    s_add_u32 s23, s23, s19
    s_ashr_i32 s23, s23, 4
    s_mov_b32 s101, 0
    s_cmp_ge_i32 s23, -60
    s_cselect_b32 s101, 1, s101
    s_cmp_ge_i32 s23, 20
    s_cselect_b32 s101, 2, s101
    s_cmp_ge_i32 s23, 100
    s_cselect_b32 s101, 3, s101
L_fb11b:
    s_nop 2
    v_readfirstlane_b32 s76, v255
    s_waitcnt vmcnt(7)
    s_cmp_ge_u32 s101, 3
    s_cbranch_scc1 L_go281
    s_waitcnt vmcnt(6)
    s_cmp_ge_u32 s101, 2
    s_cbranch_scc1 L_go281
    s_waitcnt vmcnt(5)
    s_cmp_ge_u32 s101, 1
    s_cbranch_scc1 L_go281
    s_waitcnt vmcnt(4)
L_go281:
    buffer_load_dwordx4 v[228:231], v2, s[32:35], s66 offen offset:128 nt
    v_dot2_f32_bf16 v6, v196, v32, 0
    v_dot2_f32_bf16 v6, v197, v33, v6
    v_dot2_f32_bf16 v6, v198, v34, v6
    v_dot2_f32_bf16 v6, v199, v35, v6
    v_add_f32 v88, v4, v5
    s_nop 1
    v_add_f32 v88, v88, v6
    s_nop 1
    v_add_f32_dpp v88, v88, v88 quad_perm:[1,0,3,2] row_mask:0xf bank_mask:0xf
    s_nop 1
    v_add_f32_dpp v88, v88, v88 quad_perm:[2,3,0,1] row_mask:0xf bank_mask:0xf
    s_nop 1
    v_add_f32_dpp v88, v88, v88 row_half_mirror row_mask:0xf bank_mask:0xf
    v_cvt_pk_bf16_f32 v88, v88, v88
    v_lshlrev_b32 v88, 16, v88
    v_mul_f32 v88, 0x3d93cd3a, v88
    v_cvt_pk_bf16_f32 v88, v88, v88
    v_lshlrev_b32 v88, 16, v88
    v_max_f32 v22, v22, v88
    s_waitcnt vmcnt(7)
    s_cmp_ge_u32 s101, 3
    s_cbranch_scc1 L_go282
    s_waitcnt vmcnt(6)
    s_cmp_ge_u32 s101, 2
    s_cbranch_scc1 L_go282
    s_waitcnt vmcnt(5)
    s_cmp_ge_u32 s101, 1
    s_cbranch_scc1 L_go282
    s_waitcnt vmcnt(4)
L_go282:
    buffer_load_dwordx4 v[232:235], v2, s[32:35], s66 offen offset:256 nt
    v_dot2_f32_bf16 v4, v200, v24, 0
    v_dot2_f32_bf16 v4, v201, v25, v4
    v_dot2_f32_bf16 v4, v202, v26, v4
    v_dot2_f32_bf16 v4, v203, v27, v4
    s_waitcnt vmcnt(7)
    s_cmp_ge_u32 s101, 3
    s_cbranch_scc1 L_go283
    s_waitcnt vmcnt(6)
    s_cmp_ge_u32 s101, 2
    s_cbranch_scc1 L_go283
    s_waitcnt vmcnt(5)
    s_cmp_ge_u32 s101, 1
    s_cbranch_scc1 L_go283
    s_waitcnt vmcnt(4)
L_go283:
    s_add_u32 s66, s79, 0
    s_and_b32 s66, s66, 31
    s_mul_i32 s66, s66, 98304
    s_add_u32 s66, s66, s75
    buffer_load_dwordx4 v[236:239], v2, s[36:39], s66 offen offset:0 nt
    v_dot2_f32_bf16 v5, v204, v28, 0
    v_dot2_f32_bf16 v5, v205, v29, v5
    v_dot2_f32_bf16 v5, v206, v30, v5
    v_dot2_f32_bf16 v5, v207, v31, v5
    s_waitcnt vmcnt(7)
    s_cmp_ge_u32 s101, 3
    s_cbranch_scc1 L_go284
    s_waitcnt vmcnt(6)
    s_cmp_ge_u32 s101, 2
    s_cbranch_scc1 L_go284
    s_waitcnt vmcnt(5)
    s_cmp_ge_u32 s101, 1
    s_cbranch_scc1 L_go284
    s_waitcnt vmcnt(4)
L_go284:
    buffer_load_dwordx4 v[240:243], v2, s[36:39], s66 offen offset:128 nt
    v_dot2_f32_bf16 v6, v208, v32, 0
    v_dot2_f32_bf16 v6, v209, v33, v6
    v_dot2_f32_bf16 v6, v210, v34, v6
    v_dot2_f32_bf16 v6, v211, v35, v6
    v_add_f32 v89, v4, v5
    s_nop 1
    v_add_f32 v89, v89, v6
    s_nop 1
    v_add_f32_dpp v89, v89, v89 quad_perm:[1,0,3,2] row_mask:0xf bank_mask:0xf
    s_nop 1
    v_add_f32_dpp v89, v89, v89 quad_perm:[2,3,0,1] row_mask:0xf bank_mask:0xf
    s_nop 1
    v_add_f32_dpp v89, v89, v89 row_half_mirror row_mask:0xf bank_mask:0xf
    v_cvt_pk_bf16_f32 v89, v89, v89
    v_lshlrev_b32 v89, 16, v89
    v_mul_f32 v89, 0x3d93cd3a, v89
    v_cvt_pk_bf16_f32 v89, v89, v89
    v_lshlrev_b32 v89, 16, v89
    v_max_f32 v22, v22, v89
    s_waitcnt vmcnt(7)
    s_cmp_ge_u32 s101, 3
    s_cbranch_scc1 L_go285
    s_waitcnt vmcnt(6)
    s_cmp_ge_u32 s101, 2
    s_cbranch_scc1 L_go285
    s_waitcnt vmcnt(5)
    s_cmp_ge_u32 s101, 1
    s_cbranch_scc1 L_go285
    s_waitcnt vmcnt(4)
L_go285:
    buffer_load_dwordx4 v[244:247], v2, s[36:39], s66 offen offset:256 nt
    v_dot2_f32_bf16 v4, v212, v24, 0
    v_dot2_f32_bf16 v4, v213, v25, v4
    v_dot2_f32_bf16 v4, v214, v26, v4
    v_dot2_f32_bf16 v4, v215, v27, v4
    s_waitcnt vmcnt(7)
    s_cmp_ge_u32 s101, 3
    s_cbranch_scc1 L_go286
    s_waitcnt vmcnt(6)
    s_cmp_ge_u32 s101, 2
    s_cbranch_scc1 L_go286
    s_waitcnt vmcnt(5)
    s_cmp_ge_u32 s101, 1
    s_cbranch_scc1 L_go286
    s_waitcnt vmcnt(4)
L_go286:
    s_add_u32 s66, s79, 1
    s_and_b32 s66, s66, 31
    s_mul_i32 s66, s66, 98304
    s_add_u32 s66, s66, s75
    buffer_load_dwordx4 v[248:251], v2, s[36:39], s66 offen offset:0 nt
    v_dot2_f32_bf16 v5, v216, v28, 0
    v_dot2_f32_bf16 v5, v217, v29, v5
    v_dot2_f32_bf16 v5, v218, v30, v5
    v_dot2_f32_bf16 v5, v219, v31, v5
    s_waitcnt vmcnt(7)
    s_cmp_ge_u32 s101, 3
    s_cbranch_scc1 L_go287
    s_waitcnt vmcnt(6)
    s_cmp_ge_u32 s101, 2
    s_cbranch_scc1 L_go287
    s_waitcnt vmcnt(5)
    s_cmp_ge_u32 s101, 1
    s_cbranch_scc1 L_go287
    s_waitcnt vmcnt(4)
L_go287:
    buffer_load_dwordx4 v[92:95], v2, s[36:39], s66 offen offset:128 nt
    v_dot2_f32_bf16 v6, v220, v32, 0
    v_dot2_f32_bf16 v6, v221, v33, v6
    v_dot2_f32_bf16 v6, v222, v34, v6
    v_dot2_f32_bf16 v6, v223, v35, v6
    v_add_f32 v90, v4, v5
    s_nop 1
    v_add_f32 v90, v90, v6
    s_nop 1
    v_add_f32_dpp v90, v90, v90 quad_perm:[1,0,3,2] row_mask:0xf bank_mask:0xf
    s_nop 1
    v_add_f32_dpp v90, v90, v90 quad_perm:[2,3,0,1] row_mask:0xf bank_mask:0xf
    s_nop 1
    v_add_f32_dpp v90, v90, v90 row_half_mirror row_mask:0xf bank_mask:0xf
    v_cvt_pk_bf16_f32 v90, v90, v90
    v_lshlrev_b32 v90, 16, v90
    v_mul_f32 v90, 0x3d93cd3a, v90
    v_cvt_pk_bf16_f32 v90, v90, v90
    v_lshlrev_b32 v90, 16, v90
    v_max_f32 v22, v22, v90
    s_waitcnt vmcnt(7)
    s_cmp_ge_u32 s101, 3
    s_cbranch_scc1 L_go288
    s_waitcnt vmcnt(6)
    s_cmp_ge_u32 s101, 2
    s_cbranch_scc1 L_go288
    s_waitcnt vmcnt(5)
    s_cmp_ge_u32 s101, 1
    s_cbranch_scc1 L_go288
    s_waitcnt vmcnt(4)
L_go288:
    buffer_load_dwordx4 v[96:99], v2, s[36:39], s66 offen offset:256 nt
    v_dot2_f32_bf16 v4, v224, v24, 0
    v_dot2_f32_bf16 v4, v225, v25, v4
    v_dot2_f32_bf16 v4, v226, v26, v4
    v_dot2_f32_bf16 v4, v227, v27, v4
    s_waitcnt vmcnt(7)
    s_cmp_ge_u32 s101, 3
    s_cbranch_scc1 L_go289
    s_waitcnt vmcnt(6)
    s_cmp_ge_u32 s101, 2
    s_cbranch_scc1 L_go289
    s_waitcnt vmcnt(5)
    s_cmp_ge_u32 s101, 1
    s_cbranch_scc1 L_go289
    s_waitcnt vmcnt(4)
L_go289:
    s_add_u32 s66, s79, 2
    s_and_b32 s66, s66, 31
    s_mul_i32 s66, s66, 98304
    s_add_u32 s66, s66, s75
    buffer_load_dwordx4 v[100:103], v2, s[36:39], s66 offen offset:0 nt
    v_dot2_f32_bf16 v5, v228, v28, 0
    v_dot2_f32_bf16 v5, v229, v29, v5
    v_dot2_f32_bf16 v5, v230, v30, v5
    v_dot2_f32_bf16 v5, v231, v31, v5
    s_mov_b32 s22, s20
    s_memrealtime s[20:21]
    s_waitcnt vmcnt(7)
    s_cmp_ge_u32 s101, 3
    s_cbranch_scc1 L_go290
    s_waitcnt vmcnt(6)
    s_cmp_ge_u32 s101, 2
    s_cbranch_scc1 L_go290
    s_waitcnt vmcnt(5)
    s_cmp_ge_u32 s101, 1
    s_cbranch_scc1 L_go290
    s_waitcnt vmcnt(4)
L_go290:
    buffer_load_dwordx4 v[104:107], v2, s[36:39], s66 offen offset:128 nt
    v_dot2_f32_bf16 v6, v232, v32, 0
    v_dot2_f32_bf16 v6, v233, v33, v6
    v_dot2_f32_bf16 v6, v234, v34, v6
    v_dot2_f32_bf16 v6, v235, v35, v6
    s_waitcnt lgkmcnt(0)
    v_mov_b32 v254, s20
    s_mov_b32 s70, 984576
    buffer_store_dword v254, v253, s[56:59], s70 offen sc1
    s_cmp_eq_u32 s76, 0
    s_cbranch_scc1 L_fb12a
    s_load_dwordx16 s[4:19], s[24:25], 984448
L_fb12a:
    ds_read_b32 v255, v3 offset:8
    v_add_f32 v91, v4, v5
    v_add_f32 v91, v91, v6
    s_nop 1
    v_add_f32_dpp v91, v91, v91 quad_perm:[1,0,3,2] row_mask:0xf bank_mask:0xf
    s_nop 1
    v_add_f32_dpp v91, v91, v91 quad_perm:[2,3,0,1] row_mask:0xf bank_mask:0xf
    s_nop 1
    v_add_f32_dpp v91, v91, v91 row_half_mirror row_mask:0xf bank_mask:0xf
    v_cvt_pk_bf16_f32 v91, v91, v91
    v_lshlrev_b32 v91, 16, v91
    v_mul_f32 v91, 0x3d93cd3a, v91
    v_cvt_pk_bf16_f32 v91, v91, v91
    v_lshlrev_b32 v91, 16, v91
    v_max_f32 v22, v22, v91
    s_nop 1
    v_max_f32_dpp v22, v22, v22 row_ror:8 row_mask:0xf bank_mask:0xf
    v_mov_b32 v5, v22
    s_nop 1
    v_permlane16_swap_b32 v22, v5
    v_max_f32 v22, v22, v5
    v_mov_b32 v5, v22
    s_nop 1
    v_permlane32_swap_b32 v22, v5
    v_max_f32 v22, v22, v5
    v_sub_f32 v60, v60, v22
    v_mul_f32 v60, 0x3fb8aa3b, v60
    v_exp_f32 v60, v60
    s_nop 0
    v_mov_b32 v23, v60
    v_sub_f32 v61, v61, v22
    v_mul_f32 v61, 0x3fb8aa3b, v61
    v_exp_f32 v61, v61
    s_nop 0
    v_add_f32 v23, v23, v61
    v_sub_f32 v62, v62, v22
    v_mul_f32 v62, 0x3fb8aa3b, v62
    v_exp_f32 v62, v62
    s_nop 0
    v_add_f32 v23, v23, v62
    v_sub_f32 v63, v63, v22
    v_mul_f32 v63, 0x3fb8aa3b, v63
    v_exp_f32 v63, v63
    s_nop 0
    v_add_f32 v23, v23, v63
    s_waitcnt vmcnt(7)
    s_cmp_ge_u32 s101, 3
    s_cbranch_scc1 L_go291
    s_waitcnt vmcnt(6)
    s_cmp_ge_u32 s101, 2
    s_cbranch_scc1 L_go291
    s_waitcnt vmcnt(5)
    s_cmp_ge_u32 s101, 1
    s_cbranch_scc1 L_go291
    s_waitcnt vmcnt(4)
L_go291:
    buffer_load_dwordx4 v[108:111], v2, s[36:39], s66 offen offset:256 nt
    v_lshlrev_b32 v4, 16, v236
    v_and_b32 v5, s67, v236
    v_mul_f32 v36, v60, v4
    v_mul_f32 v37, v60, v5
    v_lshlrev_b32 v6, 16, v237
    v_and_b32 v7, s67, v237
    v_mul_f32 v38, v60, v6
    v_mul_f32 v39, v60, v7
    v_lshlrev_b32 v8, 16, v238
    v_and_b32 v9, s67, v238
    v_mul_f32 v40, v60, v8
    v_mul_f32 v41, v60, v9
    v_lshlrev_b32 v10, 16, v239
    v_and_b32 v11, s67, v239
    v_mul_f32 v42, v60, v10
    v_mul_f32 v43, v60, v11
    s_waitcnt vmcnt(7)
    s_cmp_ge_u32 s101, 3
    s_cbranch_scc1 L_go292
    s_waitcnt vmcnt(6)
    s_cmp_ge_u32 s101, 2
    s_cbranch_scc1 L_go292
    s_waitcnt vmcnt(5)
    s_cmp_ge_u32 s101, 1
    s_cbranch_scc1 L_go292
    s_waitcnt vmcnt(4)
L_go292:
    s_add_u32 s66, s79, 3
    s_and_b32 s66, s66, 31
    s_mul_i32 s66, s66, 98304
    s_add_u32 s66, s66, s75
    buffer_load_dwordx4 v[112:115], v2, s[36:39], s66 offen offset:0 nt
    v_lshlrev_b32 v4, 16, v240
    v_and_b32 v5, s67, v240
    v_mul_f32 v44, v60, v4
    v_mul_f32 v45, v60, v5
    v_lshlrev_b32 v6, 16, v241
    v_and_b32 v7, s67, v241
    v_mul_f32 v46, v60, v6
    v_mul_f32 v47, v60, v7
    v_lshlrev_b32 v8, 16, v242
    v_and_b32 v9, s67, v242
    v_mul_f32 v48, v60, v8
    v_mul_f32 v49, v60, v9
    v_lshlrev_b32 v10, 16, v243
    v_and_b32 v11, s67, v243
    v_mul_f32 v50, v60, v10
    v_mul_f32 v51, v60, v11
    s_waitcnt vmcnt(7)
    s_cmp_ge_u32 s101, 3
    s_cbranch_scc1 L_go293
    s_waitcnt vmcnt(6)
    s_cmp_ge_u32 s101, 2
    s_cbranch_scc1 L_go293
    s_waitcnt vmcnt(5)
    s_cmp_ge_u32 s101, 1
    s_cbranch_scc1 L_go293
    s_waitcnt vmcnt(4)
L_go293:
    buffer_load_dwordx4 v[116:119], v2, s[36:39], s66 offen offset:128 nt
    v_lshlrev_b32 v4, 16, v244
    v_and_b32 v5, s67, v244
    v_mul_f32 v52, v60, v4
    v_mul_f32 v53, v60, v5
    v_lshlrev_b32 v6, 16, v245
    v_and_b32 v7, s67, v245
    v_mul_f32 v54, v60, v6
    v_mul_f32 v55, v60, v7
    v_lshlrev_b32 v8, 16, v246
    v_and_b32 v9, s67, v246
    v_mul_f32 v56, v60, v8
    v_mul_f32 v57, v60, v9
    v_lshlrev_b32 v10, 16, v247
    v_and_b32 v11, s67, v247
    v_mul_f32 v58, v60, v10
    v_mul_f32 v59, v60, v11
    v_sub_f32 v64, v64, v22
    v_mul_f32 v64, 0x3fb8aa3b, v64
    v_exp_f32 v64, v64
    s_nop 0
    v_add_f32 v23, v23, v64
    v_sub_f32 v65, v65, v22
    v_mul_f32 v65, 0x3fb8aa3b, v65
    v_exp_f32 v65, v65
    s_nop 0
    v_add_f32 v23, v23, v65
    v_sub_f32 v66, v66, v22
    v_mul_f32 v66, 0x3fb8aa3b, v66
    v_exp_f32 v66, v66
    s_nop 0
    v_add_f32 v23, v23, v66
    v_sub_f32 v67, v67, v22
    v_mul_f32 v67, 0x3fb8aa3b, v67
    v_exp_f32 v67, v67
    s_nop 0
    v_add_f32 v23, v23, v67
    s_waitcnt vmcnt(7)
    s_cmp_ge_u32 s101, 3
    s_cbranch_scc1 L_go294
    s_waitcnt vmcnt(6)
    s_cmp_ge_u32 s101, 2
    s_cbranch_scc1 L_go294
    s_waitcnt vmcnt(5)
    s_cmp_ge_u32 s101, 1
    s_cbranch_scc1 L_go294
    s_waitcnt vmcnt(4)
L_go294:
    buffer_load_dwordx4 v[120:123], v2, s[36:39], s66 offen offset:256 nt
    v_lshlrev_b32 v4, 16, v248
    v_and_b32 v5, s67, v248
    v_fmac_f32 v36, v61, v4
    v_fmac_f32 v37, v61, v5
    v_lshlrev_b32 v6, 16, v249
    v_and_b32 v7, s67, v249
    v_fmac_f32 v38, v61, v6
    v_fmac_f32 v39, v61, v7
    v_lshlrev_b32 v8, 16, v250
    v_and_b32 v9, s67, v250
    v_fmac_f32 v40, v61, v8
    v_fmac_f32 v41, v61, v9
    v_lshlrev_b32 v10, 16, v251
    v_and_b32 v11, s67, v251
    v_fmac_f32 v42, v61, v10
    v_fmac_f32 v43, v61, v11
    s_waitcnt vmcnt(7)
    s_cmp_ge_u32 s101, 3
    s_cbranch_scc1 L_go295
    s_waitcnt vmcnt(6)
    s_cmp_ge_u32 s101, 2
    s_cbranch_scc1 L_go295
    s_waitcnt vmcnt(5)
    s_cmp_ge_u32 s101, 1
    s_cbranch_scc1 L_go295
    s_waitcnt vmcnt(4)
L_go295:
    s_add_u32 s66, s79, 4
    s_and_b32 s66, s66, 31
    s_mul_i32 s66, s66, 98304
    s_add_u32 s66, s66, s75
    buffer_load_dwordx4 v[124:127], v2, s[36:39], s66 offen offset:0 nt
    v_lshlrev_b32 v4, 16, v92
    v_and_b32 v5, s67, v92
    v_fmac_f32 v44, v61, v4
    v_fmac_f32 v45, v61, v5
    v_lshlrev_b32 v6, 16, v93
    v_and_b32 v7, s67, v93
    v_fmac_f32 v46, v61, v6
    v_fmac_f32 v47, v61, v7
    v_lshlrev_b32 v8, 16, v94
    v_and_b32 v9, s67, v94
    v_fmac_f32 v48, v61, v8
    v_fmac_f32 v49, v61, v9
    v_lshlrev_b32 v10, 16, v95
    v_and_b32 v11, s67, v95
    v_fmac_f32 v50, v61, v10
    v_fmac_f32 v51, v61, v11
    s_waitcnt vmcnt(7)
    s_cmp_ge_u32 s101, 3
    s_cbranch_scc1 L_go296
    s_waitcnt vmcnt(6)
    s_cmp_ge_u32 s101, 2
    s_cbranch_scc1 L_go296
    s_waitcnt vmcnt(5)
    s_cmp_ge_u32 s101, 1
    s_cbranch_scc1 L_go296
    s_waitcnt vmcnt(4)
L_go296:
    buffer_load_dwordx4 v[128:131], v2, s[36:39], s66 offen offset:128 nt
    v_lshlrev_b32 v4, 16, v96
    v_and_b32 v5, s67, v96
    v_fmac_f32 v52, v61, v4
    v_fmac_f32 v53, v61, v5
    v_lshlrev_b32 v6, 16, v97
    v_and_b32 v7, s67, v97
    v_fmac_f32 v54, v61, v6
    v_fmac_f32 v55, v61, v7
    v_lshlrev_b32 v8, 16, v98
    v_and_b32 v9, s67, v98
    v_fmac_f32 v56, v61, v8
    v_fmac_f32 v57, v61, v9
    v_lshlrev_b32 v10, 16, v99
    v_and_b32 v11, s67, v99
    v_fmac_f32 v58, v61, v10
    v_fmac_f32 v59, v61, v11
    v_sub_f32 v68, v68, v22
    v_mul_f32 v68, 0x3fb8aa3b, v68
    v_exp_f32 v68, v68
    s_nop 0
    v_add_f32 v23, v23, v68
    v_sub_f32 v69, v69, v22
    v_mul_f32 v69, 0x3fb8aa3b, v69
    v_exp_f32 v69, v69
    s_nop 0
    v_add_f32 v23, v23, v69
    v_sub_f32 v70, v70, v22
    v_mul_f32 v70, 0x3fb8aa3b, v70
    v_exp_f32 v70, v70
    s_nop 0
    v_add_f32 v23, v23, v70
    v_sub_f32 v71, v71, v22
    v_mul_f32 v71, 0x3fb8aa3b, v71
    v_exp_f32 v71, v71
    s_nop 0
    v_add_f32 v23, v23, v71
    s_waitcnt vmcnt(7)
    s_cmp_ge_u32 s101, 3
    s_cbranch_scc1 L_go297
    s_waitcnt vmcnt(6)
    s_cmp_ge_u32 s101, 2
    s_cbranch_scc1 L_go297
    s_waitcnt vmcnt(5)
    s_cmp_ge_u32 s101, 1
    s_cbranch_scc1 L_go297
    s_waitcnt vmcnt(4)
L_go297:
    buffer_load_dwordx4 v[132:135], v2, s[36:39], s66 offen offset:256 nt
    v_lshlrev_b32 v4, 16, v100
    v_and_b32 v5, s67, v100
    v_fmac_f32 v36, v62, v4
    v_fmac_f32 v37, v62, v5
    v_lshlrev_b32 v6, 16, v101
    v_and_b32 v7, s67, v101
    v_fmac_f32 v38, v62, v6
    v_fmac_f32 v39, v62, v7
    v_lshlrev_b32 v8, 16, v102
    v_and_b32 v9, s67, v102
    v_fmac_f32 v40, v62, v8
    v_fmac_f32 v41, v62, v9
    v_lshlrev_b32 v10, 16, v103
    v_and_b32 v11, s67, v103
    v_fmac_f32 v42, v62, v10
    v_fmac_f32 v43, v62, v11
    s_waitcnt vmcnt(7)
    s_cmp_ge_u32 s101, 3
    s_cbranch_scc1 L_go298
    s_waitcnt vmcnt(6)
    s_cmp_ge_u32 s101, 2
    s_cbranch_scc1 L_go298
    s_waitcnt vmcnt(5)
    s_cmp_ge_u32 s101, 1
    s_cbranch_scc1 L_go298
    s_waitcnt vmcnt(4)
L_go298:
    s_add_u32 s66, s79, 5
    s_and_b32 s66, s66, 31
    s_mul_i32 s66, s66, 98304
    s_add_u32 s66, s66, s75
    buffer_load_dwordx4 v[136:139], v2, s[36:39], s66 offen offset:0 nt
    v_lshlrev_b32 v4, 16, v104
    v_and_b32 v5, s67, v104
    v_fmac_f32 v44, v62, v4
    v_fmac_f32 v45, v62, v5
    v_lshlrev_b32 v6, 16, v105
    v_and_b32 v7, s67, v105
    v_fmac_f32 v46, v62, v6
    v_fmac_f32 v47, v62, v7
    v_lshlrev_b32 v8, 16, v106
    v_and_b32 v9, s67, v106
    v_fmac_f32 v48, v62, v8
    v_fmac_f32 v49, v62, v9
    v_lshlrev_b32 v10, 16, v107
    v_and_b32 v11, s67, v107
    v_fmac_f32 v50, v62, v10
    v_fmac_f32 v51, v62, v11
    s_waitcnt lgkmcnt(0)
    s_cmp_eq_u32 s76, 0
    s_cbranch_scc1 L_fb12b
    s_mov_b32 s23, 0
    s_min_u32 s4, s4, s20
    s_sub_u32 s4, s22, s4
    s_add_u32 s23, s23, s4
    s_min_u32 s5, s5, s20
    s_sub_u32 s5, s22, s5
    s_add_u32 s23, s23, s5
    s_min_u32 s6, s6, s20
    s_sub_u32 s6, s22, s6
    s_add_u32 s23, s23, s6
    s_min_u32 s7, s7, s20
    s_sub_u32 s7, s22, s7
    s_add_u32 s23, s23, s7
    s_min_u32 s8, s8, s20
    s_sub_u32 s8, s22, s8
    s_add_u32 s23, s23, s8
    s_min_u32 s9, s9, s20
    s_sub_u32 s9, s22, s9
    s_add_u32 s23, s23, s9
    s_min_u32 s10, s10, s20
    s_sub_u32 s10, s22, s10
    s_add_u32 s23, s23, s10
    s_min_u32 s11, s11, s20
    s_sub_u32 s11, s22, s11
    s_add_u32 s23, s23, s11
    s_min_u32 s12, s12, s20
    s_sub_u32 s12, s22, s12
    s_add_u32 s23, s23, s12
    s_min_u32 s13, s13, s20
    s_sub_u32 s13, s22, s13
    s_add_u32 s23, s23, s13
    s_min_u32 s14, s14, s20
    s_sub_u32 s14, s22, s14
    s_add_u32 s23, s23, s14
    s_min_u32 s15, s15, s20
    s_sub_u32 s15, s22, s15
    s_add_u32 s23, s23, s15
    s_min_u32 s16, s16, s20
    s_sub_u32 s16, s22, s16
    s_add_u32 s23, s23, s16
    s_min_u32 s17, s17, s20
    s_sub_u32 s17, s22, s17
    s_add_u32 s23, s23, s17
    s_min_u32 s18, s18, s20
    s_sub_u32 s18, s22, s18
    s_add_u32 s23, s23, s18
    s_min_u32 s19, s19, s20
    s_sub_u32 s19, s22, s19
    s_add_u32 s23, s23, s19
    s_ashr_i32 s23, s23, 4
    s_mov_b32 s101, 0
    s_cmp_ge_i32 s23, -60
    s_cselect_b32 s101, 1, s101
    s_cmp_ge_i32 s23, 20
    s_cselect_b32 s101, 2, s101
    s_cmp_ge_i32 s23, 100
    s_cselect_b32 s101, 3, s101
L_fb12b:
    s_nop 2
    v_readfirstlane_b32 s76, v255
    s_waitcnt vmcnt(7)
    s_cmp_ge_u32 s101, 3
    s_cbranch_scc1 L_go299
    s_waitcnt vmcnt(6)
    s_cmp_ge_u32 s101, 2
    s_cbranch_scc1 L_go299
    s_waitcnt vmcnt(5)
    s_cmp_ge_u32 s101, 1
    s_cbranch_scc1 L_go299
    s_waitcnt vmcnt(4)
L_go299:
    buffer_load_dwordx4 v[140:143], v2, s[36:39], s66 offen offset:128 nt
    v_lshlrev_b32 v4, 16, v108
    v_and_b32 v5, s67, v108
    v_fmac_f32 v52, v62, v4
    v_fmac_f32 v53, v62, v5
    v_lshlrev_b32 v6, 16, v109
    v_and_b32 v7, s67, v109
    v_fmac_f32 v54, v62, v6
    v_fmac_f32 v55, v62, v7
    v_lshlrev_b32 v8, 16, v110
    v_and_b32 v9, s67, v110
    v_fmac_f32 v56, v62, v8
    v_fmac_f32 v57, v62, v9
    v_lshlrev_b32 v10, 16, v111
    v_and_b32 v11, s67, v111
    v_fmac_f32 v58, v62, v10
    v_fmac_f32 v59, v62, v11
    v_sub_f32 v72, v72, v22
    v_mul_f32 v72, 0x3fb8aa3b, v72
    v_exp_f32 v72, v72
    s_nop 0
    v_add_f32 v23, v23, v72
    v_sub_f32 v73, v73, v22
    v_mul_f32 v73, 0x3fb8aa3b, v73
    v_exp_f32 v73, v73
    s_nop 0
    v_add_f32 v23, v23, v73
    v_sub_f32 v74, v74, v22
    v_mul_f32 v74, 0x3fb8aa3b, v74
    v_exp_f32 v74, v74
    s_nop 0
    v_add_f32 v23, v23, v74
    v_sub_f32 v75, v75, v22
    v_mul_f32 v75, 0x3fb8aa3b, v75
    v_exp_f32 v75, v75
    s_nop 0
    v_add_f32 v23, v23, v75
    s_waitcnt vmcnt(7)
    s_cmp_ge_u32 s101, 3
    s_cbranch_scc1 L_go300
    s_waitcnt vmcnt(6)
    s_cmp_ge_u32 s101, 2
    s_cbranch_scc1 L_go300
    s_waitcnt vmcnt(5)
    s_cmp_ge_u32 s101, 1
    s_cbranch_scc1 L_go300
    s_waitcnt vmcnt(4)
L_go300:
    buffer_load_dwordx4 v[144:147], v2, s[36:39], s66 offen offset:256 nt
    v_lshlrev_b32 v4, 16, v112
    v_and_b32 v5, s67, v112
    v_fmac_f32 v36, v63, v4
    v_fmac_f32 v37, v63, v5
    v_lshlrev_b32 v6, 16, v113
    v_and_b32 v7, s67, v113
    v_fmac_f32 v38, v63, v6
    v_fmac_f32 v39, v63, v7
    v_lshlrev_b32 v8, 16, v114
    v_and_b32 v9, s67, v114
    v_fmac_f32 v40, v63, v8
    v_fmac_f32 v41, v63, v9
    v_lshlrev_b32 v10, 16, v115
    v_and_b32 v11, s67, v115
    v_fmac_f32 v42, v63, v10
    v_fmac_f32 v43, v63, v11
    s_waitcnt vmcnt(7)
    s_cmp_ge_u32 s101, 3
    s_cbranch_scc1 L_go301
    s_waitcnt vmcnt(6)
    s_cmp_ge_u32 s101, 2
    s_cbranch_scc1 L_go301
    s_waitcnt vmcnt(5)
    s_cmp_ge_u32 s101, 1
    s_cbranch_scc1 L_go301
    s_waitcnt vmcnt(4)
L_go301:
    s_add_u32 s66, s79, 6
    s_and_b32 s66, s66, 31
    s_mul_i32 s66, s66, 98304
    s_add_u32 s66, s66, s75
    buffer_load_dwordx4 v[148:151], v2, s[36:39], s66 offen offset:0 nt
    v_lshlrev_b32 v4, 16, v116
    v_and_b32 v5, s67, v116
    v_fmac_f32 v44, v63, v4
    v_fmac_f32 v45, v63, v5
    v_lshlrev_b32 v6, 16, v117
    v_and_b32 v7, s67, v117
    v_fmac_f32 v46, v63, v6
    v_fmac_f32 v47, v63, v7
    v_lshlrev_b32 v8, 16, v118
    v_and_b32 v9, s67, v118
    v_fmac_f32 v48, v63, v8
    v_fmac_f32 v49, v63, v9
    v_lshlrev_b32 v10, 16, v119
    v_and_b32 v11, s67, v119
    v_fmac_f32 v50, v63, v10
    v_fmac_f32 v51, v63, v11
    s_waitcnt vmcnt(7)
    s_cmp_ge_u32 s101, 3
    s_cbranch_scc1 L_go302
    s_waitcnt vmcnt(6)
    s_cmp_ge_u32 s101, 2
    s_cbranch_scc1 L_go302
    s_waitcnt vmcnt(5)
    s_cmp_ge_u32 s101, 1
    s_cbranch_scc1 L_go302
    s_waitcnt vmcnt(4)
L_go302:
    buffer_load_dwordx4 v[152:155], v2, s[36:39], s66 offen offset:128 nt
    v_lshlrev_b32 v4, 16, v120
    v_and_b32 v5, s67, v120
    v_fmac_f32 v52, v63, v4
    v_fmac_f32 v53, v63, v5
    v_lshlrev_b32 v6, 16, v121
    v_and_b32 v7, s67, v121
    v_fmac_f32 v54, v63, v6
    v_fmac_f32 v55, v63, v7
    v_lshlrev_b32 v8, 16, v122
    v_and_b32 v9, s67, v122
    v_fmac_f32 v56, v63, v8
    v_fmac_f32 v57, v63, v9
    v_lshlrev_b32 v10, 16, v123
    v_and_b32 v11, s67, v123
    v_fmac_f32 v58, v63, v10
    v_fmac_f32 v59, v63, v11
    v_sub_f32 v76, v76, v22
    v_mul_f32 v76, 0x3fb8aa3b, v76
    v_exp_f32 v76, v76
    s_nop 0
    v_add_f32 v23, v23, v76
    v_sub_f32 v77, v77, v22
    v_mul_f32 v77, 0x3fb8aa3b, v77
    v_exp_f32 v77, v77
    s_nop 0
    v_add_f32 v23, v23, v77
    v_sub_f32 v78, v78, v22
    v_mul_f32 v78, 0x3fb8aa3b, v78
    v_exp_f32 v78, v78
    s_nop 0
    v_add_f32 v23, v23, v78
    v_sub_f32 v79, v79, v22
    v_mul_f32 v79, 0x3fb8aa3b, v79
    v_exp_f32 v79, v79
    s_nop 0
    v_add_f32 v23, v23, v79
    s_waitcnt vmcnt(7)
    s_cmp_ge_u32 s101, 3
    s_cbranch_scc1 L_go303
    s_waitcnt vmcnt(6)
    s_cmp_ge_u32 s101, 2
    s_cbranch_scc1 L_go303
    s_waitcnt vmcnt(5)
    s_cmp_ge_u32 s101, 1
    s_cbranch_scc1 L_go303
    s_waitcnt vmcnt(4)
L_go303:
    buffer_load_dwordx4 v[156:159], v2, s[36:39], s66 offen offset:256 nt
    v_lshlrev_b32 v4, 16, v124
    v_and_b32 v5, s67, v124
    v_fmac_f32 v36, v64, v4
    v_fmac_f32 v37, v64, v5
    v_lshlrev_b32 v6, 16, v125
    v_and_b32 v7, s67, v125
    v_fmac_f32 v38, v64, v6
    v_fmac_f32 v39, v64, v7
    v_lshlrev_b32 v8, 16, v126
    v_and_b32 v9, s67, v126
    v_fmac_f32 v40, v64, v8
    v_fmac_f32 v41, v64, v9
    v_lshlrev_b32 v10, 16, v127
    v_and_b32 v11, s67, v127
    v_fmac_f32 v42, v64, v10
    v_fmac_f32 v43, v64, v11
    s_waitcnt vmcnt(7)
    s_cmp_ge_u32 s101, 3
    s_cbranch_scc1 L_go304
    s_waitcnt vmcnt(6)
    s_cmp_ge_u32 s101, 2
    s_cbranch_scc1 L_go304
    s_waitcnt vmcnt(5)
    s_cmp_ge_u32 s101, 1
    s_cbranch_scc1 L_go304
    s_waitcnt vmcnt(4)
L_go304:
    s_add_u32 s66, s79, 7
    s_and_b32 s66, s66, 31
    s_mul_i32 s66, s66, 98304
    s_add_u32 s66, s66, s75
    buffer_load_dwordx4 v[160:163], v2, s[36:39], s66 offen offset:0 nt
    v_lshlrev_b32 v4, 16, v128
    v_and_b32 v5, s67, v128
    v_fmac_f32 v44, v64, v4
    v_fmac_f32 v45, v64, v5
    v_lshlrev_b32 v6, 16, v129
    v_and_b32 v7, s67, v129
    v_fmac_f32 v46, v64, v6
    v_fmac_f32 v47, v64, v7
    v_lshlrev_b32 v8, 16, v130
    v_and_b32 v9, s67, v130
    v_fmac_f32 v48, v64, v8
    v_fmac_f32 v49, v64, v9
    v_lshlrev_b32 v10, 16, v131
    v_and_b32 v11, s67, v131
    v_fmac_f32 v50, v64, v10
    v_fmac_f32 v51, v64, v11
    s_waitcnt vmcnt(7)
    s_cmp_ge_u32 s101, 3
    s_cbranch_scc1 L_go305
    s_waitcnt vmcnt(6)
    s_cmp_ge_u32 s101, 2
    s_cbranch_scc1 L_go305
    s_waitcnt vmcnt(5)
    s_cmp_ge_u32 s101, 1
    s_cbranch_scc1 L_go305
    s_waitcnt vmcnt(4)
L_go305:
    buffer_load_dwordx4 v[164:167], v2, s[36:39], s66 offen offset:128 nt
    v_lshlrev_b32 v4, 16, v132
    v_and_b32 v5, s67, v132
    v_fmac_f32 v52, v64, v4
    v_fmac_f32 v53, v64, v5
    v_lshlrev_b32 v6, 16, v133
    v_and_b32 v7, s67, v133
    v_fmac_f32 v54, v64, v6
    v_fmac_f32 v55, v64, v7
    v_lshlrev_b32 v8, 16, v134
    v_and_b32 v9, s67, v134
    v_fmac_f32 v56, v64, v8
    v_fmac_f32 v57, v64, v9
    v_lshlrev_b32 v10, 16, v135
    v_and_b32 v11, s67, v135
    v_fmac_f32 v58, v64, v10
    v_fmac_f32 v59, v64, v11
    v_sub_f32 v80, v80, v22
    v_mul_f32 v80, 0x3fb8aa3b, v80
    v_exp_f32 v80, v80
    s_nop 0
    v_add_f32 v23, v23, v80
    v_sub_f32 v81, v81, v22
    v_mul_f32 v81, 0x3fb8aa3b, v81
    v_exp_f32 v81, v81
    s_nop 0
    v_add_f32 v23, v23, v81
    v_sub_f32 v82, v82, v22
    v_mul_f32 v82, 0x3fb8aa3b, v82
    v_exp_f32 v82, v82
    s_nop 0
    v_add_f32 v23, v23, v82
    v_sub_f32 v83, v83, v22
    v_mul_f32 v83, 0x3fb8aa3b, v83
    v_exp_f32 v83, v83
    s_nop 0
    v_add_f32 v23, v23, v83
    s_waitcnt vmcnt(7)
    s_cmp_ge_u32 s101, 3
    s_cbranch_scc1 L_go306
    s_waitcnt vmcnt(6)
    s_cmp_ge_u32 s101, 2
    s_cbranch_scc1 L_go306
    s_waitcnt vmcnt(5)
    s_cmp_ge_u32 s101, 1
    s_cbranch_scc1 L_go306
    s_waitcnt vmcnt(4)
L_go306:
    buffer_load_dwordx4 v[168:171], v2, s[36:39], s66 offen offset:256 nt
    v_lshlrev_b32 v4, 16, v136
    v_and_b32 v5, s67, v136
    v_fmac_f32 v36, v65, v4
    v_fmac_f32 v37, v65, v5
    v_lshlrev_b32 v6, 16, v137
    v_and_b32 v7, s67, v137
    v_fmac_f32 v38, v65, v6
    v_fmac_f32 v39, v65, v7
    v_lshlrev_b32 v8, 16, v138
    v_and_b32 v9, s67, v138
    v_fmac_f32 v40, v65, v8
    v_fmac_f32 v41, v65, v9
    v_lshlrev_b32 v10, 16, v139
    v_and_b32 v11, s67, v139
    v_fmac_f32 v42, v65, v10
    v_fmac_f32 v43, v65, v11
    s_waitcnt vmcnt(7)
    s_cmp_ge_u32 s101, 3
    s_cbranch_scc1 L_go307
    s_waitcnt vmcnt(6)
    s_cmp_ge_u32 s101, 2
    s_cbranch_scc1 L_go307
    s_waitcnt vmcnt(5)
    s_cmp_ge_u32 s101, 1
    s_cbranch_scc1 L_go307
    s_waitcnt vmcnt(4)
L_go307:
    s_add_u32 s66, s79, 8
    s_and_b32 s66, s66, 31
    s_mul_i32 s66, s66, 98304
    s_add_u32 s66, s66, s75
    buffer_load_dwordx4 v[172:175], v2, s[36:39], s66 offen offset:0 nt
    v_lshlrev_b32 v4, 16, v140
    v_and_b32 v5, s67, v140
    v_fmac_f32 v44, v65, v4
    v_fmac_f32 v45, v65, v5
    v_lshlrev_b32 v6, 16, v141
    v_and_b32 v7, s67, v141
    v_fmac_f32 v46, v65, v6
    v_fmac_f32 v47, v65, v7
    v_lshlrev_b32 v8, 16, v142
    v_and_b32 v9, s67, v142
    v_fmac_f32 v48, v65, v8
    v_fmac_f32 v49, v65, v9
    v_lshlrev_b32 v10, 16, v143
    v_and_b32 v11, s67, v143
    v_fmac_f32 v50, v65, v10
    v_fmac_f32 v51, v65, v11
    s_mov_b32 s22, s20
    s_memrealtime s[20:21]
    s_waitcnt vmcnt(7)
    s_cmp_ge_u32 s101, 3
    s_cbranch_scc1 L_go308
    s_waitcnt vmcnt(6)
    s_cmp_ge_u32 s101, 2
    s_cbranch_scc1 L_go308
    s_waitcnt vmcnt(5)
    s_cmp_ge_u32 s101, 1
    s_cbranch_scc1 L_go308
    s_waitcnt vmcnt(4)
L_go308:
    buffer_load_dwordx4 v[176:179], v2, s[36:39], s66 offen offset:128 nt
    v_lshlrev_b32 v4, 16, v144
    v_and_b32 v5, s67, v144
    v_fmac_f32 v52, v65, v4
    v_fmac_f32 v53, v65, v5
    v_lshlrev_b32 v6, 16, v145
    v_and_b32 v7, s67, v145
    v_fmac_f32 v54, v65, v6
    v_fmac_f32 v55, v65, v7
    v_lshlrev_b32 v8, 16, v146
    v_and_b32 v9, s67, v146
    v_fmac_f32 v56, v65, v8
    v_fmac_f32 v57, v65, v9
    v_lshlrev_b32 v10, 16, v147
    v_and_b32 v11, s67, v147
    v_fmac_f32 v58, v65, v10
    v_fmac_f32 v59, v65, v11
    s_waitcnt lgkmcnt(0)
    v_mov_b32 v254, s20
    s_mov_b32 s70, 984704
    buffer_store_dword v254, v253, s[56:59], s70 offen sc1
    s_cmp_eq_u32 s76, 0
    s_cbranch_scc1 L_fb13a
    s_load_dwordx16 s[4:19], s[24:25], 984576
L_fb13a:
    ds_read_b32 v255, v3 offset:8
    v_sub_f32 v84, v84, v22
    v_mul_f32 v84, 0x3fb8aa3b, v84
    v_exp_f32 v84, v84
    s_nop 0
    v_add_f32 v23, v23, v84
    v_sub_f32 v85, v85, v22
    v_mul_f32 v85, 0x3fb8aa3b, v85
    v_exp_f32 v85, v85
    s_nop 0
    v_add_f32 v23, v23, v85
    v_sub_f32 v86, v86, v22
    v_mul_f32 v86, 0x3fb8aa3b, v86
    v_exp_f32 v86, v86
    s_nop 0
    v_add_f32 v23, v23, v86
    v_sub_f32 v87, v87, v22
    v_mul_f32 v87, 0x3fb8aa3b, v87
    v_exp_f32 v87, v87
    s_nop 0
    v_add_f32 v23, v23, v87
    s_waitcnt vmcnt(7)
    s_cmp_ge_u32 s101, 3
    s_cbranch_scc1 L_go309
    s_waitcnt vmcnt(6)
    s_cmp_ge_u32 s101, 2
    s_cbranch_scc1 L_go309
    s_waitcnt vmcnt(5)
    s_cmp_ge_u32 s101, 1
    s_cbranch_scc1 L_go309
    s_waitcnt vmcnt(4)
L_go309:
    buffer_load_dwordx4 v[180:183], v2, s[36:39], s66 offen offset:256 nt
    v_lshlrev_b32 v4, 16, v148
    v_and_b32 v5, s67, v148
    v_fmac_f32 v36, v66, v4
    v_fmac_f32 v37, v66, v5
    v_lshlrev_b32 v6, 16, v149
    v_and_b32 v7, s67, v149
    v_fmac_f32 v38, v66, v6
    v_fmac_f32 v39, v66, v7
    v_lshlrev_b32 v8, 16, v150
    v_and_b32 v9, s67, v150
    v_fmac_f32 v40, v66, v8
    v_fmac_f32 v41, v66, v9
    v_lshlrev_b32 v10, 16, v151
    v_and_b32 v11, s67, v151
    v_fmac_f32 v42, v66, v10
    v_fmac_f32 v43, v66, v11
    s_waitcnt vmcnt(7)
    s_cmp_ge_u32 s101, 3
    s_cbranch_scc1 L_go310
    s_waitcnt vmcnt(6)
    s_cmp_ge_u32 s101, 2
    s_cbranch_scc1 L_go310
    s_waitcnt vmcnt(5)
    s_cmp_ge_u32 s101, 1
    s_cbranch_scc1 L_go310
    s_waitcnt vmcnt(4)
L_go310:
    s_add_u32 s66, s79, 9
    s_and_b32 s66, s66, 31
    s_mul_i32 s66, s66, 98304
    s_add_u32 s66, s66, s75
    buffer_load_dwordx4 v[184:187], v2, s[36:39], s66 offen offset:0 nt
    v_lshlrev_b32 v4, 16, v152
    v_and_b32 v5, s67, v152
    v_fmac_f32 v44, v66, v4
    v_fmac_f32 v45, v66, v5
    v_lshlrev_b32 v6, 16, v153
    v_and_b32 v7, s67, v153
    v_fmac_f32 v46, v66, v6
    v_fmac_f32 v47, v66, v7
    v_lshlrev_b32 v8, 16, v154
    v_and_b32 v9, s67, v154
    v_fmac_f32 v48, v66, v8
    v_fmac_f32 v49, v66, v9
    v_lshlrev_b32 v10, 16, v155
    v_and_b32 v11, s67, v155
    v_fmac_f32 v50, v66, v10
    v_fmac_f32 v51, v66, v11
    s_waitcnt vmcnt(7)
    s_cmp_ge_u32 s101, 3
    s_cbranch_scc1 L_go311
    s_waitcnt vmcnt(6)
    s_cmp_ge_u32 s101, 2
    s_cbranch_scc1 L_go311
    s_waitcnt vmcnt(5)
    s_cmp_ge_u32 s101, 1
    s_cbranch_scc1 L_go311
    s_waitcnt vmcnt(4)
L_go311:
    buffer_load_dwordx4 v[188:191], v2, s[36:39], s66 offen offset:128 nt
    v_lshlrev_b32 v4, 16, v156
    v_and_b32 v5, s67, v156
    v_fmac_f32 v52, v66, v4
    v_fmac_f32 v53, v66, v5
    v_lshlrev_b32 v6, 16, v157
    v_and_b32 v7, s67, v157
    v_fmac_f32 v54, v66, v6
    v_fmac_f32 v55, v66, v7
    v_lshlrev_b32 v8, 16, v158
    v_and_b32 v9, s67, v158
    v_fmac_f32 v56, v66, v8
    v_fmac_f32 v57, v66, v9
    v_lshlrev_b32 v10, 16, v159
    v_and_b32 v11, s67, v159
    v_fmac_f32 v58, v66, v10
    v_fmac_f32 v59, v66, v11
    v_sub_f32 v88, v88, v22
    v_mul_f32 v88, 0x3fb8aa3b, v88
    v_exp_f32 v88, v88
    s_nop 0
    v_add_f32 v23, v23, v88
    v_sub_f32 v89, v89, v22
    v_mul_f32 v89, 0x3fb8aa3b, v89
    v_exp_f32 v89, v89
    s_nop 0
    v_add_f32 v23, v23, v89
    v_sub_f32 v90, v90, v22
    v_mul_f32 v90, 0x3fb8aa3b, v90
    v_exp_f32 v90, v90
    s_nop 0
    v_add_f32 v23, v23, v90
    v_sub_f32 v91, v91, v22
    v_mul_f32 v91, 0x3fb8aa3b, v91
    v_exp_f32 v91, v91
    s_nop 0
    v_add_f32 v23, v23, v91
    s_waitcnt vmcnt(7)
    s_cmp_ge_u32 s101, 3
    s_cbranch_scc1 L_go312
    s_waitcnt vmcnt(6)
    s_cmp_ge_u32 s101, 2
    s_cbranch_scc1 L_go312
    s_waitcnt vmcnt(5)
    s_cmp_ge_u32 s101, 1
    s_cbranch_scc1 L_go312
    s_waitcnt vmcnt(4)
L_go312:
    buffer_load_dwordx4 v[192:195], v2, s[36:39], s66 offen offset:256 nt
    v_lshlrev_b32 v4, 16, v160
    v_and_b32 v5, s67, v160
    v_fmac_f32 v36, v67, v4
    v_fmac_f32 v37, v67, v5
    v_lshlrev_b32 v6, 16, v161
    v_and_b32 v7, s67, v161
    v_fmac_f32 v38, v67, v6
    v_fmac_f32 v39, v67, v7
    v_lshlrev_b32 v8, 16, v162
    v_and_b32 v9, s67, v162
    v_fmac_f32 v40, v67, v8
    v_fmac_f32 v41, v67, v9
    v_lshlrev_b32 v10, 16, v163
    v_and_b32 v11, s67, v163
    v_fmac_f32 v42, v67, v10
    v_fmac_f32 v43, v67, v11
    s_waitcnt vmcnt(7)
    s_cmp_ge_u32 s101, 3
    s_cbranch_scc1 L_go313
    s_waitcnt vmcnt(6)
    s_cmp_ge_u32 s101, 2
    s_cbranch_scc1 L_go313
    s_waitcnt vmcnt(5)
    s_cmp_ge_u32 s101, 1
    s_cbranch_scc1 L_go313
    s_waitcnt vmcnt(4)
L_go313:
    s_add_u32 s66, s79, 10
    s_and_b32 s66, s66, 31
    s_mul_i32 s66, s66, 98304
    s_add_u32 s66, s66, s75
    buffer_load_dwordx4 v[196:199], v2, s[36:39], s66 offen offset:0 nt
    v_lshlrev_b32 v4, 16, v164
    v_and_b32 v5, s67, v164
    v_fmac_f32 v44, v67, v4
    v_fmac_f32 v45, v67, v5
    v_lshlrev_b32 v6, 16, v165
    v_and_b32 v7, s67, v165
    v_fmac_f32 v46, v67, v6
    v_fmac_f32 v47, v67, v7
    v_lshlrev_b32 v8, 16, v166
    v_and_b32 v9, s67, v166
    v_fmac_f32 v48, v67, v8
    v_fmac_f32 v49, v67, v9
    v_lshlrev_b32 v10, 16, v167
    v_and_b32 v11, s67, v167
    v_fmac_f32 v50, v67, v10
    v_fmac_f32 v51, v67, v11
    s_waitcnt vmcnt(7)
    s_cmp_ge_u32 s101, 3
    s_cbranch_scc1 L_go314
    s_waitcnt vmcnt(6)
    s_cmp_ge_u32 s101, 2
    s_cbranch_scc1 L_go314
    s_waitcnt vmcnt(5)
    s_cmp_ge_u32 s101, 1
    s_cbranch_scc1 L_go314
    s_waitcnt vmcnt(4)
L_go314:
    buffer_load_dwordx4 v[200:203], v2, s[36:39], s66 offen offset:128 nt
    v_lshlrev_b32 v4, 16, v168
    v_and_b32 v5, s67, v168
    v_fmac_f32 v52, v67, v4
    v_fmac_f32 v53, v67, v5
    v_lshlrev_b32 v6, 16, v169
    v_and_b32 v7, s67, v169
    v_fmac_f32 v54, v67, v6
    v_fmac_f32 v55, v67, v7
    v_lshlrev_b32 v8, 16, v170
    v_and_b32 v9, s67, v170
    v_fmac_f32 v56, v67, v8
    v_fmac_f32 v57, v67, v9
    v_lshlrev_b32 v10, 16, v171
    v_and_b32 v11, s67, v171
    v_fmac_f32 v58, v67, v10
    v_fmac_f32 v59, v67, v11
    v_add_f32_dpp v23, v23, v23 row_ror:8 row_mask:0xf bank_mask:0xf
    v_mov_b32 v12, v23
    s_nop 1
    v_permlane16_swap_b32 v23, v12
    v_add_f32 v23, v23, v12
    v_mov_b32 v12, v23
    s_nop 1
    v_permlane32_swap_b32 v23, v12
    v_add_f32 v23, v23, v12
    s_lshl_b32 s70, s63, 3
    v_mov_b32 v12, s70
    ds_write_b64 v12, v[22:23] offset:96
    s_waitcnt vmcnt(7)
    s_cmp_ge_u32 s101, 3
    s_cbranch_scc1 L_go315
    s_waitcnt vmcnt(6)
    s_cmp_ge_u32 s101, 2
    s_cbranch_scc1 L_go315
    s_waitcnt vmcnt(5)
    s_cmp_ge_u32 s101, 1
    s_cbranch_scc1 L_go315
    s_waitcnt vmcnt(4)
L_go315:
    buffer_load_dwordx4 v[204:207], v2, s[36:39], s66 offen offset:256 nt
    v_lshlrev_b32 v4, 16, v172
    v_and_b32 v5, s67, v172
    v_fmac_f32 v36, v68, v4
    v_fmac_f32 v37, v68, v5
    v_lshlrev_b32 v6, 16, v173
    v_and_b32 v7, s67, v173
    v_fmac_f32 v38, v68, v6
    v_fmac_f32 v39, v68, v7
    v_lshlrev_b32 v8, 16, v174
    v_and_b32 v9, s67, v174
    v_fmac_f32 v40, v68, v8
    v_fmac_f32 v41, v68, v9
    v_lshlrev_b32 v10, 16, v175
    v_and_b32 v11, s67, v175
    v_fmac_f32 v42, v68, v10
    v_fmac_f32 v43, v68, v11
    s_waitcnt vmcnt(7)
    s_cmp_ge_u32 s101, 3
    s_cbranch_scc1 L_go316
    s_waitcnt vmcnt(6)
    s_cmp_ge_u32 s101, 2
    s_cbranch_scc1 L_go316
    s_waitcnt vmcnt(5)
    s_cmp_ge_u32 s101, 1
    s_cbranch_scc1 L_go316
    s_waitcnt vmcnt(4)
L_go316:
    s_add_u32 s66, s79, 11
    s_and_b32 s66, s66, 31
    s_mul_i32 s66, s66, 98304
    s_add_u32 s66, s66, s75
    buffer_load_dwordx4 v[208:211], v2, s[36:39], s66 offen offset:0 nt
    v_lshlrev_b32 v4, 16, v176
    v_and_b32 v5, s67, v176
    v_fmac_f32 v44, v68, v4
    v_fmac_f32 v45, v68, v5
    v_lshlrev_b32 v6, 16, v177
    v_and_b32 v7, s67, v177
    v_fmac_f32 v46, v68, v6
    v_fmac_f32 v47, v68, v7
    v_lshlrev_b32 v8, 16, v178
    v_and_b32 v9, s67, v178
    v_fmac_f32 v48, v68, v8
    v_fmac_f32 v49, v68, v9
    v_lshlrev_b32 v10, 16, v179
    v_and_b32 v11, s67, v179
    v_fmac_f32 v50, v68, v10
    v_fmac_f32 v51, v68, v11
    s_waitcnt lgkmcnt(0)
    s_cmp_eq_u32 s76, 0
    s_cbranch_scc1 L_fb13b
    s_mov_b32 s23, 0
    s_min_u32 s4, s4, s20
    s_sub_u32 s4, s22, s4
    s_add_u32 s23, s23, s4
    s_min_u32 s5, s5, s20
    s_sub_u32 s5, s22, s5
    s_add_u32 s23, s23, s5
    s_min_u32 s6, s6, s20
    s_sub_u32 s6, s22, s6
    s_add_u32 s23, s23, s6
    s_min_u32 s7, s7, s20
    s_sub_u32 s7, s22, s7
    s_add_u32 s23, s23, s7
    s_min_u32 s8, s8, s20
    s_sub_u32 s8, s22, s8
    s_add_u32 s23, s23, s8
    s_min_u32 s9, s9, s20
    s_sub_u32 s9, s22, s9
    s_add_u32 s23, s23, s9
    s_min_u32 s10, s10, s20
    s_sub_u32 s10, s22, s10
    s_add_u32 s23, s23, s10
    s_min_u32 s11, s11, s20
    s_sub_u32 s11, s22, s11
    s_add_u32 s23, s23, s11
    s_min_u32 s12, s12, s20
    s_sub_u32 s12, s22, s12
    s_add_u32 s23, s23, s12
    s_min_u32 s13, s13, s20
    s_sub_u32 s13, s22, s13
    s_add_u32 s23, s23, s13
    s_min_u32 s14, s14, s20
    s_sub_u32 s14, s22, s14
    s_add_u32 s23, s23, s14
    s_min_u32 s15, s15, s20
    s_sub_u32 s15, s22, s15
    s_add_u32 s23, s23, s15
    s_min_u32 s16, s16, s20
    s_sub_u32 s16, s22, s16
    s_add_u32 s23, s23, s16
    s_min_u32 s17, s17, s20
    s_sub_u32 s17, s22, s17
    s_add_u32 s23, s23, s17
    s_min_u32 s18, s18, s20
    s_sub_u32 s18, s22, s18
    s_add_u32 s23, s23, s18
    s_min_u32 s19, s19, s20
    s_sub_u32 s19, s22, s19
    s_add_u32 s23, s23, s19
    s_ashr_i32 s23, s23, 4
    s_mov_b32 s101, 0
    s_cmp_ge_i32 s23, -60
    s_cselect_b32 s101, 1, s101
    s_cmp_ge_i32 s23, 20
    s_cselect_b32 s101, 2, s101
    s_cmp_ge_i32 s23, 100
    s_cselect_b32 s101, 3, s101
L_fb13b:
    s_nop 2
    v_readfirstlane_b32 s76, v255
    s_waitcnt vmcnt(7)
    s_cmp_ge_u32 s101, 3
    s_cbranch_scc1 L_go317
    s_waitcnt vmcnt(6)
    s_cmp_ge_u32 s101, 2
    s_cbranch_scc1 L_go317
    s_waitcnt vmcnt(5)
    s_cmp_ge_u32 s101, 1
    s_cbranch_scc1 L_go317
    s_waitcnt vmcnt(4)
L_go317:
    buffer_load_dwordx4 v[212:215], v2, s[36:39], s66 offen offset:128 nt
    v_lshlrev_b32 v4, 16, v180
    v_and_b32 v5, s67, v180
    v_fmac_f32 v52, v68, v4
    v_fmac_f32 v53, v68, v5
    v_lshlrev_b32 v6, 16, v181
    v_and_b32 v7, s67, v181
    v_fmac_f32 v54, v68, v6
    v_fmac_f32 v55, v68, v7
    v_lshlrev_b32 v8, 16, v182
    v_and_b32 v9, s67, v182
    v_fmac_f32 v56, v68, v8
    v_fmac_f32 v57, v68, v9
    v_lshlrev_b32 v10, 16, v183
    v_and_b32 v11, s67, v183
    v_fmac_f32 v58, v68, v10
    v_fmac_f32 v59, v68, v11
    s_waitcnt vmcnt(7)
    s_cmp_ge_u32 s101, 3
    s_cbranch_scc1 L_go318
    s_waitcnt vmcnt(6)
    s_cmp_ge_u32 s101, 2
    s_cbranch_scc1 L_go318
    s_waitcnt vmcnt(5)
    s_cmp_ge_u32 s101, 1
    s_cbranch_scc1 L_go318
    s_waitcnt vmcnt(4)
L_go318:
    buffer_load_dwordx4 v[216:219], v2, s[36:39], s66 offen offset:256 nt
    v_lshlrev_b32 v4, 16, v184
    v_and_b32 v5, s67, v184
    v_fmac_f32 v36, v69, v4
    v_fmac_f32 v37, v69, v5
    v_lshlrev_b32 v6, 16, v185
    v_and_b32 v7, s67, v185
    v_fmac_f32 v38, v69, v6
    v_fmac_f32 v39, v69, v7
    v_lshlrev_b32 v8, 16, v186
    v_and_b32 v9, s67, v186
    v_fmac_f32 v40, v69, v8
    v_fmac_f32 v41, v69, v9
    v_lshlrev_b32 v10, 16, v187
    v_and_b32 v11, s67, v187
    v_fmac_f32 v42, v69, v10
    v_fmac_f32 v43, v69, v11
    s_waitcnt vmcnt(7)
    s_cmp_ge_u32 s101, 3
    s_cbranch_scc1 L_go319
    s_waitcnt vmcnt(6)
    s_cmp_ge_u32 s101, 2
    s_cbranch_scc1 L_go319
    s_waitcnt vmcnt(5)
    s_cmp_ge_u32 s101, 1
    s_cbranch_scc1 L_go319
    s_waitcnt vmcnt(4)
L_go319:
    s_add_u32 s66, s79, 12
    s_and_b32 s66, s66, 31
    s_mul_i32 s66, s66, 98304
    s_add_u32 s66, s66, s75
    buffer_load_dwordx4 v[220:223], v2, s[36:39], s66 offen offset:0 nt
    v_lshlrev_b32 v4, 16, v188
    v_and_b32 v5, s67, v188
    v_fmac_f32 v44, v69, v4
    v_fmac_f32 v45, v69, v5
    v_lshlrev_b32 v6, 16, v189
    v_and_b32 v7, s67, v189
    v_fmac_f32 v46, v69, v6
    v_fmac_f32 v47, v69, v7
    v_lshlrev_b32 v8, 16, v190
    v_and_b32 v9, s67, v190
    v_fmac_f32 v48, v69, v8
    v_fmac_f32 v49, v69, v9
    v_lshlrev_b32 v10, 16, v191
    v_and_b32 v11, s67, v191
    v_fmac_f32 v50, v69, v10
    v_fmac_f32 v51, v69, v11
    s_waitcnt vmcnt(7)
    s_cmp_ge_u32 s101, 3
    s_cbranch_scc1 L_go320
    s_waitcnt vmcnt(6)
    s_cmp_ge_u32 s101, 2
    s_cbranch_scc1 L_go320
    s_waitcnt vmcnt(5)
    s_cmp_ge_u32 s101, 1
    s_cbranch_scc1 L_go320
    s_waitcnt vmcnt(4)
L_go320:
    buffer_load_dwordx4 v[224:227], v2, s[36:39], s66 offen offset:128 nt
    v_lshlrev_b32 v4, 16, v192
    v_and_b32 v5, s67, v192
    v_fmac_f32 v52, v69, v4
    v_fmac_f32 v53, v69, v5
    v_lshlrev_b32 v6, 16, v193
    v_and_b32 v7, s67, v193
    v_fmac_f32 v54, v69, v6
    v_fmac_f32 v55, v69, v7
    v_lshlrev_b32 v8, 16, v194
    v_and_b32 v9, s67, v194
    v_fmac_f32 v56, v69, v8
    v_fmac_f32 v57, v69, v9
    v_lshlrev_b32 v10, 16, v195
    v_and_b32 v11, s67, v195
    v_fmac_f32 v58, v69, v10
    v_fmac_f32 v59, v69, v11
    s_waitcnt vmcnt(7)
    s_cmp_ge_u32 s101, 3
    s_cbranch_scc1 L_go321
    s_waitcnt vmcnt(6)
    s_cmp_ge_u32 s101, 2
    s_cbranch_scc1 L_go321
    s_waitcnt vmcnt(5)
    s_cmp_ge_u32 s101, 1
    s_cbranch_scc1 L_go321
    s_waitcnt vmcnt(4)
L_go321:
    buffer_load_dwordx4 v[228:231], v2, s[36:39], s66 offen offset:256 nt
    v_lshlrev_b32 v4, 16, v196
    v_and_b32 v5, s67, v196
    v_fmac_f32 v36, v70, v4
    v_fmac_f32 v37, v70, v5
    v_lshlrev_b32 v6, 16, v197
    v_and_b32 v7, s67, v197
    v_fmac_f32 v38, v70, v6
    v_fmac_f32 v39, v70, v7
    v_lshlrev_b32 v8, 16, v198
    v_and_b32 v9, s67, v198
    v_fmac_f32 v40, v70, v8
    v_fmac_f32 v41, v70, v9
    v_lshlrev_b32 v10, 16, v199
    v_and_b32 v11, s67, v199
    v_fmac_f32 v42, v70, v10
    v_fmac_f32 v43, v70, v11
    s_waitcnt vmcnt(7)
    s_cmp_ge_u32 s101, 3
    s_cbranch_scc1 L_go322
    s_waitcnt vmcnt(6)
    s_cmp_ge_u32 s101, 2
    s_cbranch_scc1 L_go322
    s_waitcnt vmcnt(5)
    s_cmp_ge_u32 s101, 1
    s_cbranch_scc1 L_go322
    s_waitcnt vmcnt(4)
L_go322:
    s_add_u32 s66, s79, 13
    s_and_b32 s66, s66, 31
    s_mul_i32 s66, s66, 98304
    s_add_u32 s66, s66, s75
    buffer_load_dwordx4 v[232:235], v2, s[36:39], s66 offen offset:0 nt
    v_lshlrev_b32 v4, 16, v200
    v_and_b32 v5, s67, v200
    v_fmac_f32 v44, v70, v4
    v_fmac_f32 v45, v70, v5
    v_lshlrev_b32 v6, 16, v201
    v_and_b32 v7, s67, v201
    v_fmac_f32 v46, v70, v6
    v_fmac_f32 v47, v70, v7
    v_lshlrev_b32 v8, 16, v202
    v_and_b32 v9, s67, v202
    v_fmac_f32 v48, v70, v8
    v_fmac_f32 v49, v70, v9
    v_lshlrev_b32 v10, 16, v203
    v_and_b32 v11, s67, v203
    v_fmac_f32 v50, v70, v10
    v_fmac_f32 v51, v70, v11
    s_waitcnt vmcnt(7)
    s_cmp_ge_u32 s101, 3
    s_cbranch_scc1 L_go323
    s_waitcnt vmcnt(6)
    s_cmp_ge_u32 s101, 2
    s_cbranch_scc1 L_go323
    s_waitcnt vmcnt(5)
    s_cmp_ge_u32 s101, 1
    s_cbranch_scc1 L_go323
    s_waitcnt vmcnt(4)
L_go323:
    buffer_load_dwordx4 v[236:239], v2, s[36:39], s66 offen offset:128 nt
    v_lshlrev_b32 v4, 16, v204
    v_and_b32 v5, s67, v204
    v_fmac_f32 v52, v70, v4
    v_fmac_f32 v53, v70, v5
    v_lshlrev_b32 v6, 16, v205
    v_and_b32 v7, s67, v205
    v_fmac_f32 v54, v70, v6
    v_fmac_f32 v55, v70, v7
    v_lshlrev_b32 v8, 16, v206
    v_and_b32 v9, s67, v206
    v_fmac_f32 v56, v70, v8
    v_fmac_f32 v57, v70, v9
    v_lshlrev_b32 v10, 16, v207
    v_and_b32 v11, s67, v207
    v_fmac_f32 v58, v70, v10
    v_fmac_f32 v59, v70, v11
    s_waitcnt vmcnt(7)
    s_cmp_ge_u32 s101, 3
    s_cbranch_scc1 L_go324
    s_waitcnt vmcnt(6)
    s_cmp_ge_u32 s101, 2
    s_cbranch_scc1 L_go324
    s_waitcnt vmcnt(5)
    s_cmp_ge_u32 s101, 1
    s_cbranch_scc1 L_go324
    s_waitcnt vmcnt(4)
L_go324:
    buffer_load_dwordx4 v[240:243], v2, s[36:39], s66 offen offset:256 nt
    v_lshlrev_b32 v4, 16, v208
    v_and_b32 v5, s67, v208
    v_fmac_f32 v36, v71, v4
    v_fmac_f32 v37, v71, v5
    v_lshlrev_b32 v6, 16, v209
    v_and_b32 v7, s67, v209
    v_fmac_f32 v38, v71, v6
    v_fmac_f32 v39, v71, v7
    v_lshlrev_b32 v8, 16, v210
    v_and_b32 v9, s67, v210
    v_fmac_f32 v40, v71, v8
    v_fmac_f32 v41, v71, v9
    v_lshlrev_b32 v10, 16, v211
    v_and_b32 v11, s67, v211
    v_fmac_f32 v42, v71, v10
    v_fmac_f32 v43, v71, v11
    s_waitcnt vmcnt(7)
    s_cmp_ge_u32 s101, 3
    s_cbranch_scc1 L_go325
    s_waitcnt vmcnt(6)
    s_cmp_ge_u32 s101, 2
    s_cbranch_scc1 L_go325
    s_waitcnt vmcnt(5)
    s_cmp_ge_u32 s101, 1
    s_cbranch_scc1 L_go325
    s_waitcnt vmcnt(4)
L_go325:
    s_add_u32 s66, s79, 14
    s_and_b32 s66, s66, 31
    s_mul_i32 s66, s66, 98304
    s_add_u32 s66, s66, s75
    buffer_load_dwordx4 v[244:247], v2, s[36:39], s66 offen offset:0 nt
    v_lshlrev_b32 v4, 16, v212
    v_and_b32 v5, s67, v212
    v_fmac_f32 v44, v71, v4
    v_fmac_f32 v45, v71, v5
    v_lshlrev_b32 v6, 16, v213
    v_and_b32 v7, s67, v213
    v_fmac_f32 v46, v71, v6
    v_fmac_f32 v47, v71, v7
    v_lshlrev_b32 v8, 16, v214
    v_and_b32 v9, s67, v214
    v_fmac_f32 v48, v71, v8
    v_fmac_f32 v49, v71, v9
    v_lshlrev_b32 v10, 16, v215
    v_and_b32 v11, s67, v215
    v_fmac_f32 v50, v71, v10
    v_fmac_f32 v51, v71, v11
    s_mov_b32 s22, s20
    s_memrealtime s[20:21]
    s_waitcnt vmcnt(7)
    s_cmp_ge_u32 s101, 3
    s_cbranch_scc1 L_go326
    s_waitcnt vmcnt(6)
    s_cmp_ge_u32 s101, 2
    s_cbranch_scc1 L_go326
    s_waitcnt vmcnt(5)
    s_cmp_ge_u32 s101, 1
    s_cbranch_scc1 L_go326
    s_waitcnt vmcnt(4)
L_go326:
    buffer_load_dwordx4 v[248:251], v2, s[36:39], s66 offen offset:128 nt
    v_lshlrev_b32 v4, 16, v216
    v_and_b32 v5, s67, v216
    v_fmac_f32 v52, v71, v4
    v_fmac_f32 v53, v71, v5
    v_lshlrev_b32 v6, 16, v217
    v_and_b32 v7, s67, v217
    v_fmac_f32 v54, v71, v6
    v_fmac_f32 v55, v71, v7
    v_lshlrev_b32 v8, 16, v218
    v_and_b32 v9, s67, v218
    v_fmac_f32 v56, v71, v8
    v_fmac_f32 v57, v71, v9
    v_lshlrev_b32 v10, 16, v219
    v_and_b32 v11, s67, v219
    v_fmac_f32 v58, v71, v10
    v_fmac_f32 v59, v71, v11
    s_waitcnt lgkmcnt(0)
    v_mov_b32 v254, s20
    s_mov_b32 s70, 984832
    buffer_store_dword v254, v253, s[56:59], s70 offen sc1
    s_cmp_eq_u32 s76, 0
    s_cbranch_scc1 L_fb14a
    s_load_dwordx16 s[4:19], s[24:25], 984704
L_fb14a:
    ds_read_b32 v255, v3 offset:8
    s_waitcnt vmcnt(7)
    s_cmp_ge_u32 s101, 3
    s_cbranch_scc1 L_go327
    s_waitcnt vmcnt(6)
    s_cmp_ge_u32 s101, 2
    s_cbranch_scc1 L_go327
    s_waitcnt vmcnt(5)
    s_cmp_ge_u32 s101, 1
    s_cbranch_scc1 L_go327
    s_waitcnt vmcnt(4)
L_go327:
    buffer_load_dwordx4 v[92:95], v2, s[36:39], s66 offen offset:256 nt
    v_lshlrev_b32 v4, 16, v220
    v_and_b32 v5, s67, v220
    v_fmac_f32 v36, v72, v4
    v_fmac_f32 v37, v72, v5
    v_lshlrev_b32 v6, 16, v221
    v_and_b32 v7, s67, v221
    v_fmac_f32 v38, v72, v6
    v_fmac_f32 v39, v72, v7
    v_lshlrev_b32 v8, 16, v222
    v_and_b32 v9, s67, v222
    v_fmac_f32 v40, v72, v8
    v_fmac_f32 v41, v72, v9
    v_lshlrev_b32 v10, 16, v223
    v_and_b32 v11, s67, v223
    v_fmac_f32 v42, v72, v10
    v_fmac_f32 v43, v72, v11
    s_waitcnt vmcnt(7)
    s_cmp_ge_u32 s101, 3
    s_cbranch_scc1 L_go328
    s_waitcnt vmcnt(6)
    s_cmp_ge_u32 s101, 2
    s_cbranch_scc1 L_go328
    s_waitcnt vmcnt(5)
    s_cmp_ge_u32 s101, 1
    s_cbranch_scc1 L_go328
    s_waitcnt vmcnt(4)
L_go328:
    s_add_u32 s66, s79, 15
    s_and_b32 s66, s66, 31
    s_mul_i32 s66, s66, 98304
    s_add_u32 s66, s66, s75
    buffer_load_dwordx4 v[96:99], v2, s[36:39], s66 offen offset:0 nt
    v_lshlrev_b32 v4, 16, v224
    v_and_b32 v5, s67, v224
    v_fmac_f32 v44, v72, v4
    v_fmac_f32 v45, v72, v5
    v_lshlrev_b32 v6, 16, v225
    v_and_b32 v7, s67, v225
    v_fmac_f32 v46, v72, v6
    v_fmac_f32 v47, v72, v7
    v_lshlrev_b32 v8, 16, v226
    v_and_b32 v9, s67, v226
    v_fmac_f32 v48, v72, v8
    v_fmac_f32 v49, v72, v9
    v_lshlrev_b32 v10, 16, v227
    v_and_b32 v11, s67, v227
    v_fmac_f32 v50, v72, v10
    v_fmac_f32 v51, v72, v11
    s_waitcnt vmcnt(7)
    s_cmp_ge_u32 s101, 3
    s_cbranch_scc1 L_go329
    s_waitcnt vmcnt(6)
    s_cmp_ge_u32 s101, 2
    s_cbranch_scc1 L_go329
    s_waitcnt vmcnt(5)
    s_cmp_ge_u32 s101, 1
    s_cbranch_scc1 L_go329
    s_waitcnt vmcnt(4)
L_go329:
    buffer_load_dwordx4 v[100:103], v2, s[36:39], s66 offen offset:128 nt
    v_lshlrev_b32 v4, 16, v228
    v_and_b32 v5, s67, v228
    v_fmac_f32 v52, v72, v4
    v_fmac_f32 v53, v72, v5
    v_lshlrev_b32 v6, 16, v229
    v_and_b32 v7, s67, v229
    v_fmac_f32 v54, v72, v6
    v_fmac_f32 v55, v72, v7
    v_lshlrev_b32 v8, 16, v230
    v_and_b32 v9, s67, v230
    v_fmac_f32 v56, v72, v8
    v_fmac_f32 v57, v72, v9
    v_lshlrev_b32 v10, 16, v231
    v_and_b32 v11, s67, v231
    v_fmac_f32 v58, v72, v10
    v_fmac_f32 v59, v72, v11
    s_waitcnt vmcnt(7)
    s_cmp_ge_u32 s101, 3
    s_cbranch_scc1 L_go330
    s_waitcnt vmcnt(6)
    s_cmp_ge_u32 s101, 2
    s_cbranch_scc1 L_go330
    s_waitcnt vmcnt(5)
    s_cmp_ge_u32 s101, 1
    s_cbranch_scc1 L_go330
    s_waitcnt vmcnt(4)
L_go330:
    buffer_load_dwordx4 v[104:107], v2, s[36:39], s66 offen offset:256 nt
    v_lshlrev_b32 v4, 16, v232
    v_and_b32 v5, s67, v232
    v_fmac_f32 v36, v73, v4
    v_fmac_f32 v37, v73, v5
    v_lshlrev_b32 v6, 16, v233
    v_and_b32 v7, s67, v233
    v_fmac_f32 v38, v73, v6
    v_fmac_f32 v39, v73, v7
    v_lshlrev_b32 v8, 16, v234
    v_and_b32 v9, s67, v234
    v_fmac_f32 v40, v73, v8
    v_fmac_f32 v41, v73, v9
    v_lshlrev_b32 v10, 16, v235
    v_and_b32 v11, s67, v235
    v_fmac_f32 v42, v73, v10
    v_fmac_f32 v43, v73, v11
    s_waitcnt vmcnt(7)
    s_cmp_ge_u32 s101, 3
    s_cbranch_scc1 L_go331
    s_waitcnt vmcnt(6)
    s_cmp_ge_u32 s101, 2
    s_cbranch_scc1 L_go331
    s_waitcnt vmcnt(5)
    s_cmp_ge_u32 s101, 1
    s_cbranch_scc1 L_go331
    s_waitcnt vmcnt(4)
L_go331:
    s_add_u32 s66, s79, 16
    s_and_b32 s66, s66, 31
    s_mul_i32 s66, s66, 98304
    s_add_u32 s66, s66, s75
    buffer_load_dwordx4 v[108:111], v2, s[36:39], s66 offen offset:0 nt
    v_lshlrev_b32 v4, 16, v236
    v_and_b32 v5, s67, v236
    v_fmac_f32 v44, v73, v4
    v_fmac_f32 v45, v73, v5
    v_lshlrev_b32 v6, 16, v237
    v_and_b32 v7, s67, v237
    v_fmac_f32 v46, v73, v6
    v_fmac_f32 v47, v73, v7
    v_lshlrev_b32 v8, 16, v238
    v_and_b32 v9, s67, v238
    v_fmac_f32 v48, v73, v8
    v_fmac_f32 v49, v73, v9
    v_lshlrev_b32 v10, 16, v239
    v_and_b32 v11, s67, v239
    v_fmac_f32 v50, v73, v10
    v_fmac_f32 v51, v73, v11
    s_waitcnt vmcnt(7)
    s_cmp_ge_u32 s101, 3
    s_cbranch_scc1 L_go332
    s_waitcnt vmcnt(6)
    s_cmp_ge_u32 s101, 2
    s_cbranch_scc1 L_go332
    s_waitcnt vmcnt(5)
    s_cmp_ge_u32 s101, 1
    s_cbranch_scc1 L_go332
    s_waitcnt vmcnt(4)
L_go332:
    buffer_load_dwordx4 v[112:115], v2, s[36:39], s66 offen offset:128 nt
    v_lshlrev_b32 v4, 16, v240
    v_and_b32 v5, s67, v240
    v_fmac_f32 v52, v73, v4
    v_fmac_f32 v53, v73, v5
    v_lshlrev_b32 v6, 16, v241
    v_and_b32 v7, s67, v241
    v_fmac_f32 v54, v73, v6
    v_fmac_f32 v55, v73, v7
    v_lshlrev_b32 v8, 16, v242
    v_and_b32 v9, s67, v242
    v_fmac_f32 v56, v73, v8
    v_fmac_f32 v57, v73, v9
    v_lshlrev_b32 v10, 16, v243
    v_and_b32 v11, s67, v243
    v_fmac_f32 v58, v73, v10
    v_fmac_f32 v59, v73, v11
    s_waitcnt vmcnt(7)
    s_cmp_ge_u32 s101, 3
    s_cbranch_scc1 L_go333
    s_waitcnt vmcnt(6)
    s_cmp_ge_u32 s101, 2
    s_cbranch_scc1 L_go333
    s_waitcnt vmcnt(5)
    s_cmp_ge_u32 s101, 1
    s_cbranch_scc1 L_go333
    s_waitcnt vmcnt(4)
L_go333:
    buffer_load_dwordx4 v[116:119], v2, s[36:39], s66 offen offset:256 nt
    v_lshlrev_b32 v4, 16, v244
    v_and_b32 v5, s67, v244
    v_fmac_f32 v36, v74, v4
    v_fmac_f32 v37, v74, v5
    v_lshlrev_b32 v6, 16, v245
    v_and_b32 v7, s67, v245
    v_fmac_f32 v38, v74, v6
    v_fmac_f32 v39, v74, v7
    v_lshlrev_b32 v8, 16, v246
    v_and_b32 v9, s67, v246
    v_fmac_f32 v40, v74, v8
    v_fmac_f32 v41, v74, v9
    v_lshlrev_b32 v10, 16, v247
    v_and_b32 v11, s67, v247
    v_fmac_f32 v42, v74, v10
    v_fmac_f32 v43, v74, v11
    s_waitcnt vmcnt(7)
    s_cmp_ge_u32 s101, 3
    s_cbranch_scc1 L_go334
    s_waitcnt vmcnt(6)
    s_cmp_ge_u32 s101, 2
    s_cbranch_scc1 L_go334
    s_waitcnt vmcnt(5)
    s_cmp_ge_u32 s101, 1
    s_cbranch_scc1 L_go334
    s_waitcnt vmcnt(4)
L_go334:
    s_add_u32 s66, s79, 17
    s_and_b32 s66, s66, 31
    s_mul_i32 s66, s66, 98304
    s_add_u32 s66, s66, s75
    buffer_load_dwordx4 v[120:123], v2, s[36:39], s66 offen offset:0 nt
    v_lshlrev_b32 v4, 16, v248
    v_and_b32 v5, s67, v248
    v_fmac_f32 v44, v74, v4
    v_fmac_f32 v45, v74, v5
    v_lshlrev_b32 v6, 16, v249
    v_and_b32 v7, s67, v249
    v_fmac_f32 v46, v74, v6
    v_fmac_f32 v47, v74, v7
    v_lshlrev_b32 v8, 16, v250
    v_and_b32 v9, s67, v250
    v_fmac_f32 v48, v74, v8
    v_fmac_f32 v49, v74, v9
    v_lshlrev_b32 v10, 16, v251
    v_and_b32 v11, s67, v251
    v_fmac_f32 v50, v74, v10
    v_fmac_f32 v51, v74, v11
    s_waitcnt lgkmcnt(0)
    s_cmp_eq_u32 s76, 0
    s_cbranch_scc1 L_fb14b
    s_mov_b32 s23, 0
    s_min_u32 s4, s4, s20
    s_sub_u32 s4, s22, s4
    s_add_u32 s23, s23, s4
    s_min_u32 s5, s5, s20
    s_sub_u32 s5, s22, s5
    s_add_u32 s23, s23, s5
    s_min_u32 s6, s6, s20
    s_sub_u32 s6, s22, s6
    s_add_u32 s23, s23, s6
    s_min_u32 s7, s7, s20
    s_sub_u32 s7, s22, s7
    s_add_u32 s23, s23, s7
    s_min_u32 s8, s8, s20
    s_sub_u32 s8, s22, s8
    s_add_u32 s23, s23, s8
    s_min_u32 s9, s9, s20
    s_sub_u32 s9, s22, s9
    s_add_u32 s23, s23, s9
    s_min_u32 s10, s10, s20
    s_sub_u32 s10, s22, s10
    s_add_u32 s23, s23, s10
    s_min_u32 s11, s11, s20
    s_sub_u32 s11, s22, s11
    s_add_u32 s23, s23, s11
    s_min_u32 s12, s12, s20
    s_sub_u32 s12, s22, s12
    s_add_u32 s23, s23, s12
    s_min_u32 s13, s13, s20
    s_sub_u32 s13, s22, s13
    s_add_u32 s23, s23, s13
    s_min_u32 s14, s14, s20
    s_sub_u32 s14, s22, s14
    s_add_u32 s23, s23, s14
    s_min_u32 s15, s15, s20
    s_sub_u32 s15, s22, s15
    s_add_u32 s23, s23, s15
    s_min_u32 s16, s16, s20
    s_sub_u32 s16, s22, s16
    s_add_u32 s23, s23, s16
    s_min_u32 s17, s17, s20
    s_sub_u32 s17, s22, s17
    s_add_u32 s23, s23, s17
    s_min_u32 s18, s18, s20
    s_sub_u32 s18, s22, s18
    s_add_u32 s23, s23, s18
    s_min_u32 s19, s19, s20
    s_sub_u32 s19, s22, s19
    s_add_u32 s23, s23, s19
    s_ashr_i32 s23, s23, 4
    s_mov_b32 s101, 0
    s_cmp_ge_i32 s23, -60
    s_cselect_b32 s101, 1, s101
    s_cmp_ge_i32 s23, 20
    s_cselect_b32 s101, 2, s101
    s_cmp_ge_i32 s23, 100
    s_cselect_b32 s101, 3, s101
L_fb14b:
    s_nop 2
    v_readfirstlane_b32 s76, v255
    s_waitcnt vmcnt(7)
    s_cmp_ge_u32 s101, 3
    s_cbranch_scc1 L_go335
    s_waitcnt vmcnt(6)
    s_cmp_ge_u32 s101, 2
    s_cbranch_scc1 L_go335
    s_waitcnt vmcnt(5)
    s_cmp_ge_u32 s101, 1
    s_cbranch_scc1 L_go335
    s_waitcnt vmcnt(4)
L_go335:
    buffer_load_dwordx4 v[124:127], v2, s[36:39], s66 offen offset:128 nt
    v_lshlrev_b32 v4, 16, v92
    v_and_b32 v5, s67, v92
    v_fmac_f32 v52, v74, v4
    v_fmac_f32 v53, v74, v5
    v_lshlrev_b32 v6, 16, v93
    v_and_b32 v7, s67, v93
    v_fmac_f32 v54, v74, v6
    v_fmac_f32 v55, v74, v7
    v_lshlrev_b32 v8, 16, v94
    v_and_b32 v9, s67, v94
    v_fmac_f32 v56, v74, v8
    v_fmac_f32 v57, v74, v9
    v_lshlrev_b32 v10, 16, v95
    v_and_b32 v11, s67, v95
    v_fmac_f32 v58, v74, v10
    v_fmac_f32 v59, v74, v11
    s_waitcnt vmcnt(7)
    s_cmp_ge_u32 s101, 3
    s_cbranch_scc1 L_go336
    s_waitcnt vmcnt(6)
    s_cmp_ge_u32 s101, 2
    s_cbranch_scc1 L_go336
    s_waitcnt vmcnt(5)
    s_cmp_ge_u32 s101, 1
    s_cbranch_scc1 L_go336
    s_waitcnt vmcnt(4)
L_go336:
    buffer_load_dwordx4 v[128:131], v2, s[36:39], s66 offen offset:256 nt
    v_lshlrev_b32 v4, 16, v96
    v_and_b32 v5, s67, v96
    v_fmac_f32 v36, v75, v4
    v_fmac_f32 v37, v75, v5
    v_lshlrev_b32 v6, 16, v97
    v_and_b32 v7, s67, v97
    v_fmac_f32 v38, v75, v6
    v_fmac_f32 v39, v75, v7
    v_lshlrev_b32 v8, 16, v98
    v_and_b32 v9, s67, v98
    v_fmac_f32 v40, v75, v8
    v_fmac_f32 v41, v75, v9
    v_lshlrev_b32 v10, 16, v99
    v_and_b32 v11, s67, v99
    v_fmac_f32 v42, v75, v10
    v_fmac_f32 v43, v75, v11
    s_waitcnt vmcnt(7)
    s_cmp_ge_u32 s101, 3
    s_cbranch_scc1 L_go337
    s_waitcnt vmcnt(6)
    s_cmp_ge_u32 s101, 2
    s_cbranch_scc1 L_go337
    s_waitcnt vmcnt(5)
    s_cmp_ge_u32 s101, 1
    s_cbranch_scc1 L_go337
    s_waitcnt vmcnt(4)
L_go337:
    s_add_u32 s66, s79, 18
    s_and_b32 s66, s66, 31
    s_mul_i32 s66, s66, 98304
    s_add_u32 s66, s66, s75
    buffer_load_dwordx4 v[132:135], v2, s[36:39], s66 offen offset:0 nt
    v_lshlrev_b32 v4, 16, v100
    v_and_b32 v5, s67, v100
    v_fmac_f32 v44, v75, v4
    v_fmac_f32 v45, v75, v5
    v_lshlrev_b32 v6, 16, v101
    v_and_b32 v7, s67, v101
    v_fmac_f32 v46, v75, v6
    v_fmac_f32 v47, v75, v7
    v_lshlrev_b32 v8, 16, v102
    v_and_b32 v9, s67, v102
    v_fmac_f32 v48, v75, v8
    v_fmac_f32 v49, v75, v9
    v_lshlrev_b32 v10, 16, v103
    v_and_b32 v11, s67, v103
    v_fmac_f32 v50, v75, v10
    v_fmac_f32 v51, v75, v11
    s_waitcnt vmcnt(7)
    s_cmp_ge_u32 s101, 3
    s_cbranch_scc1 L_go338
    s_waitcnt vmcnt(6)
    s_cmp_ge_u32 s101, 2
    s_cbranch_scc1 L_go338
    s_waitcnt vmcnt(5)
    s_cmp_ge_u32 s101, 1
    s_cbranch_scc1 L_go338
    s_waitcnt vmcnt(4)
L_go338:
    buffer_load_dwordx4 v[136:139], v2, s[36:39], s66 offen offset:128 nt
    v_lshlrev_b32 v4, 16, v104
    v_and_b32 v5, s67, v104
    v_fmac_f32 v52, v75, v4
    v_fmac_f32 v53, v75, v5
    v_lshlrev_b32 v6, 16, v105
    v_and_b32 v7, s67, v105
    v_fmac_f32 v54, v75, v6
    v_fmac_f32 v55, v75, v7
    v_lshlrev_b32 v8, 16, v106
    v_and_b32 v9, s67, v106
    v_fmac_f32 v56, v75, v8
    v_fmac_f32 v57, v75, v9
    v_lshlrev_b32 v10, 16, v107
    v_and_b32 v11, s67, v107
    v_fmac_f32 v58, v75, v10
    v_fmac_f32 v59, v75, v11
    s_waitcnt vmcnt(7)
    s_cmp_ge_u32 s101, 3
    s_cbranch_scc1 L_go339
    s_waitcnt vmcnt(6)
    s_cmp_ge_u32 s101, 2
    s_cbranch_scc1 L_go339
    s_waitcnt vmcnt(5)
    s_cmp_ge_u32 s101, 1
    s_cbranch_scc1 L_go339
    s_waitcnt vmcnt(4)
L_go339:
    buffer_load_dwordx4 v[140:143], v2, s[36:39], s66 offen offset:256 nt
    v_lshlrev_b32 v4, 16, v108
    v_and_b32 v5, s67, v108
    v_fmac_f32 v36, v76, v4
    v_fmac_f32 v37, v76, v5
    v_lshlrev_b32 v6, 16, v109
    v_and_b32 v7, s67, v109
    v_fmac_f32 v38, v76, v6
    v_fmac_f32 v39, v76, v7
    v_lshlrev_b32 v8, 16, v110
    v_and_b32 v9, s67, v110
    v_fmac_f32 v40, v76, v8
    v_fmac_f32 v41, v76, v9
    v_lshlrev_b32 v10, 16, v111
    v_and_b32 v11, s67, v111
    v_fmac_f32 v42, v76, v10
    v_fmac_f32 v43, v76, v11
    s_waitcnt vmcnt(7)
    s_cmp_ge_u32 s101, 3
    s_cbranch_scc1 L_go340
    s_waitcnt vmcnt(6)
    s_cmp_ge_u32 s101, 2
    s_cbranch_scc1 L_go340
    s_waitcnt vmcnt(5)
    s_cmp_ge_u32 s101, 1
    s_cbranch_scc1 L_go340
    s_waitcnt vmcnt(4)
L_go340:
    s_add_u32 s66, s79, 19
    s_and_b32 s66, s66, 31
    s_mul_i32 s66, s66, 98304
    s_add_u32 s66, s66, s75
    buffer_load_dwordx4 v[144:147], v2, s[36:39], s66 offen offset:0 nt
    v_lshlrev_b32 v4, 16, v112
    v_and_b32 v5, s67, v112
    v_fmac_f32 v44, v76, v4
    v_fmac_f32 v45, v76, v5
    v_lshlrev_b32 v6, 16, v113
    v_and_b32 v7, s67, v113
    v_fmac_f32 v46, v76, v6
    v_fmac_f32 v47, v76, v7
    v_lshlrev_b32 v8, 16, v114
    v_and_b32 v9, s67, v114
    v_fmac_f32 v48, v76, v8
    v_fmac_f32 v49, v76, v9
    v_lshlrev_b32 v10, 16, v115
    v_and_b32 v11, s67, v115
    v_fmac_f32 v50, v76, v10
    v_fmac_f32 v51, v76, v11
    s_waitcnt vmcnt(7)
    s_cmp_ge_u32 s101, 3
    s_cbranch_scc1 L_go341
    s_waitcnt vmcnt(6)
    s_cmp_ge_u32 s101, 2
    s_cbranch_scc1 L_go341
    s_waitcnt vmcnt(5)
    s_cmp_ge_u32 s101, 1
    s_cbranch_scc1 L_go341
    s_waitcnt vmcnt(4)
L_go341:
    buffer_load_dwordx4 v[148:151], v2, s[36:39], s66 offen offset:128 nt
    v_lshlrev_b32 v4, 16, v116
    v_and_b32 v5, s67, v116
    v_fmac_f32 v52, v76, v4
    v_fmac_f32 v53, v76, v5
    v_lshlrev_b32 v6, 16, v117
    v_and_b32 v7, s67, v117
    v_fmac_f32 v54, v76, v6
    v_fmac_f32 v55, v76, v7
    v_lshlrev_b32 v8, 16, v118
    v_and_b32 v9, s67, v118
    v_fmac_f32 v56, v76, v8
    v_fmac_f32 v57, v76, v9
    v_lshlrev_b32 v10, 16, v119
    v_and_b32 v11, s67, v119
    v_fmac_f32 v58, v76, v10
    v_fmac_f32 v59, v76, v11
    s_waitcnt vmcnt(7)
    s_cmp_ge_u32 s101, 3
    s_cbranch_scc1 L_go342
    s_waitcnt vmcnt(6)
    s_cmp_ge_u32 s101, 2
    s_cbranch_scc1 L_go342
    s_waitcnt vmcnt(5)
    s_cmp_ge_u32 s101, 1
    s_cbranch_scc1 L_go342
    s_waitcnt vmcnt(4)
L_go342:
    buffer_load_dwordx4 v[152:155], v2, s[36:39], s66 offen offset:256 nt
    v_lshlrev_b32 v4, 16, v120
    v_and_b32 v5, s67, v120
    v_fmac_f32 v36, v77, v4
    v_fmac_f32 v37, v77, v5
    v_lshlrev_b32 v6, 16, v121
    v_and_b32 v7, s67, v121
    v_fmac_f32 v38, v77, v6
    v_fmac_f32 v39, v77, v7
    v_lshlrev_b32 v8, 16, v122
    v_and_b32 v9, s67, v122
    v_fmac_f32 v40, v77, v8
    v_fmac_f32 v41, v77, v9
    v_lshlrev_b32 v10, 16, v123
    v_and_b32 v11, s67, v123
    v_fmac_f32 v42, v77, v10
    v_fmac_f32 v43, v77, v11
    s_waitcnt vmcnt(7)
    s_cmp_ge_u32 s101, 3
    s_cbranch_scc1 L_go343
    s_waitcnt vmcnt(6)
    s_cmp_ge_u32 s101, 2
    s_cbranch_scc1 L_go343
    s_waitcnt vmcnt(5)
    s_cmp_ge_u32 s101, 1
    s_cbranch_scc1 L_go343
    s_waitcnt vmcnt(4)
L_go343:
    s_add_u32 s66, s79, 20
    s_and_b32 s66, s66, 31
    s_mul_i32 s66, s66, 98304
    s_add_u32 s66, s66, s75
    buffer_load_dwordx4 v[156:159], v2, s[36:39], s66 offen offset:0 nt
    v_lshlrev_b32 v4, 16, v124
    v_and_b32 v5, s67, v124
    v_fmac_f32 v44, v77, v4
    v_fmac_f32 v45, v77, v5
    v_lshlrev_b32 v6, 16, v125
    v_and_b32 v7, s67, v125
    v_fmac_f32 v46, v77, v6
    v_fmac_f32 v47, v77, v7
    v_lshlrev_b32 v8, 16, v126
    v_and_b32 v9, s67, v126
    v_fmac_f32 v48, v77, v8
    v_fmac_f32 v49, v77, v9
    v_lshlrev_b32 v10, 16, v127
    v_and_b32 v11, s67, v127
    v_fmac_f32 v50, v77, v10
    v_fmac_f32 v51, v77, v11
    s_mov_b32 s22, s20
    s_memrealtime s[20:21]
    s_waitcnt vmcnt(7)
    s_cmp_ge_u32 s101, 3
    s_cbranch_scc1 L_go344
    s_waitcnt vmcnt(6)
    s_cmp_ge_u32 s101, 2
    s_cbranch_scc1 L_go344
    s_waitcnt vmcnt(5)
    s_cmp_ge_u32 s101, 1
    s_cbranch_scc1 L_go344
    s_waitcnt vmcnt(4)
L_go344:
    buffer_load_dwordx4 v[160:163], v2, s[36:39], s66 offen offset:128 nt
    v_lshlrev_b32 v4, 16, v128
    v_and_b32 v5, s67, v128
    v_fmac_f32 v52, v77, v4
    v_fmac_f32 v53, v77, v5
    v_lshlrev_b32 v6, 16, v129
    v_and_b32 v7, s67, v129
    v_fmac_f32 v54, v77, v6
    v_fmac_f32 v55, v77, v7
    v_lshlrev_b32 v8, 16, v130
    v_and_b32 v9, s67, v130
    v_fmac_f32 v56, v77, v8
    v_fmac_f32 v57, v77, v9
    v_lshlrev_b32 v10, 16, v131
    v_and_b32 v11, s67, v131
    v_fmac_f32 v58, v77, v10
    v_fmac_f32 v59, v77, v11
    s_waitcnt lgkmcnt(0)
    v_mov_b32 v254, s20
    s_mov_b32 s70, 984960
    buffer_store_dword v254, v253, s[56:59], s70 offen sc1
    s_cmp_eq_u32 s76, 0
    s_cbranch_scc1 L_fb15a
    s_load_dwordx16 s[4:19], s[24:25], 984832
L_fb15a:
    ds_read_b32 v255, v3 offset:8
    s_waitcnt vmcnt(7)
    s_cmp_ge_u32 s101, 3
    s_cbranch_scc1 L_go345
    s_waitcnt vmcnt(6)
    s_cmp_ge_u32 s101, 2
    s_cbranch_scc1 L_go345
    s_waitcnt vmcnt(5)
    s_cmp_ge_u32 s101, 1
    s_cbranch_scc1 L_go345
    s_waitcnt vmcnt(4)
L_go345:
    buffer_load_dwordx4 v[164:167], v2, s[36:39], s66 offen offset:256 nt
    v_lshlrev_b32 v4, 16, v132
    v_and_b32 v5, s67, v132
    v_fmac_f32 v36, v78, v4
    v_fmac_f32 v37, v78, v5
    v_lshlrev_b32 v6, 16, v133
    v_and_b32 v7, s67, v133
    v_fmac_f32 v38, v78, v6
    v_fmac_f32 v39, v78, v7
    v_lshlrev_b32 v8, 16, v134
    v_and_b32 v9, s67, v134
    v_fmac_f32 v40, v78, v8
    v_fmac_f32 v41, v78, v9
    v_lshlrev_b32 v10, 16, v135
    v_and_b32 v11, s67, v135
    v_fmac_f32 v42, v78, v10
    v_fmac_f32 v43, v78, v11
    s_waitcnt vmcnt(7)
    s_cmp_ge_u32 s101, 3
    s_cbranch_scc1 L_go346
    s_waitcnt vmcnt(6)
    s_cmp_ge_u32 s101, 2
    s_cbranch_scc1 L_go346
    s_waitcnt vmcnt(5)
    s_cmp_ge_u32 s101, 1
    s_cbranch_scc1 L_go346
    s_waitcnt vmcnt(4)
L_go346:
    s_add_u32 s66, s79, 21
    s_and_b32 s66, s66, 31
    s_mul_i32 s66, s66, 98304
    s_add_u32 s66, s66, s75
    buffer_load_dwordx4 v[168:171], v2, s[36:39], s66 offen offset:0 nt
    v_lshlrev_b32 v4, 16, v136
    v_and_b32 v5, s67, v136
    v_fmac_f32 v44, v78, v4
    v_fmac_f32 v45, v78, v5
    v_lshlrev_b32 v6, 16, v137
    v_and_b32 v7, s67, v137
    v_fmac_f32 v46, v78, v6
    v_fmac_f32 v47, v78, v7
    v_lshlrev_b32 v8, 16, v138
    v_and_b32 v9, s67, v138
    v_fmac_f32 v48, v78, v8
    v_fmac_f32 v49, v78, v9
    v_lshlrev_b32 v10, 16, v139
    v_and_b32 v11, s67, v139
    v_fmac_f32 v50, v78, v10
    v_fmac_f32 v51, v78, v11
    s_waitcnt vmcnt(7)
    s_cmp_ge_u32 s101, 3
    s_cbranch_scc1 L_go347
    s_waitcnt vmcnt(6)
    s_cmp_ge_u32 s101, 2
    s_cbranch_scc1 L_go347
    s_waitcnt vmcnt(5)
    s_cmp_ge_u32 s101, 1
    s_cbranch_scc1 L_go347
    s_waitcnt vmcnt(4)
L_go347:
    buffer_load_dwordx4 v[172:175], v2, s[36:39], s66 offen offset:128 nt
    v_lshlrev_b32 v4, 16, v140
    v_and_b32 v5, s67, v140
    v_fmac_f32 v52, v78, v4
    v_fmac_f32 v53, v78, v5
    v_lshlrev_b32 v6, 16, v141
    v_and_b32 v7, s67, v141
    v_fmac_f32 v54, v78, v6
    v_fmac_f32 v55, v78, v7
    v_lshlrev_b32 v8, 16, v142
    v_and_b32 v9, s67, v142
    v_fmac_f32 v56, v78, v8
    v_fmac_f32 v57, v78, v9
    v_lshlrev_b32 v10, 16, v143
    v_and_b32 v11, s67, v143
    v_fmac_f32 v58, v78, v10
    v_fmac_f32 v59, v78, v11
    s_waitcnt vmcnt(7)
    s_cmp_ge_u32 s101, 3
    s_cbranch_scc1 L_go348
    s_waitcnt vmcnt(6)
    s_cmp_ge_u32 s101, 2
    s_cbranch_scc1 L_go348
    s_waitcnt vmcnt(5)
    s_cmp_ge_u32 s101, 1
    s_cbranch_scc1 L_go348
    s_waitcnt vmcnt(4)
L_go348:
    buffer_load_dwordx4 v[176:179], v2, s[36:39], s66 offen offset:256 nt
    v_lshlrev_b32 v4, 16, v144
    v_and_b32 v5, s67, v144
    v_fmac_f32 v36, v79, v4
    v_fmac_f32 v37, v79, v5
    v_lshlrev_b32 v6, 16, v145
    v_and_b32 v7, s67, v145
    v_fmac_f32 v38, v79, v6
    v_fmac_f32 v39, v79, v7
    v_lshlrev_b32 v8, 16, v146
    v_and_b32 v9, s67, v146
    v_fmac_f32 v40, v79, v8
    v_fmac_f32 v41, v79, v9
    v_lshlrev_b32 v10, 16, v147
    v_and_b32 v11, s67, v147
    v_fmac_f32 v42, v79, v10
    v_fmac_f32 v43, v79, v11
    s_waitcnt vmcnt(7)
    s_cmp_ge_u32 s101, 3
    s_cbranch_scc1 L_go349
    s_waitcnt vmcnt(6)
    s_cmp_ge_u32 s101, 2
    s_cbranch_scc1 L_go349
    s_waitcnt vmcnt(5)
    s_cmp_ge_u32 s101, 1
    s_cbranch_scc1 L_go349
    s_waitcnt vmcnt(4)
L_go349:
    s_add_u32 s66, s79, 22
    s_and_b32 s66, s66, 31
    s_mul_i32 s66, s66, 98304
    s_add_u32 s66, s66, s75
    buffer_load_dwordx4 v[180:183], v2, s[36:39], s66 offen offset:0 nt
    v_lshlrev_b32 v4, 16, v148
    v_and_b32 v5, s67, v148
    v_fmac_f32 v44, v79, v4
    v_fmac_f32 v45, v79, v5
    v_lshlrev_b32 v6, 16, v149
    v_and_b32 v7, s67, v149
    v_fmac_f32 v46, v79, v6
    v_fmac_f32 v47, v79, v7
    v_lshlrev_b32 v8, 16, v150
    v_and_b32 v9, s67, v150
    v_fmac_f32 v48, v79, v8
    v_fmac_f32 v49, v79, v9
    v_lshlrev_b32 v10, 16, v151
    v_and_b32 v11, s67, v151
    v_fmac_f32 v50, v79, v10
    v_fmac_f32 v51, v79, v11
    s_waitcnt vmcnt(7)
    s_cmp_ge_u32 s101, 3
    s_cbranch_scc1 L_go350
    s_waitcnt vmcnt(6)
    s_cmp_ge_u32 s101, 2
    s_cbranch_scc1 L_go350
    s_waitcnt vmcnt(5)
    s_cmp_ge_u32 s101, 1
    s_cbranch_scc1 L_go350
    s_waitcnt vmcnt(4)
L_go350:
    buffer_load_dwordx4 v[184:187], v2, s[36:39], s66 offen offset:128 nt
    v_lshlrev_b32 v4, 16, v152
    v_and_b32 v5, s67, v152
    v_fmac_f32 v52, v79, v4
    v_fmac_f32 v53, v79, v5
    v_lshlrev_b32 v6, 16, v153
    v_and_b32 v7, s67, v153
    v_fmac_f32 v54, v79, v6
    v_fmac_f32 v55, v79, v7
    v_lshlrev_b32 v8, 16, v154
    v_and_b32 v9, s67, v154
    v_fmac_f32 v56, v79, v8
    v_fmac_f32 v57, v79, v9
    v_lshlrev_b32 v10, 16, v155
    v_and_b32 v11, s67, v155
    v_fmac_f32 v58, v79, v10
    v_fmac_f32 v59, v79, v11
    s_waitcnt vmcnt(7)
    s_cmp_ge_u32 s101, 3
    s_cbranch_scc1 L_go351
    s_waitcnt vmcnt(6)
    s_cmp_ge_u32 s101, 2
    s_cbranch_scc1 L_go351
    s_waitcnt vmcnt(5)
    s_cmp_ge_u32 s101, 1
    s_cbranch_scc1 L_go351
    s_waitcnt vmcnt(4)
L_go351:
    buffer_load_dwordx4 v[188:191], v2, s[36:39], s66 offen offset:256 nt
    v_lshlrev_b32 v4, 16, v156
    v_and_b32 v5, s67, v156
    v_fmac_f32 v36, v80, v4
    v_fmac_f32 v37, v80, v5
    v_lshlrev_b32 v6, 16, v157
    v_and_b32 v7, s67, v157
    v_fmac_f32 v38, v80, v6
    v_fmac_f32 v39, v80, v7
    v_lshlrev_b32 v8, 16, v158
    v_and_b32 v9, s67, v158
    v_fmac_f32 v40, v80, v8
    v_fmac_f32 v41, v80, v9
    v_lshlrev_b32 v10, 16, v159
    v_and_b32 v11, s67, v159
    v_fmac_f32 v42, v80, v10
    v_fmac_f32 v43, v80, v11
    s_waitcnt vmcnt(7)
    s_cmp_ge_u32 s101, 3
    s_cbranch_scc1 L_go352
    s_waitcnt vmcnt(6)
    s_cmp_ge_u32 s101, 2
    s_cbranch_scc1 L_go352
    s_waitcnt vmcnt(5)
    s_cmp_ge_u32 s101, 1
    s_cbranch_scc1 L_go352
    s_waitcnt vmcnt(4)
L_go352:
    s_add_u32 s66, s79, 23
    s_and_b32 s66, s66, 31
    s_mul_i32 s66, s66, 98304
    s_add_u32 s66, s66, s75
    buffer_load_dwordx4 v[192:195], v2, s[36:39], s66 offen offset:0 nt
    v_lshlrev_b32 v4, 16, v160
    v_and_b32 v5, s67, v160
    v_fmac_f32 v44, v80, v4
    v_fmac_f32 v45, v80, v5
    v_lshlrev_b32 v6, 16, v161
    v_and_b32 v7, s67, v161
    v_fmac_f32 v46, v80, v6
    v_fmac_f32 v47, v80, v7
    v_lshlrev_b32 v8, 16, v162
    v_and_b32 v9, s67, v162
    v_fmac_f32 v48, v80, v8
    v_fmac_f32 v49, v80, v9
    v_lshlrev_b32 v10, 16, v163
    v_and_b32 v11, s67, v163
    v_fmac_f32 v50, v80, v10
    v_fmac_f32 v51, v80, v11
    s_waitcnt lgkmcnt(0)
    s_cmp_eq_u32 s76, 0
    s_cbranch_scc1 L_fb15b
    s_mov_b32 s23, 0
    s_min_u32 s4, s4, s20
    s_sub_u32 s4, s22, s4
    s_add_u32 s23, s23, s4
    s_min_u32 s5, s5, s20
    s_sub_u32 s5, s22, s5
    s_add_u32 s23, s23, s5
    s_min_u32 s6, s6, s20
    s_sub_u32 s6, s22, s6
    s_add_u32 s23, s23, s6
    s_min_u32 s7, s7, s20
    s_sub_u32 s7, s22, s7
    s_add_u32 s23, s23, s7
    s_min_u32 s8, s8, s20
    s_sub_u32 s8, s22, s8
    s_add_u32 s23, s23, s8
    s_min_u32 s9, s9, s20
    s_sub_u32 s9, s22, s9
    s_add_u32 s23, s23, s9
    s_min_u32 s10, s10, s20
    s_sub_u32 s10, s22, s10
    s_add_u32 s23, s23, s10
    s_min_u32 s11, s11, s20
    s_sub_u32 s11, s22, s11
    s_add_u32 s23, s23, s11
    s_min_u32 s12, s12, s20
    s_sub_u32 s12, s22, s12
    s_add_u32 s23, s23, s12
    s_min_u32 s13, s13, s20
    s_sub_u32 s13, s22, s13
    s_add_u32 s23, s23, s13
    s_min_u32 s14, s14, s20
    s_sub_u32 s14, s22, s14
    s_add_u32 s23, s23, s14
    s_min_u32 s15, s15, s20
    s_sub_u32 s15, s22, s15
    s_add_u32 s23, s23, s15
    s_min_u32 s16, s16, s20
    s_sub_u32 s16, s22, s16
    s_add_u32 s23, s23, s16
    s_min_u32 s17, s17, s20
    s_sub_u32 s17, s22, s17
    s_add_u32 s23, s23, s17
    s_min_u32 s18, s18, s20
    s_sub_u32 s18, s22, s18
    s_add_u32 s23, s23, s18
    s_min_u32 s19, s19, s20
    s_sub_u32 s19, s22, s19
    s_add_u32 s23, s23, s19
    s_ashr_i32 s23, s23, 4
    s_mov_b32 s101, 0
    s_cmp_ge_i32 s23, -60
    s_cselect_b32 s101, 1, s101
    s_cmp_ge_i32 s23, 20
    s_cselect_b32 s101, 2, s101
    s_cmp_ge_i32 s23, 100
    s_cselect_b32 s101, 3, s101
L_fb15b:
    s_nop 2
    v_readfirstlane_b32 s76, v255
    s_waitcnt vmcnt(7)
    s_cmp_ge_u32 s101, 3
    s_cbranch_scc1 L_go353
    s_waitcnt vmcnt(6)
    s_cmp_ge_u32 s101, 2
    s_cbranch_scc1 L_go353
    s_waitcnt vmcnt(5)
    s_cmp_ge_u32 s101, 1
    s_cbranch_scc1 L_go353
    s_waitcnt vmcnt(4)
L_go353:
    buffer_load_dwordx4 v[196:199], v2, s[36:39], s66 offen offset:128 nt
    v_lshlrev_b32 v4, 16, v164
    v_and_b32 v5, s67, v164
    v_fmac_f32 v52, v80, v4
    v_fmac_f32 v53, v80, v5
    v_lshlrev_b32 v6, 16, v165
    v_and_b32 v7, s67, v165
    v_fmac_f32 v54, v80, v6
    v_fmac_f32 v55, v80, v7
    v_lshlrev_b32 v8, 16, v166
    v_and_b32 v9, s67, v166
    v_fmac_f32 v56, v80, v8
    v_fmac_f32 v57, v80, v9
    v_lshlrev_b32 v10, 16, v167
    v_and_b32 v11, s67, v167
    v_fmac_f32 v58, v80, v10
    v_fmac_f32 v59, v80, v11
    s_waitcnt vmcnt(7)
    s_cmp_ge_u32 s101, 3
    s_cbranch_scc1 L_go354
    s_waitcnt vmcnt(6)
    s_cmp_ge_u32 s101, 2
    s_cbranch_scc1 L_go354
    s_waitcnt vmcnt(5)
    s_cmp_ge_u32 s101, 1
    s_cbranch_scc1 L_go354
    s_waitcnt vmcnt(4)
L_go354:
    buffer_load_dwordx4 v[200:203], v2, s[36:39], s66 offen offset:256 nt
    v_lshlrev_b32 v4, 16, v168
    v_and_b32 v5, s67, v168
    v_fmac_f32 v36, v81, v4
    v_fmac_f32 v37, v81, v5
    v_lshlrev_b32 v6, 16, v169
    v_and_b32 v7, s67, v169
    v_fmac_f32 v38, v81, v6
    v_fmac_f32 v39, v81, v7
    v_lshlrev_b32 v8, 16, v170
    v_and_b32 v9, s67, v170
    v_fmac_f32 v40, v81, v8
    v_fmac_f32 v41, v81, v9
    v_lshlrev_b32 v10, 16, v171
    v_and_b32 v11, s67, v171
    v_fmac_f32 v42, v81, v10
    v_fmac_f32 v43, v81, v11
    s_waitcnt vmcnt(7)
    s_cmp_ge_u32 s101, 3
    s_cbranch_scc1 L_go355
    s_waitcnt vmcnt(6)
    s_cmp_ge_u32 s101, 2
    s_cbranch_scc1 L_go355
    s_waitcnt vmcnt(5)
    s_cmp_ge_u32 s101, 1
    s_cbranch_scc1 L_go355
    s_waitcnt vmcnt(4)
L_go355:
    s_add_u32 s66, s79, 24
    s_and_b32 s66, s66, 31
    s_mul_i32 s66, s66, 98304
    s_add_u32 s66, s66, s75
    buffer_load_dwordx4 v[204:207], v2, s[36:39], s66 offen offset:0 nt
    v_lshlrev_b32 v4, 16, v172
    v_and_b32 v5, s67, v172
    v_fmac_f32 v44, v81, v4
    v_fmac_f32 v45, v81, v5
    v_lshlrev_b32 v6, 16, v173
    v_and_b32 v7, s67, v173
    v_fmac_f32 v46, v81, v6
    v_fmac_f32 v47, v81, v7
    v_lshlrev_b32 v8, 16, v174
    v_and_b32 v9, s67, v174
    v_fmac_f32 v48, v81, v8
    v_fmac_f32 v49, v81, v9
    v_lshlrev_b32 v10, 16, v175
    v_and_b32 v11, s67, v175
    v_fmac_f32 v50, v81, v10
    v_fmac_f32 v51, v81, v11
    s_waitcnt vmcnt(7)
    s_cmp_ge_u32 s101, 3
    s_cbranch_scc1 L_go356
    s_waitcnt vmcnt(6)
    s_cmp_ge_u32 s101, 2
    s_cbranch_scc1 L_go356
    s_waitcnt vmcnt(5)
    s_cmp_ge_u32 s101, 1
    s_cbranch_scc1 L_go356
    s_waitcnt vmcnt(4)
L_go356:
    buffer_load_dwordx4 v[208:211], v2, s[36:39], s66 offen offset:128 nt
    v_lshlrev_b32 v4, 16, v176
    v_and_b32 v5, s67, v176
    v_fmac_f32 v52, v81, v4
    v_fmac_f32 v53, v81, v5
    v_lshlrev_b32 v6, 16, v177
    v_and_b32 v7, s67, v177
    v_fmac_f32 v54, v81, v6
    v_fmac_f32 v55, v81, v7
    v_lshlrev_b32 v8, 16, v178
    v_and_b32 v9, s67, v178
    v_fmac_f32 v56, v81, v8
    v_fmac_f32 v57, v81, v9
    v_lshlrev_b32 v10, 16, v179
    v_and_b32 v11, s67, v179
    v_fmac_f32 v58, v81, v10
    v_fmac_f32 v59, v81, v11
    s_waitcnt vmcnt(7)
    s_cmp_ge_u32 s101, 3
    s_cbranch_scc1 L_go357
    s_waitcnt vmcnt(6)
    s_cmp_ge_u32 s101, 2
    s_cbranch_scc1 L_go357
    s_waitcnt vmcnt(5)
    s_cmp_ge_u32 s101, 1
    s_cbranch_scc1 L_go357
    s_waitcnt vmcnt(4)
L_go357:
    buffer_load_dwordx4 v[212:215], v2, s[36:39], s66 offen offset:256 nt
    v_lshlrev_b32 v4, 16, v180
    v_and_b32 v5, s67, v180
    v_fmac_f32 v36, v82, v4
    v_fmac_f32 v37, v82, v5
    v_lshlrev_b32 v6, 16, v181
    v_and_b32 v7, s67, v181
    v_fmac_f32 v38, v82, v6
    v_fmac_f32 v39, v82, v7
    v_lshlrev_b32 v8, 16, v182
    v_and_b32 v9, s67, v182
    v_fmac_f32 v40, v82, v8
    v_fmac_f32 v41, v82, v9
    v_lshlrev_b32 v10, 16, v183
    v_and_b32 v11, s67, v183
    v_fmac_f32 v42, v82, v10
    v_fmac_f32 v43, v82, v11
    s_waitcnt vmcnt(7)
    s_cmp_ge_u32 s101, 3
    s_cbranch_scc1 L_go358
    s_waitcnt vmcnt(6)
    s_cmp_ge_u32 s101, 2
    s_cbranch_scc1 L_go358
    s_waitcnt vmcnt(5)
    s_cmp_ge_u32 s101, 1
    s_cbranch_scc1 L_go358
    s_waitcnt vmcnt(4)
L_go358:
    s_add_u32 s66, s79, 25
    s_and_b32 s66, s66, 31
    s_mul_i32 s66, s66, 98304
    s_add_u32 s66, s66, s75
    buffer_load_dwordx4 v[216:219], v2, s[36:39], s66 offen offset:0 nt
    v_lshlrev_b32 v4, 16, v184
    v_and_b32 v5, s67, v184
    v_fmac_f32 v44, v82, v4
    v_fmac_f32 v45, v82, v5
    v_lshlrev_b32 v6, 16, v185
    v_and_b32 v7, s67, v185
    v_fmac_f32 v46, v82, v6
    v_fmac_f32 v47, v82, v7
    v_lshlrev_b32 v8, 16, v186
    v_and_b32 v9, s67, v186
    v_fmac_f32 v48, v82, v8
    v_fmac_f32 v49, v82, v9
    v_lshlrev_b32 v10, 16, v187
    v_and_b32 v11, s67, v187
    v_fmac_f32 v50, v82, v10
    v_fmac_f32 v51, v82, v11
    s_waitcnt vmcnt(7)
    s_cmp_ge_u32 s101, 3
    s_cbranch_scc1 L_go359
    s_waitcnt vmcnt(6)
    s_cmp_ge_u32 s101, 2
    s_cbranch_scc1 L_go359
    s_waitcnt vmcnt(5)
    s_cmp_ge_u32 s101, 1
    s_cbranch_scc1 L_go359
    s_waitcnt vmcnt(4)
L_go359:
    buffer_load_dwordx4 v[220:223], v2, s[36:39], s66 offen offset:128 nt
    v_lshlrev_b32 v4, 16, v188
    v_and_b32 v5, s67, v188
    v_fmac_f32 v52, v82, v4
    v_fmac_f32 v53, v82, v5
    v_lshlrev_b32 v6, 16, v189
    v_and_b32 v7, s67, v189
    v_fmac_f32 v54, v82, v6
    v_fmac_f32 v55, v82, v7
    v_lshlrev_b32 v8, 16, v190
    v_and_b32 v9, s67, v190
    v_fmac_f32 v56, v82, v8
    v_fmac_f32 v57, v82, v9
    v_lshlrev_b32 v10, 16, v191
    v_and_b32 v11, s67, v191
    v_fmac_f32 v58, v82, v10
    v_fmac_f32 v59, v82, v11
    s_waitcnt vmcnt(7)
    s_cmp_ge_u32 s101, 3
    s_cbranch_scc1 L_go360
    s_waitcnt vmcnt(6)
    s_cmp_ge_u32 s101, 2
    s_cbranch_scc1 L_go360
    s_waitcnt vmcnt(5)
    s_cmp_ge_u32 s101, 1
    s_cbranch_scc1 L_go360
    s_waitcnt vmcnt(4)
L_go360:
    buffer_load_dwordx4 v[224:227], v2, s[36:39], s66 offen offset:256 nt
    v_lshlrev_b32 v4, 16, v192
    v_and_b32 v5, s67, v192
    v_fmac_f32 v36, v83, v4
    v_fmac_f32 v37, v83, v5
    v_lshlrev_b32 v6, 16, v193
    v_and_b32 v7, s67, v193
    v_fmac_f32 v38, v83, v6
    v_fmac_f32 v39, v83, v7
    v_lshlrev_b32 v8, 16, v194
    v_and_b32 v9, s67, v194
    v_fmac_f32 v40, v83, v8
    v_fmac_f32 v41, v83, v9
    v_lshlrev_b32 v10, 16, v195
    v_and_b32 v11, s67, v195
    v_fmac_f32 v42, v83, v10
    v_fmac_f32 v43, v83, v11
    s_waitcnt vmcnt(7)
    s_cmp_ge_u32 s101, 3
    s_cbranch_scc1 L_go361
    s_waitcnt vmcnt(6)
    s_cmp_ge_u32 s101, 2
    s_cbranch_scc1 L_go361
    s_waitcnt vmcnt(5)
    s_cmp_ge_u32 s101, 1
    s_cbranch_scc1 L_go361
    s_waitcnt vmcnt(4)
L_go361:
    s_add_u32 s66, s79, 26
    s_and_b32 s66, s66, 31
    s_mul_i32 s66, s66, 98304
    s_add_u32 s66, s66, s75
    buffer_load_dwordx4 v[228:231], v2, s[36:39], s66 offen offset:0 nt
    v_lshlrev_b32 v4, 16, v196
    v_and_b32 v5, s67, v196
    v_fmac_f32 v44, v83, v4
    v_fmac_f32 v45, v83, v5
    v_lshlrev_b32 v6, 16, v197
    v_and_b32 v7, s67, v197
    v_fmac_f32 v46, v83, v6
    v_fmac_f32 v47, v83, v7
    v_lshlrev_b32 v8, 16, v198
    v_and_b32 v9, s67, v198
    v_fmac_f32 v48, v83, v8
    v_fmac_f32 v49, v83, v9
    v_lshlrev_b32 v10, 16, v199
    v_and_b32 v11, s67, v199
    v_fmac_f32 v50, v83, v10
    v_fmac_f32 v51, v83, v11
    s_waitcnt vmcnt(7)
    s_cmp_ge_u32 s101, 3
    s_cbranch_scc1 L_go362
    s_waitcnt vmcnt(6)
    s_cmp_ge_u32 s101, 2
    s_cbranch_scc1 L_go362
    s_waitcnt vmcnt(5)
    s_cmp_ge_u32 s101, 1
    s_cbranch_scc1 L_go362
    s_waitcnt vmcnt(4)
L_go362:
    buffer_load_dwordx4 v[232:235], v2, s[36:39], s66 offen offset:128 nt
    v_lshlrev_b32 v4, 16, v200
    v_and_b32 v5, s67, v200
    v_fmac_f32 v52, v83, v4
    v_fmac_f32 v53, v83, v5
    v_lshlrev_b32 v6, 16, v201
    v_and_b32 v7, s67, v201
    v_fmac_f32 v54, v83, v6
    v_fmac_f32 v55, v83, v7
    v_lshlrev_b32 v8, 16, v202
    v_and_b32 v9, s67, v202
    v_fmac_f32 v56, v83, v8
    v_fmac_f32 v57, v83, v9
    v_lshlrev_b32 v10, 16, v203
    v_and_b32 v11, s67, v203
    v_fmac_f32 v58, v83, v10
    v_fmac_f32 v59, v83, v11
    s_waitcnt vmcnt(7)
    s_cmp_ge_u32 s101, 3
    s_cbranch_scc1 L_go363
    s_waitcnt vmcnt(6)
    s_cmp_ge_u32 s101, 2
    s_cbranch_scc1 L_go363
    s_waitcnt vmcnt(5)
    s_cmp_ge_u32 s101, 1
    s_cbranch_scc1 L_go363
    s_waitcnt vmcnt(4)
L_go363:
    buffer_load_dwordx4 v[236:239], v2, s[36:39], s66 offen offset:256 nt
    v_lshlrev_b32 v4, 16, v204
    v_and_b32 v5, s67, v204
    v_fmac_f32 v36, v84, v4
    v_fmac_f32 v37, v84, v5
    v_lshlrev_b32 v6, 16, v205
    v_and_b32 v7, s67, v205
    v_fmac_f32 v38, v84, v6
    v_fmac_f32 v39, v84, v7
    v_lshlrev_b32 v8, 16, v206
    v_and_b32 v9, s67, v206
    v_fmac_f32 v40, v84, v8
    v_fmac_f32 v41, v84, v9
    v_lshlrev_b32 v10, 16, v207
    v_and_b32 v11, s67, v207
    v_fmac_f32 v42, v84, v10
    v_fmac_f32 v43, v84, v11
    s_waitcnt vmcnt(7)
    s_cmp_ge_u32 s101, 3
    s_cbranch_scc1 L_go364
    s_waitcnt vmcnt(6)
    s_cmp_ge_u32 s101, 2
    s_cbranch_scc1 L_go364
    s_waitcnt vmcnt(5)
    s_cmp_ge_u32 s101, 1
    s_cbranch_scc1 L_go364
    s_waitcnt vmcnt(4)
L_go364:
    s_add_u32 s66, s79, 27
    s_and_b32 s66, s66, 31
    s_mul_i32 s66, s66, 98304
    s_add_u32 s66, s66, s75
    buffer_load_dwordx4 v[240:243], v2, s[36:39], s66 offen offset:0 nt
    v_lshlrev_b32 v4, 16, v208
    v_and_b32 v5, s67, v208
    v_fmac_f32 v44, v84, v4
    v_fmac_f32 v45, v84, v5
    v_lshlrev_b32 v6, 16, v209
    v_and_b32 v7, s67, v209
    v_fmac_f32 v46, v84, v6
    v_fmac_f32 v47, v84, v7
    v_lshlrev_b32 v8, 16, v210
    v_and_b32 v9, s67, v210
    v_fmac_f32 v48, v84, v8
    v_fmac_f32 v49, v84, v9
    v_lshlrev_b32 v10, 16, v211
    v_and_b32 v11, s67, v211
    v_fmac_f32 v50, v84, v10
    v_fmac_f32 v51, v84, v11
    s_waitcnt vmcnt(7)
    s_cmp_ge_u32 s101, 3
    s_cbranch_scc1 L_go365
    s_waitcnt vmcnt(6)
    s_cmp_ge_u32 s101, 2
    s_cbranch_scc1 L_go365
    s_waitcnt vmcnt(5)
    s_cmp_ge_u32 s101, 1
    s_cbranch_scc1 L_go365
    s_waitcnt vmcnt(4)
L_go365:
    buffer_load_dwordx4 v[244:247], v2, s[36:39], s66 offen offset:128 nt
    v_lshlrev_b32 v4, 16, v212
    v_and_b32 v5, s67, v212
    v_fmac_f32 v52, v84, v4
    v_fmac_f32 v53, v84, v5
    v_lshlrev_b32 v6, 16, v213
    v_and_b32 v7, s67, v213
    v_fmac_f32 v54, v84, v6
    v_fmac_f32 v55, v84, v7
    v_lshlrev_b32 v8, 16, v214
    v_and_b32 v9, s67, v214
    v_fmac_f32 v56, v84, v8
    v_fmac_f32 v57, v84, v9
    v_lshlrev_b32 v10, 16, v215
    v_and_b32 v11, s67, v215
    v_fmac_f32 v58, v84, v10
    v_fmac_f32 v59, v84, v11
    s_waitcnt vmcnt(7)
    s_cmp_ge_u32 s101, 3
    s_cbranch_scc1 L_go366
    s_waitcnt vmcnt(6)
    s_cmp_ge_u32 s101, 2
    s_cbranch_scc1 L_go366
    s_waitcnt vmcnt(5)
    s_cmp_ge_u32 s101, 1
    s_cbranch_scc1 L_go366
    s_waitcnt vmcnt(4)
L_go366:
    buffer_load_dwordx4 v[248:251], v2, s[36:39], s66 offen offset:256 nt
    v_lshlrev_b32 v4, 16, v216
    v_and_b32 v5, s67, v216
    v_fmac_f32 v36, v85, v4
    v_fmac_f32 v37, v85, v5
    v_lshlrev_b32 v6, 16, v217
    v_and_b32 v7, s67, v217
    v_fmac_f32 v38, v85, v6
    v_fmac_f32 v39, v85, v7
    v_lshlrev_b32 v8, 16, v218
    v_and_b32 v9, s67, v218
    v_fmac_f32 v40, v85, v8
    v_fmac_f32 v41, v85, v9
    v_lshlrev_b32 v10, 16, v219
    v_and_b32 v11, s67, v219
    v_fmac_f32 v42, v85, v10
    v_fmac_f32 v43, v85, v11
    s_waitcnt vmcnt(7)
    s_cmp_ge_u32 s101, 3
    s_cbranch_scc1 L_go367
    s_waitcnt vmcnt(6)
    s_cmp_ge_u32 s101, 2
    s_cbranch_scc1 L_go367
    s_waitcnt vmcnt(5)
    s_cmp_ge_u32 s101, 1
    s_cbranch_scc1 L_go367
    s_waitcnt vmcnt(4)
L_go367:
    s_add_u32 s66, s79, 28
    s_and_b32 s66, s66, 31
    s_mul_i32 s66, s66, 98304
    s_add_u32 s66, s66, s75
    buffer_load_dwordx4 v[92:95], v2, s[36:39], s66 offen offset:0 nt
    v_lshlrev_b32 v4, 16, v220
    v_and_b32 v5, s67, v220
    v_fmac_f32 v44, v85, v4
    v_fmac_f32 v45, v85, v5
    v_lshlrev_b32 v6, 16, v221
    v_and_b32 v7, s67, v221
    v_fmac_f32 v46, v85, v6
    v_fmac_f32 v47, v85, v7
    v_lshlrev_b32 v8, 16, v222
    v_and_b32 v9, s67, v222
    v_fmac_f32 v48, v85, v8
    v_fmac_f32 v49, v85, v9
    v_lshlrev_b32 v10, 16, v223
    v_and_b32 v11, s67, v223
    v_fmac_f32 v50, v85, v10
    v_fmac_f32 v51, v85, v11
    s_waitcnt vmcnt(7)
    s_cmp_ge_u32 s101, 3
    s_cbranch_scc1 L_go368
    s_waitcnt vmcnt(6)
    s_cmp_ge_u32 s101, 2
    s_cbranch_scc1 L_go368
    s_waitcnt vmcnt(5)
    s_cmp_ge_u32 s101, 1
    s_cbranch_scc1 L_go368
    s_waitcnt vmcnt(4)
L_go368:
    buffer_load_dwordx4 v[96:99], v2, s[36:39], s66 offen offset:128 nt
    v_lshlrev_b32 v4, 16, v224
    v_and_b32 v5, s67, v224
    v_fmac_f32 v52, v85, v4
    v_fmac_f32 v53, v85, v5
    v_lshlrev_b32 v6, 16, v225
    v_and_b32 v7, s67, v225
    v_fmac_f32 v54, v85, v6
    v_fmac_f32 v55, v85, v7
    v_lshlrev_b32 v8, 16, v226
    v_and_b32 v9, s67, v226
    v_fmac_f32 v56, v85, v8
    v_fmac_f32 v57, v85, v9
    v_lshlrev_b32 v10, 16, v227
    v_and_b32 v11, s67, v227
    v_fmac_f32 v58, v85, v10
    v_fmac_f32 v59, v85, v11
    s_waitcnt vmcnt(7)
    s_cmp_ge_u32 s101, 3
    s_cbranch_scc1 L_go369
    s_waitcnt vmcnt(6)
    s_cmp_ge_u32 s101, 2
    s_cbranch_scc1 L_go369
    s_waitcnt vmcnt(5)
    s_cmp_ge_u32 s101, 1
    s_cbranch_scc1 L_go369
    s_waitcnt vmcnt(4)
L_go369:
    buffer_load_dwordx4 v[100:103], v2, s[36:39], s66 offen offset:256 nt
    v_lshlrev_b32 v4, 16, v228
    v_and_b32 v5, s67, v228
    v_fmac_f32 v36, v86, v4
    v_fmac_f32 v37, v86, v5
    v_lshlrev_b32 v6, 16, v229
    v_and_b32 v7, s67, v229
    v_fmac_f32 v38, v86, v6
    v_fmac_f32 v39, v86, v7
    v_lshlrev_b32 v8, 16, v230
    v_and_b32 v9, s67, v230
    v_fmac_f32 v40, v86, v8
    v_fmac_f32 v41, v86, v9
    v_lshlrev_b32 v10, 16, v231
    v_and_b32 v11, s67, v231
    v_fmac_f32 v42, v86, v10
    v_fmac_f32 v43, v86, v11
    s_waitcnt vmcnt(7)
    s_cmp_ge_u32 s101, 3
    s_cbranch_scc1 L_go370
    s_waitcnt vmcnt(6)
    s_cmp_ge_u32 s101, 2
    s_cbranch_scc1 L_go370
    s_waitcnt vmcnt(5)
    s_cmp_ge_u32 s101, 1
    s_cbranch_scc1 L_go370
    s_waitcnt vmcnt(4)
L_go370:
    s_add_u32 s66, s79, 29
    s_and_b32 s66, s66, 31
    s_mul_i32 s66, s66, 98304
    s_add_u32 s66, s66, s75
    buffer_load_dwordx4 v[104:107], v2, s[36:39], s66 offen offset:0 nt
    v_lshlrev_b32 v4, 16, v232
    v_and_b32 v5, s67, v232
    v_fmac_f32 v44, v86, v4
    v_fmac_f32 v45, v86, v5
    v_lshlrev_b32 v6, 16, v233
    v_and_b32 v7, s67, v233
    v_fmac_f32 v46, v86, v6
    v_fmac_f32 v47, v86, v7
    v_lshlrev_b32 v8, 16, v234
    v_and_b32 v9, s67, v234
    v_fmac_f32 v48, v86, v8
    v_fmac_f32 v49, v86, v9
    v_lshlrev_b32 v10, 16, v235
    v_and_b32 v11, s67, v235
    v_fmac_f32 v50, v86, v10
    v_fmac_f32 v51, v86, v11
    s_waitcnt vmcnt(7)
    s_cmp_ge_u32 s101, 3
    s_cbranch_scc1 L_go371
    s_waitcnt vmcnt(6)
    s_cmp_ge_u32 s101, 2
    s_cbranch_scc1 L_go371
    s_waitcnt vmcnt(5)
    s_cmp_ge_u32 s101, 1
    s_cbranch_scc1 L_go371
    s_waitcnt vmcnt(4)
L_go371:
    buffer_load_dwordx4 v[108:111], v2, s[36:39], s66 offen offset:128 nt
    v_lshlrev_b32 v4, 16, v236
    v_and_b32 v5, s67, v236
    v_fmac_f32 v52, v86, v4
    v_fmac_f32 v53, v86, v5
    v_lshlrev_b32 v6, 16, v237
    v_and_b32 v7, s67, v237
    v_fmac_f32 v54, v86, v6
    v_fmac_f32 v55, v86, v7
    v_lshlrev_b32 v8, 16, v238
    v_and_b32 v9, s67, v238
    v_fmac_f32 v56, v86, v8
    v_fmac_f32 v57, v86, v9
    v_lshlrev_b32 v10, 16, v239
    v_and_b32 v11, s67, v239
    v_fmac_f32 v58, v86, v10
    v_fmac_f32 v59, v86, v11
    s_waitcnt vmcnt(7)
    s_cmp_ge_u32 s101, 3
    s_cbranch_scc1 L_go372
    s_waitcnt vmcnt(6)
    s_cmp_ge_u32 s101, 2
    s_cbranch_scc1 L_go372
    s_waitcnt vmcnt(5)
    s_cmp_ge_u32 s101, 1
    s_cbranch_scc1 L_go372
    s_waitcnt vmcnt(4)
L_go372:
    buffer_load_dwordx4 v[112:115], v2, s[36:39], s66 offen offset:256 nt
    v_lshlrev_b32 v4, 16, v240
    v_and_b32 v5, s67, v240
    v_fmac_f32 v36, v87, v4
    v_fmac_f32 v37, v87, v5
    v_lshlrev_b32 v6, 16, v241
    v_and_b32 v7, s67, v241
    v_fmac_f32 v38, v87, v6
    v_fmac_f32 v39, v87, v7
    v_lshlrev_b32 v8, 16, v242
    v_and_b32 v9, s67, v242
    v_fmac_f32 v40, v87, v8
    v_fmac_f32 v41, v87, v9
    v_lshlrev_b32 v10, 16, v243
    v_and_b32 v11, s67, v243
    v_fmac_f32 v42, v87, v10
    v_fmac_f32 v43, v87, v11
    s_waitcnt vmcnt(7)
    s_cmp_ge_u32 s101, 3
    s_cbranch_scc1 L_go373
    s_waitcnt vmcnt(6)
    s_cmp_ge_u32 s101, 2
    s_cbranch_scc1 L_go373
    s_waitcnt vmcnt(5)
    s_cmp_ge_u32 s101, 1
    s_cbranch_scc1 L_go373
    s_waitcnt vmcnt(4)
L_go373:
    s_add_u32 s66, s79, 30
    s_and_b32 s66, s66, 31
    s_mul_i32 s66, s66, 98304
    s_add_u32 s66, s66, s75
    buffer_load_dwordx4 v[116:119], v2, s[36:39], s66 offen offset:0 nt
    v_lshlrev_b32 v4, 16, v244
    v_and_b32 v5, s67, v244
    v_fmac_f32 v44, v87, v4
    v_fmac_f32 v45, v87, v5
    v_lshlrev_b32 v6, 16, v245
    v_and_b32 v7, s67, v245
    v_fmac_f32 v46, v87, v6
    v_fmac_f32 v47, v87, v7
    v_lshlrev_b32 v8, 16, v246
    v_and_b32 v9, s67, v246
    v_fmac_f32 v48, v87, v8
    v_fmac_f32 v49, v87, v9
    v_lshlrev_b32 v10, 16, v247
    v_and_b32 v11, s67, v247
    v_fmac_f32 v50, v87, v10
    v_fmac_f32 v51, v87, v11
    s_waitcnt vmcnt(7)
    s_cmp_ge_u32 s101, 3
    s_cbranch_scc1 L_go374
    s_waitcnt vmcnt(6)
    s_cmp_ge_u32 s101, 2
    s_cbranch_scc1 L_go374
    s_waitcnt vmcnt(5)
    s_cmp_ge_u32 s101, 1
    s_cbranch_scc1 L_go374
    s_waitcnt vmcnt(4)
L_go374:
    buffer_load_dwordx4 v[120:123], v2, s[36:39], s66 offen offset:128 nt
    v_lshlrev_b32 v4, 16, v248
    v_and_b32 v5, s67, v248
    v_fmac_f32 v52, v87, v4
    v_fmac_f32 v53, v87, v5
    v_lshlrev_b32 v6, 16, v249
    v_and_b32 v7, s67, v249
    v_fmac_f32 v54, v87, v6
    v_fmac_f32 v55, v87, v7
    v_lshlrev_b32 v8, 16, v250
    v_and_b32 v9, s67, v250
    v_fmac_f32 v56, v87, v8
    v_fmac_f32 v57, v87, v9
    v_lshlrev_b32 v10, 16, v251
    v_and_b32 v11, s67, v251
    v_fmac_f32 v58, v87, v10
    v_fmac_f32 v59, v87, v11
    s_waitcnt vmcnt(7)
    s_cmp_ge_u32 s101, 3
    s_cbranch_scc1 L_go375
    s_waitcnt vmcnt(6)
    s_cmp_ge_u32 s101, 2
    s_cbranch_scc1 L_go375
    s_waitcnt vmcnt(5)
    s_cmp_ge_u32 s101, 1
    s_cbranch_scc1 L_go375
    s_waitcnt vmcnt(4)
L_go375:
    buffer_load_dwordx4 v[124:127], v2, s[36:39], s66 offen offset:256 nt
    v_lshlrev_b32 v4, 16, v92
    v_and_b32 v5, s67, v92
    v_fmac_f32 v36, v88, v4
    v_fmac_f32 v37, v88, v5
    v_lshlrev_b32 v6, 16, v93
    v_and_b32 v7, s67, v93
    v_fmac_f32 v38, v88, v6
    v_fmac_f32 v39, v88, v7
    v_lshlrev_b32 v8, 16, v94
    v_and_b32 v9, s67, v94
    v_fmac_f32 v40, v88, v8
    v_fmac_f32 v41, v88, v9
    v_lshlrev_b32 v10, 16, v95
    v_and_b32 v11, s67, v95
    v_fmac_f32 v42, v88, v10
    v_fmac_f32 v43, v88, v11
    s_waitcnt vmcnt(7)
    s_cmp_ge_u32 s101, 3
    s_cbranch_scc1 L_go376
    s_waitcnt vmcnt(6)
    s_cmp_ge_u32 s101, 2
    s_cbranch_scc1 L_go376
    s_waitcnt vmcnt(5)
    s_cmp_ge_u32 s101, 1
    s_cbranch_scc1 L_go376
    s_waitcnt vmcnt(4)
L_go376:
    s_add_u32 s66, s79, 31
    s_and_b32 s66, s66, 31
    s_mul_i32 s66, s66, 98304
    s_add_u32 s66, s66, s75
    buffer_load_dwordx4 v[128:131], v2, s[36:39], s66 offen offset:0 nt
    v_lshlrev_b32 v4, 16, v96
    v_and_b32 v5, s67, v96
    v_fmac_f32 v44, v88, v4
    v_fmac_f32 v45, v88, v5
    v_lshlrev_b32 v6, 16, v97
    v_and_b32 v7, s67, v97
    v_fmac_f32 v46, v88, v6
    v_fmac_f32 v47, v88, v7
    v_lshlrev_b32 v8, 16, v98
    v_and_b32 v9, s67, v98
    v_fmac_f32 v48, v88, v8
    v_fmac_f32 v49, v88, v9
    v_lshlrev_b32 v10, 16, v99
    v_and_b32 v11, s67, v99
    v_fmac_f32 v50, v88, v10
    v_fmac_f32 v51, v88, v11
    s_waitcnt vmcnt(7)
    s_cmp_ge_u32 s101, 3
    s_cbranch_scc1 L_go377
    s_waitcnt vmcnt(6)
    s_cmp_ge_u32 s101, 2
    s_cbranch_scc1 L_go377
    s_waitcnt vmcnt(5)
    s_cmp_ge_u32 s101, 1
    s_cbranch_scc1 L_go377
    s_waitcnt vmcnt(4)
L_go377:
    buffer_load_dwordx4 v[132:135], v2, s[36:39], s66 offen offset:128 nt
    v_lshlrev_b32 v4, 16, v100
    v_and_b32 v5, s67, v100
    v_fmac_f32 v52, v88, v4
    v_fmac_f32 v53, v88, v5
    v_lshlrev_b32 v6, 16, v101
    v_and_b32 v7, s67, v101
    v_fmac_f32 v54, v88, v6
    v_fmac_f32 v55, v88, v7
    v_lshlrev_b32 v8, 16, v102
    v_and_b32 v9, s67, v102
    v_fmac_f32 v56, v88, v8
    v_fmac_f32 v57, v88, v9
    v_lshlrev_b32 v10, 16, v103
    v_and_b32 v11, s67, v103
    v_fmac_f32 v58, v88, v10
    v_fmac_f32 v59, v88, v11
    s_waitcnt vmcnt(7)
    s_cmp_ge_u32 s101, 3
    s_cbranch_scc1 L_go378
    s_waitcnt vmcnt(6)
    s_cmp_ge_u32 s101, 2
    s_cbranch_scc1 L_go378
    s_waitcnt vmcnt(5)
    s_cmp_ge_u32 s101, 1
    s_cbranch_scc1 L_go378
    s_waitcnt vmcnt(4)
L_go378:
    buffer_load_dwordx4 v[136:139], v2, s[36:39], s66 offen offset:256 nt
    v_lshlrev_b32 v4, 16, v104
    v_and_b32 v5, s67, v104
    v_fmac_f32 v36, v89, v4
    v_fmac_f32 v37, v89, v5
    v_lshlrev_b32 v6, 16, v105
    v_and_b32 v7, s67, v105
    v_fmac_f32 v38, v89, v6
    v_fmac_f32 v39, v89, v7
    v_lshlrev_b32 v8, 16, v106
    v_and_b32 v9, s67, v106
    v_fmac_f32 v40, v89, v8
    v_fmac_f32 v41, v89, v9
    v_lshlrev_b32 v10, 16, v107
    v_and_b32 v11, s67, v107
    v_fmac_f32 v42, v89, v10
    v_fmac_f32 v43, v89, v11
    s_lshl_b32 s70, s63, 2
    v_mov_b32 v12, s70
    s_mov_b32 s74, 0
L_mx1_spin:
    ds_read_b32 v22, v12 offset:48
    ds_read_b32 v16, v3 offset:8
    s_waitcnt lgkmcnt(0)
    v_subrev_u32 v16, 1, v16
    v_max_u32 v16, v16, v22
    v_cmp_eq_u32 vcc, -1, v16
    s_cbranch_vccz L_mx1_done
    s_add_u32 s74, s74, 1
    s_cmp_ge_u32 s74, s100
    s_cbranch_scc1 L_mx1_done
    s_sleep 1
    s_branch L_mx1_spin
L_mx1_done:
    s_waitcnt vmcnt(7)
    v_lshlrev_b32 v4, 16, v108
    v_and_b32 v5, s67, v108
    v_fmac_f32 v44, v89, v4
    v_fmac_f32 v45, v89, v5
    v_lshlrev_b32 v6, 16, v109
    v_and_b32 v7, s67, v109
    v_fmac_f32 v46, v89, v6
    v_fmac_f32 v47, v89, v7
    v_lshlrev_b32 v8, 16, v110
    v_and_b32 v9, s67, v110
    v_fmac_f32 v48, v89, v8
    v_fmac_f32 v49, v89, v9
    v_lshlrev_b32 v10, 16, v111
    v_and_b32 v11, s67, v111
    v_fmac_f32 v50, v89, v10
    v_fmac_f32 v51, v89, v11
    s_waitcnt vmcnt(6)
    v_lshlrev_b32 v4, 16, v112
    v_and_b32 v5, s67, v112
    v_fmac_f32 v52, v89, v4
    v_fmac_f32 v53, v89, v5
    v_lshlrev_b32 v6, 16, v113
    v_and_b32 v7, s67, v113
    v_fmac_f32 v54, v89, v6
    v_fmac_f32 v55, v89, v7
    v_lshlrev_b32 v8, 16, v114
    v_and_b32 v9, s67, v114
    v_fmac_f32 v56, v89, v8
    v_fmac_f32 v57, v89, v9
    v_lshlrev_b32 v10, 16, v115
    v_and_b32 v11, s67, v115
    v_fmac_f32 v58, v89, v10
    v_fmac_f32 v59, v89, v11
    s_waitcnt vmcnt(5)
    v_lshlrev_b32 v4, 16, v116
    v_and_b32 v5, s67, v116
    v_fmac_f32 v36, v90, v4
    v_fmac_f32 v37, v90, v5
    v_lshlrev_b32 v6, 16, v117
    v_and_b32 v7, s67, v117
    v_fmac_f32 v38, v90, v6
    v_fmac_f32 v39, v90, v7
    v_lshlrev_b32 v8, 16, v118
    v_and_b32 v9, s67, v118
    v_fmac_f32 v40, v90, v8
    v_fmac_f32 v41, v90, v9
    v_lshlrev_b32 v10, 16, v119
    v_and_b32 v11, s67, v119
    v_fmac_f32 v42, v90, v10
    v_fmac_f32 v43, v90, v11
    s_waitcnt vmcnt(4)
    v_lshlrev_b32 v4, 16, v120
    v_and_b32 v5, s67, v120
    v_fmac_f32 v44, v90, v4
    v_fmac_f32 v45, v90, v5
    v_lshlrev_b32 v6, 16, v121
    v_and_b32 v7, s67, v121
    v_fmac_f32 v46, v90, v6
    v_fmac_f32 v47, v90, v7
    v_lshlrev_b32 v8, 16, v122
    v_and_b32 v9, s67, v122
    v_fmac_f32 v48, v90, v8
    v_fmac_f32 v49, v90, v9
    v_lshlrev_b32 v10, 16, v123
    v_and_b32 v11, s67, v123
    v_fmac_f32 v50, v90, v10
    v_fmac_f32 v51, v90, v11
    s_waitcnt vmcnt(3)
    v_lshlrev_b32 v4, 16, v124
    v_and_b32 v5, s67, v124
    v_fmac_f32 v52, v90, v4
    v_fmac_f32 v53, v90, v5
    v_lshlrev_b32 v6, 16, v125
    v_and_b32 v7, s67, v125
    v_fmac_f32 v54, v90, v6
    v_fmac_f32 v55, v90, v7
    v_lshlrev_b32 v8, 16, v126
    v_and_b32 v9, s67, v126
    v_fmac_f32 v56, v90, v8
    v_fmac_f32 v57, v90, v9
    v_lshlrev_b32 v10, 16, v127
    v_and_b32 v11, s67, v127
    v_fmac_f32 v58, v90, v10
    v_fmac_f32 v59, v90, v11
    s_waitcnt vmcnt(2)
    v_lshlrev_b32 v4, 16, v128
    v_and_b32 v5, s67, v128
    v_fmac_f32 v36, v91, v4
    v_fmac_f32 v37, v91, v5
    v_lshlrev_b32 v6, 16, v129
    v_and_b32 v7, s67, v129
    v_fmac_f32 v38, v91, v6
    v_fmac_f32 v39, v91, v7
    v_lshlrev_b32 v8, 16, v130
    v_and_b32 v9, s67, v130
    v_fmac_f32 v40, v91, v8
    v_fmac_f32 v41, v91, v9
    v_lshlrev_b32 v10, 16, v131
    v_and_b32 v11, s67, v131
    v_fmac_f32 v42, v91, v10
    v_fmac_f32 v43, v91, v11
    s_waitcnt vmcnt(1)
    v_lshlrev_b32 v4, 16, v132
    v_and_b32 v5, s67, v132
    v_fmac_f32 v44, v91, v4
    v_fmac_f32 v45, v91, v5
    v_lshlrev_b32 v6, 16, v133
    v_and_b32 v7, s67, v133
    v_fmac_f32 v46, v91, v6
    v_fmac_f32 v47, v91, v7
    v_lshlrev_b32 v8, 16, v134
    v_and_b32 v9, s67, v134
    v_fmac_f32 v48, v91, v8
    v_fmac_f32 v49, v91, v9
    v_lshlrev_b32 v10, 16, v135
    v_and_b32 v11, s67, v135
    v_fmac_f32 v50, v91, v10
    v_fmac_f32 v51, v91, v11
    s_waitcnt vmcnt(0)
    v_lshlrev_b32 v4, 16, v136
    v_and_b32 v5, s67, v136
    v_fmac_f32 v52, v91, v4
    v_fmac_f32 v53, v91, v5
    v_lshlrev_b32 v6, 16, v137
    v_and_b32 v7, s67, v137
    v_fmac_f32 v54, v91, v6
    v_fmac_f32 v55, v91, v7
    v_lshlrev_b32 v8, 16, v138
    v_and_b32 v9, s67, v138
    v_fmac_f32 v56, v91, v8
    v_fmac_f32 v57, v91, v9
    v_lshlrev_b32 v10, 16, v139
    v_and_b32 v11, s67, v139
    v_fmac_f32 v58, v91, v10
    v_fmac_f32 v59, v91, v11
    v_permlane32_swap_b32 v36, v48
    v_permlane32_swap_b32 v37, v49
    v_permlane32_swap_b32 v38, v50
    v_permlane32_swap_b32 v39, v51
    v_permlane32_swap_b32 v40, v52
    v_permlane32_swap_b32 v41, v53
    v_permlane32_swap_b32 v42, v54
    v_permlane32_swap_b32 v43, v55
    v_permlane32_swap_b32 v44, v56
    v_permlane32_swap_b32 v45, v57
    v_permlane32_swap_b32 v46, v58
    v_permlane32_swap_b32 v47, v59
    v_add_f32 v36, v36, v48
    v_add_f32 v37, v37, v49
    v_add_f32 v38, v38, v50
    v_add_f32 v39, v39, v51
    v_add_f32 v40, v40, v52
    v_add_f32 v41, v41, v53
    v_add_f32 v42, v42, v54
    v_add_f32 v43, v43, v55
    v_add_f32 v44, v44, v56
    v_add_f32 v45, v45, v57
    v_add_f32 v46, v46, v58
    v_add_f32 v47, v47, v59
    v_permlane16_swap_b32 v36, v42
    v_permlane16_swap_b32 v37, v43
    v_permlane16_swap_b32 v38, v44
    v_permlane16_swap_b32 v39, v45
    v_permlane16_swap_b32 v40, v46
    v_permlane16_swap_b32 v41, v47
    v_add_f32 v36, v36, v42
    v_add_f32 v37, v37, v43
    v_add_f32 v38, v38, v44
    v_add_f32 v39, v39, v45
    v_add_f32 v40, v40, v46
    v_add_f32 v41, v41, v47
    v_add_f32_dpp v48, v36, v36 row_ror:8 row_mask:0xf bank_mask:0x3
    v_add_f32_dpp v49, v37, v37 row_ror:8 row_mask:0xf bank_mask:0x3
    v_add_f32_dpp v50, v38, v38 row_ror:8 row_mask:0xf bank_mask:0x3
    v_add_f32_dpp v48, v39, v39 row_ror:8 row_mask:0xf bank_mask:0xc
    v_add_f32_dpp v49, v40, v40 row_ror:8 row_mask:0xf bank_mask:0xc
    v_add_f32_dpp v50, v41, v41 row_ror:8 row_mask:0xf bank_mask:0xc
    v_mul_f32 v48, v48, v22
    v_mul_f32 v49, v49, v22
    v_mul_f32 v50, v50, v22
    ds_write_b32 v252, v48 offset:4096
    ds_write_b32 v252, v49 offset:4100
    ds_write_b32 v252, v50 offset:4104
    s_mov_b64 exec, 1
    ds_add_rtn_u32 v16, v3, v17 offset:16
    s_mov_b64 exec, -1
    s_lshl_b32 s71, s3, 10
    s_waitcnt lgkmcnt(0)
    v_readfirstlane_b32 s77, v16
    s_nop 0
    s_cmp_lg_u32 s77, 3
    s_cbranch_scc1 L_fl1
    ds_read_b128 v[36:39], v18 offset:4096
    ds_read_b128 v[40:43], v18 offset:4864
    ds_read_b128 v[44:47], v18 offset:5632
    ds_read_b128 v[48:51], v18 offset:6400
    s_waitcnt lgkmcnt(0)
    v_pk_add_f32 v[36:37], v[36:37], v[40:41]
    v_pk_add_f32 v[44:45], v[44:45], v[48:49]
    v_pk_add_f32 v[38:39], v[38:39], v[42:43]
    v_pk_add_f32 v[46:47], v[46:47], v[50:51]
    v_pk_add_f32 v[36:37], v[36:37], v[44:45]
    v_pk_add_f32 v[38:39], v[38:39], v[46:47]
    buffer_store_dwordx4 v[36:39], v19, s[56:59], s71 offen sc1
    ds_write_b32 v3, v17 offset:12
L_fl1:
    s_endpgm
L_helper:
    s_setprio 3
    s_mov_b32 s76, 0x05040100
    s_mov_b32 s77, 0x07060302
    s_mul_i32 s68, s61, 5
    s_add_u32 s68, s68, s64
    s_mul_i32 s75, s61, 3
    s_add_u32 s75, s75, s64
    s_sub_u32 s75, s75, 5
    s_lshl_b32 s75, s75, 4
    v_mul_u32_u24 v4, 10923, v1
    v_lshrrev_b32 v4, 16, v4
    v_mul_u32_u24 v5, 6, v4
    v_sub_u32 v5, v1, v5
    s_and_b32 s70, s64, 1
    s_mul_i32 s70, s70, 320
    s_mul_i32 s71, s60, 80
    s_add_u32 s70, s70, s71
    v_mul_u32_u24 v6, 10, v4
    v_add_u32 v6, s70, v6
    v_lshlrev_b32 v26, 1, v6
    v_mul_u32_u24 v27, 40, v1
    v_mul_u32_u24 v28, 12288, v6
    v_lshl_add_u32 v28, v5, 4, v28
    s_mul_i32 s70, s61, 384
    s_lshr_b32 s71, s64, 1
    s_mul_i32 s71, s71, 96
    s_add_u32 s70, s70, s71
    v_add_u32 v28, s70, v28
    v_cmp_gt_u32 vcc, 48, v1
    v_mov_b32 v7, 0x7f000000
    s_nop 0
    v_cndmask_b32 v28, v7, v28, vcc
    s_waitcnt lgkmcnt(0)
    s_barrier
    s_mov_b32 s28, s4
    s_mov_b32 s29, s5
    s_mov_b32 s40, s10
    s_mov_b32 s41, s11
    buffer_load_dwordx4 v[32:35], v27, s[28:31], 0 offen
    buffer_load_dwordx4 v[36:39], v27, s[28:31], 0 offen offset:16
    buffer_load_dwordx2 v[40:41], v27, s[28:31], 0 offen offset:32
    buffer_load_dwordx4 v[44:47], v26, s[28:31], 0 offen offset:0
    buffer_load_dword v42, v26, s[28:31], 0 offen offset:16
    buffer_load_dwordx4 v[48:51], v26, s[28:31], 0 offen offset:1280
    buffer_load_dword v43, v26, s[28:31], 0 offen offset:1296
    buffer_load_dwordx4 v[108:111], v28, s[40:43], 0 offen nt
    s_mov_b32 s66, 12288
    buffer_load_dwordx4 v[112:115], v28, s[40:43], s66 offen nt
    s_mov_b32 s66, 24576
    buffer_load_dwordx4 v[116:119], v28, s[40:43], s66 offen nt
    s_mov_b32 s66, 36864
    buffer_load_dwordx4 v[120:123], v28, s[40:43], s66 offen nt
    s_mov_b32 s66, 49152
    buffer_load_dwordx4 v[124:127], v28, s[40:43], s66 offen nt
    s_mov_b32 s66, 61440
    buffer_load_dwordx4 v[128:131], v28, s[40:43], s66 offen nt
    s_mov_b32 s66, 73728
    buffer_load_dwordx4 v[132:135], v28, s[40:43], s66 offen nt
    s_mov_b32 s66, 86016
    buffer_load_dwordx4 v[136:139], v28, s[40:43], s66 offen nt
    s_mov_b32 s66, 98304
    buffer_load_dwordx4 v[140:143], v28, s[40:43], s66 offen nt
    s_mov_b32 s66, 110592
    buffer_load_dwordx4 v[144:147], v28, s[40:43], s66 offen nt
    s_mov_b32 s56, s24
    s_mov_b32 s57, s25
    s_mov_b32 s48, s20
    s_mov_b32 s49, s21
    s_mov_b32 s52, s22
    s_mov_b32 s53, s23
    s_cmp_lt_u32 s64, 5
    s_cselect_b32 s44, s12, s16
    s_cselect_b32 s45, s13, s17
    s_cselect_b32 s96, s12, s18
    s_cselect_b32 s97, s13, s19
    s_mov_b32 s46, 1966080
    s_cselect_b32 s46, 7864320, s46
    s_mov_b32 s98, s46
    s_mov_b32 s47, 0x20000
    s_mov_b32 s99, 0x20000
    v_lshlrev_b32 v29, 5, v1
    s_mul_i32 s70, s60, 3072
    v_add_u32 v29, s70, v29
    v_lshlrev_b32 v24, 4, v1
    v_mul_u32_u24 v25, 2560, v20
    v_lshl_add_u32 v25, v21, 4, v25
    s_mul_i32 s70, s78, 5120
    s_lshl_b32 s71, s79, 7
    s_add_u32 s70, s70, s71
    s_add_u32 s70, s70, 262144
    s_cmp_ge_u32 s64, 5
    s_cselect_b32 s70, 4194304, s70
    v_add_u32 v25, s70, v25
    v_cmp_le_u32 vcc, 16, v1
    v_mov_b32 v7, 4194304
    s_nop 0
    v_cndmask_b32 v25, v25, v7, vcc
    v_mov_b32 v8, -1
    v_mov_b32 v9, -1
    v_mov_b32 v10, -1
    v_mov_b32 v11, -1
    s_cmp_lg_u32 s60, 3
    s_cbranch_scc1 L_clr_done
    s_mul_i32 s71, s68, 3072
    s_add_u32 s71, s71, 458752
    s_cmp_ge_u32 s64, 5
    s_cselect_b32 s71, 4194304, s71
    buffer_store_dwordx4 v[8:11], v24, s[56:59], s71 offen offset:0 sc1
    buffer_store_dwordx4 v[8:11], v24, s[56:59], s71 offen offset:1024 sc1
    buffer_store_dwordx4 v[8:11], v24, s[56:59], s71 offen offset:2048 sc1
    s_lshl_b32 s70, s3, 10
    s_mov_b32 exec_hi, 0x3ffff
    buffer_store_dwordx4 v[8:11], v24, s[56:59], s70 offen sc1
    s_mov_b64 exec, -1
    buffer_store_dwordx4 v[8:11], v25, s[56:59], 0 offen sc1
    s_cmp_lg_u32 s3, 7
    s_cbranch_scc1 L_clr_done
    s_mov_b32 s70, 983040
    buffer_store_dwordx4 v[8:11], v24, s[56:59], s70 offen offset:0 sc1
    buffer_store_dwordx4 v[8:11], v24, s[56:59], s70 offen offset:1024 sc1
    buffer_store_dwordx4 v[8:11], v24, s[56:59], s70 offen offset:2048 sc1
    buffer_store_dwordx4 v[8:11], v24, s[56:59], s70 offen offset:3072 sc1
L_clr_done:
    s_cmp_lg_u32 s60, 3
    s_cbranch_scc1 L_h3w
    s_waitcnt vmcnt(0)
L_h3w:
    s_waitcnt vmcnt(10)
    v_lshlrev_b32 v52, 16, v32
    v_and_b32 v53, s67, v32
    v_lshlrev_b32 v54, 16, v33
    v_and_b32 v55, s67, v33
    v_lshlrev_b32 v56, 16, v34
    v_and_b32 v57, s67, v34
    v_lshlrev_b32 v58, 16, v35
    v_and_b32 v59, s67, v35
    v_lshlrev_b32 v60, 16, v36
    v_and_b32 v61, s67, v36
    v_lshlrev_b32 v62, 16, v37
    v_and_b32 v63, s67, v37
    v_lshlrev_b32 v64, 16, v38
    v_and_b32 v65, s67, v38
    v_lshlrev_b32 v66, 16, v39
    v_and_b32 v67, s67, v39
    v_lshlrev_b32 v68, 16, v40
    v_and_b32 v69, s67, v40
    v_lshlrev_b32 v70, 16, v41
    v_and_b32 v71, s67, v41
    v_pk_add_f32 v[8:9], v[52:53], v[54:55]
    v_pk_add_f32 v[8:9], v[8:9], v[56:57]
    v_pk_add_f32 v[8:9], v[8:9], v[58:59]
    v_pk_add_f32 v[8:9], v[8:9], v[60:61]
    v_pk_add_f32 v[8:9], v[8:9], v[62:63]
    v_pk_add_f32 v[8:9], v[8:9], v[64:65]
    v_pk_add_f32 v[8:9], v[8:9], v[66:67]
    v_pk_add_f32 v[8:9], v[8:9], v[68:69]
    v_pk_add_f32 v[8:9], v[8:9], v[70:71]
    v_add_f32 v4, v8, v9
    s_nop 1
    v_add_f32_dpp v4, v4, v4 quad_perm:[1,0,3,2] row_mask:0xf bank_mask:0xf
    s_nop 1
    v_add_f32_dpp v4, v4, v4 quad_perm:[2,3,0,1] row_mask:0xf bank_mask:0xf
    s_nop 1
    v_add_f32_dpp v4, v4, v4 row_half_mirror row_mask:0xf bank_mask:0xf
    s_nop 1
    v_add_f32_dpp v4, v4, v4 row_mirror row_mask:0xf bank_mask:0xf
    v_mov_b32 v5, v4
    s_nop 1
    v_permlane16_swap_b32 v4, v5
    v_add_f32 v4, v4, v5
    v_mul_f32 v4, 0xbacccccd, v4
    v_pk_add_f32 v[10:11], v[52:53], v[4:5] op_sel_hi:[1,0]
    v_pk_mul_f32 v[8:9], v[10:11], v[10:11]
    v_pk_add_f32 v[10:11], v[54:55], v[4:5] op_sel_hi:[1,0]
    v_pk_fma_f32 v[8:9], v[10:11], v[10:11], v[8:9]
    v_pk_add_f32 v[10:11], v[56:57], v[4:5] op_sel_hi:[1,0]
    v_pk_fma_f32 v[8:9], v[10:11], v[10:11], v[8:9]
    v_pk_add_f32 v[10:11], v[58:59], v[4:5] op_sel_hi:[1,0]
    v_pk_fma_f32 v[8:9], v[10:11], v[10:11], v[8:9]
    v_pk_add_f32 v[10:11], v[60:61], v[4:5] op_sel_hi:[1,0]
    v_pk_fma_f32 v[8:9], v[10:11], v[10:11], v[8:9]
    v_pk_add_f32 v[10:11], v[62:63], v[4:5] op_sel_hi:[1,0]
    v_pk_fma_f32 v[8:9], v[10:11], v[10:11], v[8:9]
    v_pk_add_f32 v[10:11], v[64:65], v[4:5] op_sel_hi:[1,0]
    v_pk_fma_f32 v[8:9], v[10:11], v[10:11], v[8:9]
    v_pk_add_f32 v[10:11], v[66:67], v[4:5] op_sel_hi:[1,0]
    v_pk_fma_f32 v[8:9], v[10:11], v[10:11], v[8:9]
    v_pk_add_f32 v[10:11], v[68:69], v[4:5] op_sel_hi:[1,0]
    v_pk_fma_f32 v[8:9], v[10:11], v[10:11], v[8:9]
    v_pk_add_f32 v[10:11], v[70:71], v[4:5] op_sel_hi:[1,0]
    v_pk_fma_f32 v[8:9], v[10:11], v[10:11], v[8:9]
    v_add_f32 v6, v8, v9
    s_nop 1
    v_add_f32_dpp v6, v6, v6 quad_perm:[1,0,3,2] row_mask:0xf bank_mask:0xf
    s_nop 1
    v_add_f32_dpp v6, v6, v6 quad_perm:[2,3,0,1] row_mask:0xf bank_mask:0xf
    s_nop 1
    v_add_f32_dpp v6, v6, v6 row_half_mirror row_mask:0xf bank_mask:0xf
    s_nop 1
    v_add_f32_dpp v6, v6, v6 row_mirror row_mask:0xf bank_mask:0xf
    v_mov_b32 v7, v6
    s_nop 1
    v_permlane16_swap_b32 v6, v7
    v_add_f32 v6, v6, v7
    v_mul_f32 v6, 0x3acccccd, v6
    v_cvt_pk_bf16_f32 v4, v4, v4
    v_lshlrev_b32 v4, 16, v4
    v_cvt_pk_bf16_f32 v6, v6, v6
    v_lshlrev_b32 v6, 16, v6
    v_add_f32 v6, 0x3727c5ac, v6
    v_cvt_pk_bf16_f32 v6, v6, v6
    v_lshlrev_b32 v6, 16, v6
    v_sqrt_f32 v6, v6
    s_nop 0
    v_cvt_pk_bf16_f32 v6, v6, v6
    v_lshlrev_b32 v6, 16, v6
    v_rcp_f32 v6, v6
    v_mov_b32 v5, v4
    v_mov_b32 v7, v6
    s_nop 0
    v_permlane32_swap_b32 v4, v5
    v_permlane32_swap_b32 v6, v7
    v_lshlrev_b32 v72, 16, v44
    v_and_b32 v73, s67, v44
    v_pk_add_f32 v[72:73], v[72:73], v[4:5] op_sel_hi:[1,0]
    v_cvt_pk_bf16_f32 v73, v72, v73
    v_lshlrev_b32 v72, 16, v73
    v_and_b32 v73, s67, v73
    v_pk_mul_f32 v[72:73], v[72:73], v[6:7] op_sel_hi:[1,0]
    v_cvt_pk_bf16_f32 v73, v72, v73
    v_lshlrev_b32 v72, 16, v73
    v_and_b32 v73, s67, v73
    v_lshlrev_b32 v74, 16, v45
    v_and_b32 v75, s67, v45
    v_pk_add_f32 v[74:75], v[74:75], v[4:5] op_sel_hi:[1,0]
    v_cvt_pk_bf16_f32 v75, v74, v75
    v_lshlrev_b32 v74, 16, v75
    v_and_b32 v75, s67, v75
    v_pk_mul_f32 v[74:75], v[74:75], v[6:7] op_sel_hi:[1,0]
    v_cvt_pk_bf16_f32 v75, v74, v75
    v_lshlrev_b32 v74, 16, v75
    v_and_b32 v75, s67, v75
    v_lshlrev_b32 v76, 16, v46
    v_and_b32 v77, s67, v46
    v_pk_add_f32 v[76:77], v[76:77], v[4:5] op_sel_hi:[1,0]
    v_cvt_pk_bf16_f32 v77, v76, v77
    v_lshlrev_b32 v76, 16, v77
    v_and_b32 v77, s67, v77
    v_pk_mul_f32 v[76:77], v[76:77], v[6:7] op_sel_hi:[1,0]
    v_cvt_pk_bf16_f32 v77, v76, v77
    v_lshlrev_b32 v76, 16, v77
    v_and_b32 v77, s67, v77
    v_lshlrev_b32 v78, 16, v47
    v_and_b32 v79, s67, v47
    v_pk_add_f32 v[78:79], v[78:79], v[4:5] op_sel_hi:[1,0]
    v_cvt_pk_bf16_f32 v79, v78, v79
    v_lshlrev_b32 v78, 16, v79
    v_and_b32 v79, s67, v79
    v_pk_mul_f32 v[78:79], v[78:79], v[6:7] op_sel_hi:[1,0]
    v_cvt_pk_bf16_f32 v79, v78, v79
    v_lshlrev_b32 v78, 16, v79
    v_and_b32 v79, s67, v79
    v_lshlrev_b32 v80, 16, v42
    v_and_b32 v81, s67, v42
    v_pk_add_f32 v[80:81], v[80:81], v[4:5] op_sel_hi:[1,0]
    v_cvt_pk_bf16_f32 v81, v80, v81
    v_lshlrev_b32 v80, 16, v81
    v_and_b32 v81, s67, v81
    v_pk_mul_f32 v[80:81], v[80:81], v[6:7] op_sel_hi:[1,0]
    v_cvt_pk_bf16_f32 v81, v80, v81
    v_lshlrev_b32 v80, 16, v81
    v_and_b32 v81, s67, v81
    v_lshlrev_b32 v82, 16, v48
    v_and_b32 v83, s67, v48
    v_pk_add_f32 v[82:83], v[82:83], v[4:5] op_sel:[0,1] op_sel_hi:[1,1]
    v_cvt_pk_bf16_f32 v83, v82, v83
    v_lshlrev_b32 v82, 16, v83
    v_and_b32 v83, s67, v83
    v_pk_mul_f32 v[82:83], v[82:83], v[6:7] op_sel:[0,1] op_sel_hi:[1,1]
    v_cvt_pk_bf16_f32 v83, v82, v83
    v_lshlrev_b32 v82, 16, v83
    v_and_b32 v83, s67, v83
    v_lshlrev_b32 v84, 16, v49
    v_and_b32 v85, s67, v49
    v_pk_add_f32 v[84:85], v[84:85], v[4:5] op_sel:[0,1] op_sel_hi:[1,1]
    v_cvt_pk_bf16_f32 v85, v84, v85
    v_lshlrev_b32 v84, 16, v85
    v_and_b32 v85, s67, v85
    v_pk_mul_f32 v[84:85], v[84:85], v[6:7] op_sel:[0,1] op_sel_hi:[1,1]
    v_cvt_pk_bf16_f32 v85, v84, v85
    v_lshlrev_b32 v84, 16, v85
    v_and_b32 v85, s67, v85
    v_lshlrev_b32 v86, 16, v50
    v_and_b32 v87, s67, v50
    v_pk_add_f32 v[86:87], v[86:87], v[4:5] op_sel:[0,1] op_sel_hi:[1,1]
    v_cvt_pk_bf16_f32 v87, v86, v87
    v_lshlrev_b32 v86, 16, v87
    v_and_b32 v87, s67, v87
    v_pk_mul_f32 v[86:87], v[86:87], v[6:7] op_sel:[0,1] op_sel_hi:[1,1]
    v_cvt_pk_bf16_f32 v87, v86, v87
    v_lshlrev_b32 v86, 16, v87
    v_and_b32 v87, s67, v87
    v_lshlrev_b32 v88, 16, v51
    v_and_b32 v89, s67, v51
    v_pk_add_f32 v[88:89], v[88:89], v[4:5] op_sel:[0,1] op_sel_hi:[1,1]
    v_cvt_pk_bf16_f32 v89, v88, v89
    v_lshlrev_b32 v88, 16, v89
    v_and_b32 v89, s67, v89
    v_pk_mul_f32 v[88:89], v[88:89], v[6:7] op_sel:[0,1] op_sel_hi:[1,1]
    v_cvt_pk_bf16_f32 v89, v88, v89
    v_lshlrev_b32 v88, 16, v89
    v_and_b32 v89, s67, v89
    v_lshlrev_b32 v90, 16, v43
    v_and_b32 v91, s67, v43
    v_pk_add_f32 v[90:91], v[90:91], v[4:5] op_sel:[0,1] op_sel_hi:[1,1]
    v_cvt_pk_bf16_f32 v91, v90, v91
    v_lshlrev_b32 v90, 16, v91
    v_and_b32 v91, s67, v91
    v_pk_mul_f32 v[90:91], v[90:91], v[6:7] op_sel:[0,1] op_sel_hi:[1,1]
    v_cvt_pk_bf16_f32 v91, v90, v91
    v_lshlrev_b32 v90, 16, v91
    v_and_b32 v91, s67, v91
    s_waitcnt vmcnt(9)
    v_lshlrev_b32 v8, 16, v108
    v_and_b32 v9, s67, v108
    v_mul_f32 v92, v72, v8
    v_mul_f32 v93, v72, v9
    v_mul_f32 v100, v82, v8
    v_mul_f32 v101, v82, v9
    v_lshlrev_b32 v10, 16, v109
    v_and_b32 v11, s67, v109
    v_mul_f32 v94, v72, v10
    v_mul_f32 v95, v72, v11
    v_mul_f32 v102, v82, v10
    v_mul_f32 v103, v82, v11
    v_lshlrev_b32 v12, 16, v110
    v_and_b32 v13, s67, v110
    v_mul_f32 v96, v72, v12
    v_mul_f32 v97, v72, v13
    v_mul_f32 v104, v82, v12
    v_mul_f32 v105, v82, v13
    v_lshlrev_b32 v14, 16, v111
    v_and_b32 v15, s67, v111
    v_mul_f32 v98, v72, v14
    v_mul_f32 v99, v72, v15
    v_mul_f32 v106, v82, v14
    v_mul_f32 v107, v82, v15
    s_waitcnt vmcnt(8)
    v_lshlrev_b32 v8, 16, v112
    v_and_b32 v9, s67, v112
    v_fmac_f32 v92, v73, v8
    v_fmac_f32 v93, v73, v9
    v_fmac_f32 v100, v83, v8
    v_fmac_f32 v101, v83, v9
    v_lshlrev_b32 v10, 16, v113
    v_and_b32 v11, s67, v113
    v_fmac_f32 v94, v73, v10
    v_fmac_f32 v95, v73, v11
    v_fmac_f32 v102, v83, v10
    v_fmac_f32 v103, v83, v11
    v_lshlrev_b32 v12, 16, v114
    v_and_b32 v13, s67, v114
    v_fmac_f32 v96, v73, v12
    v_fmac_f32 v97, v73, v13
    v_fmac_f32 v104, v83, v12
    v_fmac_f32 v105, v83, v13
    v_lshlrev_b32 v14, 16, v115
    v_and_b32 v15, s67, v115
    v_fmac_f32 v98, v73, v14
    v_fmac_f32 v99, v73, v15
    v_fmac_f32 v106, v83, v14
    v_fmac_f32 v107, v83, v15
    s_waitcnt vmcnt(7)
    v_lshlrev_b32 v8, 16, v116
    v_and_b32 v9, s67, v116
    v_fmac_f32 v92, v74, v8
    v_fmac_f32 v93, v74, v9
    v_fmac_f32 v100, v84, v8
    v_fmac_f32 v101, v84, v9
    v_lshlrev_b32 v10, 16, v117
    v_and_b32 v11, s67, v117
    v_fmac_f32 v94, v74, v10
    v_fmac_f32 v95, v74, v11
    v_fmac_f32 v102, v84, v10
    v_fmac_f32 v103, v84, v11
    v_lshlrev_b32 v12, 16, v118
    v_and_b32 v13, s67, v118
    v_fmac_f32 v96, v74, v12
    v_fmac_f32 v97, v74, v13
    v_fmac_f32 v104, v84, v12
    v_fmac_f32 v105, v84, v13
    v_lshlrev_b32 v14, 16, v119
    v_and_b32 v15, s67, v119
    v_fmac_f32 v98, v74, v14
    v_fmac_f32 v99, v74, v15
    v_fmac_f32 v106, v84, v14
    v_fmac_f32 v107, v84, v15
    s_waitcnt vmcnt(6)
    v_lshlrev_b32 v8, 16, v120
    v_and_b32 v9, s67, v120
    v_fmac_f32 v92, v75, v8
    v_fmac_f32 v93, v75, v9
    v_fmac_f32 v100, v85, v8
    v_fmac_f32 v101, v85, v9
    v_lshlrev_b32 v10, 16, v121
    v_and_b32 v11, s67, v121
    v_fmac_f32 v94, v75, v10
    v_fmac_f32 v95, v75, v11
    v_fmac_f32 v102, v85, v10
    v_fmac_f32 v103, v85, v11
    v_lshlrev_b32 v12, 16, v122
    v_and_b32 v13, s67, v122
    v_fmac_f32 v96, v75, v12
    v_fmac_f32 v97, v75, v13
    v_fmac_f32 v104, v85, v12
    v_fmac_f32 v105, v85, v13
    v_lshlrev_b32 v14, 16, v123
    v_and_b32 v15, s67, v123
    v_fmac_f32 v98, v75, v14
    v_fmac_f32 v99, v75, v15
    v_fmac_f32 v106, v85, v14
    v_fmac_f32 v107, v85, v15
    s_waitcnt vmcnt(5)
    v_lshlrev_b32 v8, 16, v124
    v_and_b32 v9, s67, v124
    v_fmac_f32 v92, v76, v8
    v_fmac_f32 v93, v76, v9
    v_fmac_f32 v100, v86, v8
    v_fmac_f32 v101, v86, v9
    v_lshlrev_b32 v10, 16, v125
    v_and_b32 v11, s67, v125
    v_fmac_f32 v94, v76, v10
    v_fmac_f32 v95, v76, v11
    v_fmac_f32 v102, v86, v10
    v_fmac_f32 v103, v86, v11
    v_lshlrev_b32 v12, 16, v126
    v_and_b32 v13, s67, v126
    v_fmac_f32 v96, v76, v12
    v_fmac_f32 v97, v76, v13
    v_fmac_f32 v104, v86, v12
    v_fmac_f32 v105, v86, v13
    v_lshlrev_b32 v14, 16, v127
    v_and_b32 v15, s67, v127
    v_fmac_f32 v98, v76, v14
    v_fmac_f32 v99, v76, v15
    v_fmac_f32 v106, v86, v14
    v_fmac_f32 v107, v86, v15
    s_waitcnt vmcnt(4)
    v_lshlrev_b32 v8, 16, v128
    v_and_b32 v9, s67, v128
    v_fmac_f32 v92, v77, v8
    v_fmac_f32 v93, v77, v9
    v_fmac_f32 v100, v87, v8
    v_fmac_f32 v101, v87, v9
    v_lshlrev_b32 v10, 16, v129
    v_and_b32 v11, s67, v129
    v_fmac_f32 v94, v77, v10
    v_fmac_f32 v95, v77, v11
    v_fmac_f32 v102, v87, v10
    v_fmac_f32 v103, v87, v11
    v_lshlrev_b32 v12, 16, v130
    v_and_b32 v13, s67, v130
    v_fmac_f32 v96, v77, v12
    v_fmac_f32 v97, v77, v13
    v_fmac_f32 v104, v87, v12
    v_fmac_f32 v105, v87, v13
    v_lshlrev_b32 v14, 16, v131
    v_and_b32 v15, s67, v131
    v_fmac_f32 v98, v77, v14
    v_fmac_f32 v99, v77, v15
    v_fmac_f32 v106, v87, v14
    v_fmac_f32 v107, v87, v15
    s_waitcnt vmcnt(3)
    v_lshlrev_b32 v8, 16, v132
    v_and_b32 v9, s67, v132
    v_fmac_f32 v92, v78, v8
    v_fmac_f32 v93, v78, v9
    v_fmac_f32 v100, v88, v8
    v_fmac_f32 v101, v88, v9
    v_lshlrev_b32 v10, 16, v133
    v_and_b32 v11, s67, v133
    v_fmac_f32 v94, v78, v10
    v_fmac_f32 v95, v78, v11
    v_fmac_f32 v102, v88, v10
    v_fmac_f32 v103, v88, v11
    v_lshlrev_b32 v12, 16, v134
    v_and_b32 v13, s67, v134
    v_fmac_f32 v96, v78, v12
    v_fmac_f32 v97, v78, v13
    v_fmac_f32 v104, v88, v12
    v_fmac_f32 v105, v88, v13
    v_lshlrev_b32 v14, 16, v135
    v_and_b32 v15, s67, v135
    v_fmac_f32 v98, v78, v14
    v_fmac_f32 v99, v78, v15
    v_fmac_f32 v106, v88, v14
    v_fmac_f32 v107, v88, v15
    s_waitcnt vmcnt(2)
    v_lshlrev_b32 v8, 16, v136
    v_and_b32 v9, s67, v136
    v_fmac_f32 v92, v79, v8
    v_fmac_f32 v93, v79, v9
    v_fmac_f32 v100, v89, v8
    v_fmac_f32 v101, v89, v9
    v_lshlrev_b32 v10, 16, v137
    v_and_b32 v11, s67, v137
    v_fmac_f32 v94, v79, v10
    v_fmac_f32 v95, v79, v11
    v_fmac_f32 v102, v89, v10
    v_fmac_f32 v103, v89, v11
    v_lshlrev_b32 v12, 16, v138
    v_and_b32 v13, s67, v138
    v_fmac_f32 v96, v79, v12
    v_fmac_f32 v97, v79, v13
    v_fmac_f32 v104, v89, v12
    v_fmac_f32 v105, v89, v13
    v_lshlrev_b32 v14, 16, v139
    v_and_b32 v15, s67, v139
    v_fmac_f32 v98, v79, v14
    v_fmac_f32 v99, v79, v15
    v_fmac_f32 v106, v89, v14
    v_fmac_f32 v107, v89, v15
    s_waitcnt vmcnt(1)
    v_lshlrev_b32 v8, 16, v140
    v_and_b32 v9, s67, v140
    v_fmac_f32 v92, v80, v8
    v_fmac_f32 v93, v80, v9
    v_fmac_f32 v100, v90, v8
    v_fmac_f32 v101, v90, v9
    v_lshlrev_b32 v10, 16, v141
    v_and_b32 v11, s67, v141
    v_fmac_f32 v94, v80, v10
    v_fmac_f32 v95, v80, v11
    v_fmac_f32 v102, v90, v10
    v_fmac_f32 v103, v90, v11
    v_lshlrev_b32 v12, 16, v142
    v_and_b32 v13, s67, v142
    v_fmac_f32 v96, v80, v12
    v_fmac_f32 v97, v80, v13
    v_fmac_f32 v104, v90, v12
    v_fmac_f32 v105, v90, v13
    v_lshlrev_b32 v14, 16, v143
    v_and_b32 v15, s67, v143
    v_fmac_f32 v98, v80, v14
    v_fmac_f32 v99, v80, v15
    v_fmac_f32 v106, v90, v14
    v_fmac_f32 v107, v90, v15
    s_waitcnt vmcnt(0)
    v_lshlrev_b32 v8, 16, v144
    v_and_b32 v9, s67, v144
    v_fmac_f32 v92, v81, v8
    v_fmac_f32 v93, v81, v9
    v_fmac_f32 v100, v91, v8
    v_fmac_f32 v101, v91, v9
    v_lshlrev_b32 v10, 16, v145
    v_and_b32 v11, s67, v145
    v_fmac_f32 v94, v81, v10
    v_fmac_f32 v95, v81, v11
    v_fmac_f32 v102, v91, v10
    v_fmac_f32 v103, v91, v11
    v_lshlrev_b32 v12, 16, v146
    v_and_b32 v13, s67, v146
    v_fmac_f32 v96, v81, v12
    v_fmac_f32 v97, v81, v13
    v_fmac_f32 v104, v91, v12
    v_fmac_f32 v105, v91, v13
    v_lshlrev_b32 v14, 16, v147
    v_and_b32 v15, s67, v147
    v_fmac_f32 v98, v81, v14
    v_fmac_f32 v99, v81, v15
    v_fmac_f32 v106, v91, v14
    v_fmac_f32 v107, v91, v15
    v_cmp_gt_u32 vcc, 48, v1
    s_nop 0
    s_and_saveexec_b64 s[72:73], vcc
    ds_write_b128 v29, v[92:95] offset:7168
    ds_write_b128 v29, v[96:99] offset:7184
    ds_write_b128 v29, v[100:103] offset:8704
    ds_write_b128 v29, v[104:107] offset:8720
    s_mov_b64 exec, 1
    v_mov_b32 v4, 1
    ds_add_rtn_u32 v5, v3, v4 offset:0
    s_mov_b64 exec, -1
    s_waitcnt lgkmcnt(0)
    v_readfirstlane_b32 s70, v5
    v_cmp_gt_u32 vcc, 48, v1
    v_mov_b32 v7, 4194304
    s_nop 0
    v_cndmask_b32 v30, v7, v24, vcc
    s_cmp_lg_u32 s70, 3
    s_cbranch_scc1 L_q_skip
    v_mul_u32_u24 v6, 5462, v1
    v_lshrrev_b32 v6, 16, v6
    v_mul_u32_u24 v7, 12, v6
    v_sub_u32 v7, v1, v7
    v_mul_u32_u24 v8, 1536, v6
    v_lshl_add_u32 v8, v7, 4, v8
    ds_read_b128 v[108:111], v8 offset:7168
    ds_read_b128 v[112:115], v8 offset:7360
    ds_read_b128 v[116:119], v8 offset:7552
    ds_read_b128 v[120:123], v8 offset:7744
    ds_read_b128 v[124:127], v8 offset:7936
    ds_read_b128 v[128:131], v8 offset:8128
    ds_read_b128 v[132:135], v8 offset:8320
    ds_read_b128 v[136:139], v8 offset:8512
    s_waitcnt lgkmcnt(0)
    ds_read_b128 v[140:143], v8 offset:10240
    ds_read_b128 v[144:147], v8 offset:10432
    ds_read_b128 v[148:151], v8 offset:10624
    ds_read_b128 v[152:155], v8 offset:10816
    ds_read_b128 v[156:159], v8 offset:11008
    ds_read_b128 v[160:163], v8 offset:11200
    ds_read_b128 v[164:167], v8 offset:11392
    ds_read_b128 v[168:171], v8 offset:11584
    s_waitcnt lgkmcnt(0)
    ds_read_b128 v[172:175], v8 offset:13312
    ds_read_b128 v[176:179], v8 offset:13504
    ds_read_b128 v[180:183], v8 offset:13696
    ds_read_b128 v[184:187], v8 offset:13888
    ds_read_b128 v[188:191], v8 offset:14080
    ds_read_b128 v[192:195], v8 offset:14272
    ds_read_b128 v[196:199], v8 offset:14464
    ds_read_b128 v[200:203], v8 offset:14656
    s_waitcnt lgkmcnt(0)
    ds_read_b128 v[204:207], v8 offset:16384
    ds_read_b128 v[208:211], v8 offset:16576
    ds_read_b128 v[212:215], v8 offset:16768
    ds_read_b128 v[216:219], v8 offset:16960
    ds_read_b128 v[220:223], v8 offset:17152
    ds_read_b128 v[224:227], v8 offset:17344
    ds_read_b128 v[228:231], v8 offset:17536
    ds_read_b128 v[232:235], v8 offset:17728
    s_waitcnt lgkmcnt(0)
    v_pk_add_f32 v[108:109], v[108:109], v[112:113]
    v_pk_add_f32 v[110:111], v[110:111], v[114:115]
    v_pk_add_f32 v[116:117], v[116:117], v[120:121]
    v_pk_add_f32 v[118:119], v[118:119], v[122:123]
    v_pk_add_f32 v[124:125], v[124:125], v[128:129]
    v_pk_add_f32 v[126:127], v[126:127], v[130:131]
    v_pk_add_f32 v[132:133], v[132:133], v[136:137]
    v_pk_add_f32 v[134:135], v[134:135], v[138:139]
    v_pk_add_f32 v[140:141], v[140:141], v[144:145]
    v_pk_add_f32 v[142:143], v[142:143], v[146:147]
    v_pk_add_f32 v[148:149], v[148:149], v[152:153]
    v_pk_add_f32 v[150:151], v[150:151], v[154:155]
    v_pk_add_f32 v[156:157], v[156:157], v[160:161]
    v_pk_add_f32 v[158:159], v[158:159], v[162:163]
    v_pk_add_f32 v[164:165], v[164:165], v[168:169]
    v_pk_add_f32 v[166:167], v[166:167], v[170:171]
    v_pk_add_f32 v[172:173], v[172:173], v[176:177]
    v_pk_add_f32 v[174:175], v[174:175], v[178:179]
    v_pk_add_f32 v[180:181], v[180:181], v[184:185]
    v_pk_add_f32 v[182:183], v[182:183], v[186:187]
    v_pk_add_f32 v[188:189], v[188:189], v[192:193]
    v_pk_add_f32 v[190:191], v[190:191], v[194:195]
    v_pk_add_f32 v[196:197], v[196:197], v[200:201]
    v_pk_add_f32 v[198:199], v[198:199], v[202:203]
    v_pk_add_f32 v[204:205], v[204:205], v[208:209]
    v_pk_add_f32 v[206:207], v[206:207], v[210:211]
    v_pk_add_f32 v[212:213], v[212:213], v[216:217]
    v_pk_add_f32 v[214:215], v[214:215], v[218:219]
    v_pk_add_f32 v[220:221], v[220:221], v[224:225]
    v_pk_add_f32 v[222:223], v[222:223], v[226:227]
    v_pk_add_f32 v[228:229], v[228:229], v[232:233]
    v_pk_add_f32 v[230:231], v[230:231], v[234:235]
    v_pk_add_f32 v[108:109], v[108:109], v[116:117]
    v_pk_add_f32 v[110:111], v[110:111], v[118:119]
    v_pk_add_f32 v[124:125], v[124:125], v[132:133]
    v_pk_add_f32 v[126:127], v[126:127], v[134:135]
    v_pk_add_f32 v[140:141], v[140:141], v[148:149]
    v_pk_add_f32 v[142:143], v[142:143], v[150:151]
    v_pk_add_f32 v[156:157], v[156:157], v[164:165]
    v_pk_add_f32 v[158:159], v[158:159], v[166:167]
    v_pk_add_f32 v[172:173], v[172:173], v[180:181]
    v_pk_add_f32 v[174:175], v[174:175], v[182:183]
    v_pk_add_f32 v[188:189], v[188:189], v[196:197]
    v_pk_add_f32 v[190:191], v[190:191], v[198:199]
    v_pk_add_f32 v[204:205], v[204:205], v[212:213]
    v_pk_add_f32 v[206:207], v[206:207], v[214:215]
    v_pk_add_f32 v[220:221], v[220:221], v[228:229]
    v_pk_add_f32 v[222:223], v[222:223], v[230:231]
    v_pk_add_f32 v[108:109], v[108:109], v[124:125]
    v_pk_add_f32 v[110:111], v[110:111], v[126:127]
    v_pk_add_f32 v[140:141], v[140:141], v[156:157]
    v_pk_add_f32 v[142:143], v[142:143], v[158:159]
    v_pk_add_f32 v[172:173], v[172:173], v[188:189]
    v_pk_add_f32 v[174:175], v[174:175], v[190:191]
    v_pk_add_f32 v[204:205], v[204:205], v[220:221]
    v_pk_add_f32 v[206:207], v[206:207], v[222:223]
    v_pk_add_f32 v[108:109], v[108:109], v[140:141]
    v_pk_add_f32 v[110:111], v[110:111], v[142:143]
    v_pk_add_f32 v[172:173], v[172:173], v[204:205]
    v_pk_add_f32 v[174:175], v[174:175], v[206:207]
    v_pk_add_f32 v[108:109], v[108:109], v[172:173]
    v_pk_add_f32 v[110:111], v[110:111], v[174:175]
    v_cmp_gt_u32 vcc, 24, v1
    v_mov_b32 v9, 4194304
    s_nop 0
    v_cndmask_b32 v9, v9, v24, vcc
    s_mul_i32 s70, s3, 384
    s_add_u32 s70, s70, 1048576
    buffer_store_dwordx4 v[108:111], v9, s[56:59], s70 offen sc1
    v_mul_u32_u24 v16, 768, v6
    v_lshl_add_u32 v16, v7, 4, v16
    v_cmp_gt_u32 vcc, 48, v1
    v_mov_b32 v17, 4194304
    s_nop 0
    v_cndmask_b32 v16, v17, v16, vcc
    s_lshl_b32 s70, s61, 3
    s_add_u32 s72, s22, s70
    s_addc_u32 s73, s23, 0
    s_mov_b32 s71, 1
    v_lshlrev_b32 v31, 10, v1
    s_lshl_b32 s70, s61, 13
    s_add_u32 s70, s70, 784
    s_lshl_b32 s66, s3, 10
    s_add_u32 s66, s66, 784
    s_waitcnt vmcnt(0) lgkmcnt(0)
    s_atomic_add s71, s[72:73], 0 glc
    s_waitcnt lgkmcnt(0)
    s_and_b32 s71, s71, 7
    s_cmp_lg_u32 s71, 7
    s_cbranch_scc1 L_qf_wait
    s_mov_b64 exec, 0xff
    buffer_store_dword v3, v31, s[56:59], s70 offen sc1
    s_mov_b64 exec, -1
    s_branch L_qf_done
L_qf_wait:
    s_sleep 12
    s_mov_b32 s74, 0
L_qf_spin:
    buffer_load_dword v18, v3, s[56:59], s66 offen sc1
    s_waitcnt vmcnt(0)
    v_cmp_eq_u32 vcc, -1, v18
    s_cbranch_vccz L_qf_done
    s_add_u32 s74, s74, 1
    s_cmp_ge_u32 s74, s100
    s_cbranch_scc1 L_qf_done
    s_sleep 6
    s_branch L_qf_spin
L_qf_done:
    s_mul_i32 s70, s61, 3072
    s_add_u32 s70, s70, 1048576
    buffer_load_dwordx4 v[108:111], v16, s[56:59], s70 offen offset:0 sc1
    buffer_load_dwordx4 v[140:143], v16, s[56:59], s70 offen offset:192 sc1
    buffer_load_dwordx4 v[112:115], v16, s[56:59], s70 offen offset:384 sc1
    buffer_load_dwordx4 v[144:147], v16, s[56:59], s70 offen offset:576 sc1
    s_waitcnt vmcnt(0)
    v_pk_add_f32 v[108:109], v[108:109], v[112:113]
    v_pk_add_f32 v[110:111], v[110:111], v[114:115]
    v_cvt_pk_bf16_f32 v8, v108, v109
    v_cvt_pk_bf16_f32 v9, v110, v111
    v_pk_add_f32 v[140:141], v[140:141], v[144:145]
    v_pk_add_f32 v[142:143], v[142:143], v[146:147]
    v_cvt_pk_bf16_f32 v10, v140, v141
    v_cvt_pk_bf16_f32 v11, v142, v143
    v_min_u32 v8, -2, v8
    v_min_u32 v9, -2, v9
    v_min_u32 v10, -2, v10
    v_min_u32 v11, -2, v11
    v_lshlrev_b32 v4, 3, v1
    v_cmp_gt_u32 vcc, 48, v1
    s_nop 0
    s_and_saveexec_b64 s[72:73], vcc
    ds_write_b64 v4, v[8:9] offset:128
    ds_write_b64 v4, v[10:11] offset:512
    s_mov_b64 exec, -1
L_q_skip:
    s_mov_b32 s74, 0
L_wt_spin:
    ds_read_b32 v4, v3 offset:28
    s_waitcnt lgkmcnt(0)
    v_cmp_eq_u32 vcc, 0, v4
    s_cbranch_vccz L_wt_done
    s_add_u32 s74, s74, 1
    s_cmp_ge_u32 s74, s100
    s_cbranch_scc1 L_wt_done
    s_sleep 32
    s_branch L_wt_spin
L_wt_done:
    s_cmp_lg_u32 s60, 1
    s_cbranch_scc1 L_all_skip
    v_and_b32 v4, 31, v1
    v_lshlrev_b32 v4, 3, v4
    s_mov_b32 s74, 0
L_all_spin:
    buffer_load_dword v5, v4, s[52:55], 0 offen sc1
    s_waitcnt vmcnt(0)
    v_cmp_gt_u32 vcc, 8, v5
    s_cbranch_vccz L_all_done
    s_add_u32 s74, s74, 1
    s_cmp_ge_u32 s74, s100
    s_cbranch_scc1 L_all_done
    s_sleep 64
    s_branch L_all_spin
L_all_done:
    v_mov_b32 v5, 1
    ds_write_b32 v3, v5 offset:8
L_all_skip:
    s_mul_i32 s69, s60, 12288
    s_add_u32 s69, s69, 27136
    s_cmp_ge_u32 s64, 5
    s_cbranch_scc1 L_wadr_mlp
    s_lshl_b32 s70, s78, 2
    s_add_u32 s70, s70, s60
    s_mul_i32 s70, s70, 192
    s_lshl_b32 s71, s79, 6
    v_lshrrev_b32 v4, 2, v1
    v_and_b32 v5, 3, v1
    v_mul_u32_u24 v6, 43, v4
    v_lshrrev_b32 v6, 7, v6
    v_mul_u32_u24 v7, 3, v6
    v_sub_u32 v7, v4, v7
    v_lshlrev_b32 v7, 6, v7
    v_lshl_add_u32 v7, v6, 3, v7
    v_add_u32 v7, s70, v7
    v_mul_u32_u24 v26, 1280, v7
    v_lshl_add_u32 v26, v5, 4, v26
    v_add_u32 v26, s71, v26
    v_lshrrev_b32 v7, 1, v5
    v_mul_u32_u24 v7, 6, v7
    v_lshrrev_b32 v6, 2, v4
    v_add_u32 v7, v7, v6
    v_lshlrev_b32 v28, 10, v7
    v_and_b32 v6, 3, v4
    v_lshl_add_u32 v28, v6, 8, v28
    v_and_b32 v6, 1, v5
    v_lshl_add_u32 v28, v6, 7, v28
    v_add_u32 v28, s69, v28
    v_lshrrev_b32 v4, 2, v1
    v_add_u32 v4, 16, v4
    v_and_b32 v5, 3, v1
    v_mul_u32_u24 v6, 43, v4
    v_lshrrev_b32 v6, 7, v6
    v_mul_u32_u24 v7, 3, v6
    v_sub_u32 v7, v4, v7
    v_lshlrev_b32 v7, 6, v7
    v_lshl_add_u32 v7, v6, 3, v7
    v_add_u32 v7, s70, v7
    v_mul_u32_u24 v27, 1280, v7
    v_lshl_add_u32 v27, v5, 4, v27
    v_add_u32 v27, s71, v27
    v_lshrrev_b32 v7, 1, v5
    v_mul_u32_u24 v7, 6, v7
    v_lshrrev_b32 v6, 2, v4
    v_add_u32 v7, v7, v6
    v_lshlrev_b32 v29, 10, v7
    v_and_b32 v6, 3, v4
    v_lshl_add_u32 v29, v6, 8, v29
    v_and_b32 v6, 1, v5
    v_lshl_add_u32 v29, v6, 7, v29
    v_add_u32 v29, s69, v29
    s_movk_i32 s72, 64
    s_movk_i32 s73, 32
    s_movk_i32 s66, 1280
    s_branch L_wadr_done
L_wadr_mlp:
    v_lshrrev_b32 v4, 1, v1
    s_mul_i32 s70, s60, 20
    v_add_u32 v4, s70, v4
    v_mul_u32_u24 v26, 24576, v4
    v_and_b32 v5, 1, v1
    v_lshl_add_u32 v26, v5, 4, v26
    s_lshl_b32 s70, s75, 1
    v_add_u32 v26, s70, v26
    v_lshlrev_b32 v28, 7, v1
    v_add_u32 v28, s69, v28
    v_cmp_le_u32 vcc, 20, v1
    s_nop 1
    v_cndmask_b32 v4, 0, 1, vcc
    v_mul_u32_u24 v5, 20, v4
    v_sub_u32 v5, v1, v5
    v_mul_u32_u24 v27, 10240, v4
    v_lshl_add_u32 v27, v5, 4, v27
    s_mul_i32 s70, s75, 1280
    s_mul_i32 s71, s60, 320
    s_add_u32 s70, s70, s71
    v_add_u32 v27, s70, v27
    v_lshrrev_b32 v29, 1, v5
    v_lshlrev_b32 v29, 9, v29
    v_lshl_add_u32 v29, v4, 8, v29
    v_and_b32 v5, 1, v5
    v_lshl_add_u32 v29, v5, 7, v29
    s_add_u32 s70, s69, 6144
    v_add_u32 v29, s70, v29
    s_movk_i32 s72, 40
    s_movk_i32 s73, 40
    s_movk_i32 s66, 3072
L_wadr_done:
    v_cmp_gt_u32 vcc, s72, v1
    s_nop 0
    s_mov_b64 exec, vcc
    buffer_load_dwordx4 v[32:35], v26, s[44:47], 0 offen nt
    s_mul_i32 s70, s66, 1
    buffer_load_dwordx4 v[36:39], v26, s[44:47], s70 offen nt
    s_waitcnt vmcnt(1)
    s_mul_i32 s70, s66, 2
    buffer_load_dwordx4 v[40:43], v26, s[44:47], s70 offen nt
    s_mul_i32 s70, s66, 3
    buffer_load_dwordx4 v[44:47], v26, s[44:47], s70 offen nt
    s_waitcnt vmcnt(1)
    s_mul_i32 s70, s66, 4
    buffer_load_dwordx4 v[48:51], v26, s[44:47], s70 offen nt
    s_mul_i32 s70, s66, 5
    buffer_load_dwordx4 v[52:55], v26, s[44:47], s70 offen nt
    s_waitcnt vmcnt(1)
    s_mul_i32 s70, s66, 6
    buffer_load_dwordx4 v[56:59], v26, s[44:47], s70 offen nt
    s_mul_i32 s70, s66, 7
    buffer_load_dwordx4 v[60:63], v26, s[44:47], s70 offen nt
    s_waitcnt vmcnt(0)
    v_perm_b32 v64, v36, v32, s76
    v_perm_b32 v68, v36, v32, s77
    v_perm_b32 v65, v44, v40, s76
    v_perm_b32 v69, v44, v40, s77
    v_perm_b32 v66, v52, v48, s76
    v_perm_b32 v70, v52, v48, s77
    v_perm_b32 v67, v60, v56, s76
    v_perm_b32 v71, v60, v56, s77
    ds_write_b128 v28, v[64:67] offset:0
    ds_write_b128 v28, v[68:71] offset:16
    v_perm_b32 v72, v37, v33, s76
    v_perm_b32 v76, v37, v33, s77
    v_perm_b32 v73, v45, v41, s76
    v_perm_b32 v77, v45, v41, s77
    v_perm_b32 v74, v53, v49, s76
    v_perm_b32 v78, v53, v49, s77
    v_perm_b32 v75, v61, v57, s76
    v_perm_b32 v79, v61, v57, s77
    ds_write_b128 v28, v[72:75] offset:32
    ds_write_b128 v28, v[76:79] offset:48
    v_perm_b32 v80, v38, v34, s76
    v_perm_b32 v84, v38, v34, s77
    v_perm_b32 v81, v46, v42, s76
    v_perm_b32 v85, v46, v42, s77
    v_perm_b32 v82, v54, v50, s76
    v_perm_b32 v86, v54, v50, s77
    v_perm_b32 v83, v62, v58, s76
    v_perm_b32 v87, v62, v58, s77
    ds_write_b128 v28, v[80:83] offset:64
    ds_write_b128 v28, v[84:87] offset:80
    v_perm_b32 v88, v39, v35, s76
    v_perm_b32 v92, v39, v35, s77
    v_perm_b32 v89, v47, v43, s76
    v_perm_b32 v93, v47, v43, s77
    v_perm_b32 v90, v55, v51, s76
    v_perm_b32 v94, v55, v51, s77
    v_perm_b32 v91, v63, v59, s76
    v_perm_b32 v95, v63, v59, s77
    ds_write_b128 v28, v[88:91] offset:96
    ds_write_b128 v28, v[92:95] offset:112
    s_mov_b64 exec, -1
    s_waitcnt lgkmcnt(0)
    v_cmp_gt_u32 vcc, s73, v1
    s_nop 0
    s_mov_b64 exec, vcc
    buffer_load_dwordx4 v[32:35], v27, s[96:99], 0 offen nt
    s_movk_i32 s70, 1280
    buffer_load_dwordx4 v[36:39], v27, s[96:99], s70 offen nt
    s_waitcnt vmcnt(1)
    s_movk_i32 s70, 2560
    buffer_load_dwordx4 v[40:43], v27, s[96:99], s70 offen nt
    s_movk_i32 s70, 3840
    buffer_load_dwordx4 v[44:47], v27, s[96:99], s70 offen nt
    s_waitcnt vmcnt(1)
    s_movk_i32 s70, 5120
    buffer_load_dwordx4 v[48:51], v27, s[96:99], s70 offen nt
    s_movk_i32 s70, 6400
    buffer_load_dwordx4 v[52:55], v27, s[96:99], s70 offen nt
    s_waitcnt vmcnt(1)
    s_movk_i32 s70, 7680
    buffer_load_dwordx4 v[56:59], v27, s[96:99], s70 offen nt
    s_movk_i32 s70, 8960
    buffer_load_dwordx4 v[60:63], v27, s[96:99], s70 offen nt
    s_waitcnt vmcnt(0)
    v_perm_b32 v64, v36, v32, s76
    v_perm_b32 v68, v36, v32, s77
    v_perm_b32 v65, v44, v40, s76
    v_perm_b32 v69, v44, v40, s77
    v_perm_b32 v66, v52, v48, s76
    v_perm_b32 v70, v52, v48, s77
    v_perm_b32 v67, v60, v56, s76
    v_perm_b32 v71, v60, v56, s77
    ds_write_b128 v29, v[64:67] offset:0
    ds_write_b128 v29, v[68:71] offset:16
    v_perm_b32 v72, v37, v33, s76
    v_perm_b32 v76, v37, v33, s77
    v_perm_b32 v73, v45, v41, s76
    v_perm_b32 v77, v45, v41, s77
    v_perm_b32 v74, v53, v49, s76
    v_perm_b32 v78, v53, v49, s77
    v_perm_b32 v75, v61, v57, s76
    v_perm_b32 v79, v61, v57, s77
    ds_write_b128 v29, v[72:75] offset:32
    ds_write_b128 v29, v[76:79] offset:48
    v_perm_b32 v80, v38, v34, s76
    v_perm_b32 v84, v38, v34, s77
    v_perm_b32 v81, v46, v42, s76
    v_perm_b32 v85, v46, v42, s77
    v_perm_b32 v82, v54, v50, s76
    v_perm_b32 v86, v54, v50, s77
    v_perm_b32 v83, v62, v58, s76
    v_perm_b32 v87, v62, v58, s77
    ds_write_b128 v29, v[80:83] offset:64
    ds_write_b128 v29, v[84:87] offset:80
    v_perm_b32 v88, v39, v35, s76
    v_perm_b32 v92, v39, v35, s77
    v_perm_b32 v89, v47, v43, s76
    v_perm_b32 v93, v47, v43, s77
    v_perm_b32 v90, v55, v51, s76
    v_perm_b32 v94, v55, v51, s77
    v_perm_b32 v91, v63, v59, s76
    v_perm_b32 v95, v63, v59, s77
    ds_write_b128 v29, v[88:91] offset:96
    ds_write_b128 v29, v[92:95] offset:112
    s_mov_b64 exec, -1
    s_waitcnt lgkmcnt(0)
L_stage_done:
    s_cmp_lg_u32 s60, 0
    s_cbranch_scc1 L_ml_skip
    v_lshlrev_b32 v31, 10, v21
    s_mov_b32 s74, 0
L_ml10_spin:
    ds_read_b128 v[4:7], v3 offset:64
    ds_read_b128 v[8:11], v3 offset:80
    ds_read_b32 v12, v3 offset:20
    s_waitcnt lgkmcnt(0)
    v_max3_u32 v13, v4, v5, v6
    v_max3_u32 v13, v13, v7, v8
    v_max3_u32 v13, v13, v9, v10
    v_max3_u32 v13, v13, v11, v12
    v_cmp_eq_u32 vcc, -1, v13
    s_cbranch_vccz L_ml10_done
    s_add_u32 s74, s74, 1
    s_cmp_ge_u32 s74, s100
    s_cbranch_scc1 L_ml10_done
    s_sleep 32
    s_branch L_ml10_spin
L_ml10_done:
    v_max3_f32 v12, v4, v6, v8
    v_max_f32 v12, v12, v10
    v_sub_f32 v14, v4, v12
    v_mul_f32 v14, 0x3fb8aa3b, v14
    v_exp_f32 v14, v14
    v_sub_f32 v15, v6, v12
    v_mul_f32 v15, 0x3fb8aa3b, v15
    v_exp_f32 v15, v15
    v_sub_f32 v16, v8, v12
    v_mul_f32 v16, 0x3fb8aa3b, v16
    v_exp_f32 v16, v16
    v_sub_f32 v17, v10, v12
    v_mul_f32 v17, 0x3fb8aa3b, v17
    v_exp_f32 v17, v17
    v_mul_f32 v13, v14, v5
    v_fmac_f32 v13, v15, v7
    v_fmac_f32 v13, v16, v9
    v_fmac_f32 v13, v17, v11
    s_lshl_b32 s70, s3, 10
    s_add_u32 s70, s70, 768
    s_mov_b64 exec, 1
    buffer_store_dwordx2 v[12:13], v3, s[56:59], s70 offen sc1
    s_mov_b64 exec, -1
    s_lshl_b32 s70, s61, 13
    s_add_u32 s70, s70, 768
    s_sleep 64
    s_mov_b32 s74, 0
L_ml20_spin:
    s_mov_b64 exec, 0xff
    buffer_load_dwordx2 v[12:13], v31, s[56:59], s70 offen sc1
    s_waitcnt vmcnt(0)
    v_max_u32 v14, v12, v13
    v_cmp_eq_u32 vcc, -1, v14
    s_cbranch_vccz L_ml20_done
    s_add_u32 s74, s74, 1
    s_cmp_ge_u32 s74, s100
    s_cbranch_scc1 L_ml20_done
    s_sleep 100
    s_branch L_ml20_spin
L_ml20_done:
    v_mov_b32 v14, v12
    s_nop 1
    v_max_f32_dpp v14, v14, v14 quad_perm:[1,0,3,2] row_mask:0xf bank_mask:0xf
    s_nop 1
    v_max_f32_dpp v14, v14, v14 quad_perm:[2,3,0,1] row_mask:0xf bank_mask:0xf
    s_nop 1
    v_max_f32_dpp v14, v14, v14 row_half_mirror row_mask:0xf bank_mask:0xf
    v_sub_f32 v12, v12, v14
    v_mul_f32 v12, 0x3fb8aa3b, v12
    v_exp_f32 v12, v12
    s_nop 0
    v_mul_f32 v13, v13, v12
    s_nop 1
    v_add_f32_dpp v13, v13, v13 quad_perm:[1,0,3,2] row_mask:0xf bank_mask:0xf
    s_nop 1
    v_add_f32_dpp v13, v13, v13 quad_perm:[2,3,0,1] row_mask:0xf bank_mask:0xf
    s_nop 1
    v_add_f32_dpp v13, v13, v13 row_half_mirror row_mask:0xf bank_mask:0xf
    v_rcp_f32 v13, v13
    v_sub_f32 v16, v4, v14
    v_mul_f32 v16, 0x3fb8aa3b, v16
    v_exp_f32 v16, v16
    s_nop 0
    v_mul_f32 v16, v16, v13
    v_min_u32 v16, -2, v16
    v_sub_f32 v17, v6, v14
    v_mul_f32 v17, 0x3fb8aa3b, v17
    v_exp_f32 v17, v17
    s_nop 0
    v_mul_f32 v17, v17, v13
    v_min_u32 v17, -2, v17
    v_sub_f32 v18, v8, v14
    v_mul_f32 v18, 0x3fb8aa3b, v18
    v_exp_f32 v18, v18
    s_nop 0
    v_mul_f32 v18, v18, v13
    v_min_u32 v18, -2, v18
    v_sub_f32 v19, v10, v14
    v_mul_f32 v19, 0x3fb8aa3b, v19
    v_exp_f32 v19, v19
    s_nop 0
    v_mul_f32 v19, v19, v13
    v_min_u32 v19, -2, v19
    s_mov_b64 exec, 1
    ds_write_b128 v3, v[16:19] offset:32
    s_mov_b64 exec, -1
    s_mov_b32 s74, 0
L_ml11_spin:
    ds_read_b128 v[4:7], v3 offset:96
    ds_read_b128 v[8:11], v3 offset:112
    ds_read_b32 v12, v3 offset:20
    s_waitcnt lgkmcnt(0)
    v_subrev_u32 v12, 1, v12
    v_max3_u32 v13, v4, v5, v6
    v_max3_u32 v13, v13, v7, v8
    v_max3_u32 v13, v13, v9, v10
    v_max3_u32 v13, v13, v11, v12
    v_cmp_eq_u32 vcc, -1, v13
    s_cbranch_vccz L_ml11_done
    s_add_u32 s74, s74, 1
    s_cmp_ge_u32 s74, s100
    s_cbranch_scc1 L_ml11_done
    s_sleep 32
    s_branch L_ml11_spin
L_ml11_done:
    v_max3_f32 v12, v4, v6, v8
    v_max_f32 v12, v12, v10
    v_sub_f32 v14, v4, v12
    v_mul_f32 v14, 0x3fb8aa3b, v14
    v_exp_f32 v14, v14
    v_sub_f32 v15, v6, v12
    v_mul_f32 v15, 0x3fb8aa3b, v15
    v_exp_f32 v15, v15
    v_sub_f32 v16, v8, v12
    v_mul_f32 v16, 0x3fb8aa3b, v16
    v_exp_f32 v16, v16
    v_sub_f32 v17, v10, v12
    v_mul_f32 v17, 0x3fb8aa3b, v17
    v_exp_f32 v17, v17
    v_mul_f32 v13, v14, v5
    v_fmac_f32 v13, v15, v7
    v_fmac_f32 v13, v16, v9
    v_fmac_f32 v13, v17, v11
    s_lshl_b32 s70, s3, 10
    s_add_u32 s70, s70, 776
    s_mov_b64 exec, 1
    buffer_store_dwordx2 v[12:13], v3, s[56:59], s70 offen sc1
    s_mov_b64 exec, -1
    s_lshl_b32 s70, s61, 13
    s_add_u32 s70, s70, 776
    s_sleep 64
    s_mov_b32 s74, 0
L_ml21_spin:
    s_mov_b64 exec, 0xff
    buffer_load_dwordx2 v[12:13], v31, s[56:59], s70 offen sc1
    s_waitcnt vmcnt(0)
    v_max_u32 v14, v12, v13
    v_cmp_eq_u32 vcc, -1, v14
    s_cbranch_vccz L_ml21_done
    s_add_u32 s74, s74, 1
    s_cmp_ge_u32 s74, s100
    s_cbranch_scc1 L_ml21_done
    s_sleep 100
    s_branch L_ml21_spin
L_ml21_done:
    v_mov_b32 v14, v12
    s_nop 1
    v_max_f32_dpp v14, v14, v14 quad_perm:[1,0,3,2] row_mask:0xf bank_mask:0xf
    s_nop 1
    v_max_f32_dpp v14, v14, v14 quad_perm:[2,3,0,1] row_mask:0xf bank_mask:0xf
    s_nop 1
    v_max_f32_dpp v14, v14, v14 row_half_mirror row_mask:0xf bank_mask:0xf
    v_sub_f32 v12, v12, v14
    v_mul_f32 v12, 0x3fb8aa3b, v12
    v_exp_f32 v12, v12
    s_nop 0
    v_mul_f32 v13, v13, v12
    s_nop 1
    v_add_f32_dpp v13, v13, v13 quad_perm:[1,0,3,2] row_mask:0xf bank_mask:0xf
    s_nop 1
    v_add_f32_dpp v13, v13, v13 quad_perm:[2,3,0,1] row_mask:0xf bank_mask:0xf
    s_nop 1
    v_add_f32_dpp v13, v13, v13 row_half_mirror row_mask:0xf bank_mask:0xf
    v_rcp_f32 v13, v13
    v_sub_f32 v16, v4, v14
    v_mul_f32 v16, 0x3fb8aa3b, v16
    v_exp_f32 v16, v16
    s_nop 0
    v_mul_f32 v16, v16, v13
    v_min_u32 v16, -2, v16
    v_sub_f32 v17, v6, v14
    v_mul_f32 v17, 0x3fb8aa3b, v17
    v_exp_f32 v17, v17
    s_nop 0
    v_mul_f32 v17, v17, v13
    v_min_u32 v17, -2, v17
    v_sub_f32 v18, v8, v14
    v_mul_f32 v18, 0x3fb8aa3b, v18
    v_exp_f32 v18, v18
    s_nop 0
    v_mul_f32 v18, v18, v13
    v_min_u32 v18, -2, v18
    v_sub_f32 v19, v10, v14
    v_mul_f32 v19, 0x3fb8aa3b, v19
    v_exp_f32 v19, v19
    s_nop 0
    v_mul_f32 v19, v19, v13
    v_min_u32 v19, -2, v19
    s_mov_b64 exec, 1
    ds_write_b128 v3, v[16:19] offset:48
    s_mov_b64 exec, -1
L_ml_skip:
    v_and_b32 v26, 15, v1
    v_lshrrev_b32 v27, 4, v1
    v_add_u32 v4, s69, v24
    s_cmp_ge_u32 s64, 5
    s_cbranch_scc1 L_mlp
    ds_read_b128 v[128:131], v4 offset:0
    ds_read_b128 v[132:135], v4 offset:1024
    ds_read_b128 v[136:139], v4 offset:2048
    ds_read_b128 v[140:143], v4 offset:3072
    ds_read_b128 v[144:147], v4 offset:4096
    ds_read_b128 v[148:151], v4 offset:5120
    ds_read_b128 v[152:155], v4 offset:6144
    ds_read_b128 v[156:159], v4 offset:7168
    ds_read_b128 v[160:163], v4 offset:8192
    ds_read_b128 v[164:167], v4 offset:9216
    ds_read_b128 v[168:171], v4 offset:10240
    ds_read_b128 v[172:175], v4 offset:11264
    s_mul_i32 s71, s60, 768
    v_lshlrev_b32 v28, 3, v1
    v_add_u32 v28, s71, v28
    v_and_b32 v5, 1, v26
    v_mul_u32_u24 v29, 384, v5
    v_lshl_add_u32 v29, v27, 4, v29
    v_add_u32 v29, s71, v29
    v_lshlrev_b32 v31, 7, v5
    v_lshl_add_u32 v31, v27, 4, v31
    s_lshl_b32 s71, s60, 8
    v_add_u32 v31, s71, v31
    v_mov_b32 v96, 768
    v_and_b32 v97, 1, v1
    v_lshlrev_b32 v97, 2, v97
    v_lshrrev_b32 v5, 5, v1
    v_lshl_add_u32 v97, v5, 1, v97
    v_bfe_u32 v5, v1, 4, 1
    v_add_u32 v97, v97, v5
    s_lshl_b32 s70, s68, 3
    v_add_u32 v97, s70, v97
    v_lshlrev_b32 v98, 1, v97
    buffer_load_ushort v99, v98, s[28:31], 0 offen
    v_bfe_u32 v7, v1, 1, 3
    v_mul_u32_u24 v100, 5120, v7
    v_lshl_add_u32 v100, v97, 2, v100
    v_cmp_ne_u32 vcc, 0, v7
    v_mov_b32 v7, 4194304
    s_waitcnt vmcnt(0) lgkmcnt(0)
    v_cndmask_b32 v98, v98, v7, vcc
    v_lshlrev_b32 v99, 16, v99
    s_lshl_b32 s70, s78, 2
    s_add_u32 s70, s70, s60
    s_lshl_b32 s66, s70, 13
    s_mov_b32 s74, 0
L_mid_spin:
    ds_read_b32 v4, v3 offset:48
    ds_read_b32 v5, v3 offset:8
    s_waitcnt lgkmcnt(0)
    v_subrev_u32 v5, 1, v5
    v_max_u32 v4, v4, v5
    v_cmp_eq_u32 vcc, -1, v4
    s_cbranch_vccz L_mid_done
    s_add_u32 s74, s74, 1
    s_cmp_ge_u32 s74, s100
    s_cbranch_scc1 L_mid_done
    s_sleep 32
    s_branch L_mid_spin
L_mid_done:
    v_lshlrev_b32 v6, 10, v21
    s_add_u32 s70, s66, 776
    s_mov_b32 s74, 0
L_p0_spin:
    s_mov_b64 exec, 0xff
    buffer_load_dword v4, v6, s[56:59], s70 offen sc1
    s_waitcnt vmcnt(0)
    v_cmp_eq_u32 vcc, -1, v4
    s_cbranch_vccz L_p0_done
    s_add_u32 s74, s74, 1
    s_cmp_ge_u32 s74, s100
    s_cbranch_scc1 L_p0_done
    s_sleep 100
    s_branch L_p0_spin
L_p0_done:
    s_mov_b64 exec, -1
    s_add_u32 s70, s66, 1572864
    s_add_u32 s71, s70, 4096
    s_mov_b32 s26, 0
    s_mov_b32 s27, 0
    s_mov_b32 s100, 1048576
    s_mov_b64 exec, -1
    s_waitcnt vmcnt(0) lgkmcnt(0)
    s_mov_b32 s74, 0
L_wo_wait0:
    ds_read_b32 v4, v3 offset:12
    s_waitcnt lgkmcnt(0)
    v_cmp_eq_u32 vcc, 0, v4
    s_cbranch_vccz L_wo_wait0_done
    s_add_u32 s74, s74, 1
    s_cmp_ge_u32 s74, s100
    s_cbranch_scc1 L_wo_wait0_done
    s_sleep 2
    s_branch L_wo_wait0
L_wo_wait0_done:
    buffer_load_dwordx4 v[208:211], v30, s[56:59], s70 offen offset:0 sc1
    buffer_load_dwordx4 v[212:215], v30, s[56:59], s70 offen offset:1024 sc1
    buffer_load_dwordx4 v[216:219], v30, s[56:59], s70 offen offset:2048 sc1
    buffer_load_dwordx4 v[220:223], v30, s[56:59], s70 offen offset:3072 sc1
    buffer_load_dwordx4 v[224:227], v30, s[56:59], s71 offen offset:0 sc1
    buffer_load_dwordx4 v[228:231], v30, s[56:59], s71 offen offset:1024 sc1
    buffer_load_dwordx4 v[232:235], v30, s[56:59], s71 offen offset:2048 sc1
    buffer_load_dwordx4 v[236:239], v30, s[56:59], s71 offen offset:3072 sc1
    s_mov_b32 s70, s66
    s_add_u32 s71, s70, 4096
    buffer_load_dwordx4 v[32:35], v30, s[56:59], s70 offen offset:0 sc1
    buffer_load_dwordx4 v[36:39], v30, s[56:59], s70 offen offset:1024 sc1
    buffer_load_dwordx4 v[40:43], v30, s[56:59], s70 offen offset:2048 sc1
    buffer_load_dwordx4 v[44:47], v30, s[56:59], s70 offen offset:3072 sc1
    buffer_load_dwordx4 v[48:51], v30, s[56:59], s71 offen offset:0 sc1
    buffer_load_dwordx4 v[52:55], v30, s[56:59], s71 offen offset:1024 sc1
    buffer_load_dwordx4 v[56:59], v30, s[56:59], s71 offen offset:2048 sc1
    buffer_load_dwordx4 v[60:63], v30, s[56:59], s71 offen offset:3072 sc1
    s_waitcnt vmcnt(8)
    v_pk_add_f32 v[208:209], v[208:209], v[212:213]
    v_pk_add_f32 v[210:211], v[210:211], v[214:215]
    v_pk_add_f32 v[216:217], v[216:217], v[220:221]
    v_pk_add_f32 v[218:219], v[218:219], v[222:223]
    v_pk_add_f32 v[224:225], v[224:225], v[228:229]
    v_pk_add_f32 v[226:227], v[226:227], v[230:231]
    v_pk_add_f32 v[232:233], v[232:233], v[236:237]
    v_pk_add_f32 v[234:235], v[234:235], v[238:239]
    v_pk_add_f32 v[208:209], v[208:209], v[216:217]
    v_pk_add_f32 v[210:211], v[210:211], v[218:219]
    v_pk_add_f32 v[224:225], v[224:225], v[232:233]
    v_pk_add_f32 v[226:227], v[226:227], v[234:235]
    v_pk_add_f32 v[12:13], v[208:209], v[224:225]
    v_pk_add_f32 v[14:15], v[210:211], v[226:227]
    v_cvt_pk_bf16_f32 v8, v12, v13
    v_cvt_pk_bf16_f32 v9, v14, v15
    s_mov_b32 exec_hi, 0xffff
    ds_write_b64 v28, v[8:9] offset:19712
    s_mov_b64 exec, -1
    s_waitcnt vmcnt(0)
    v_pk_add_f32 v[32:33], v[32:33], v[36:37]
    v_pk_add_f32 v[34:35], v[34:35], v[38:39]
    v_pk_add_f32 v[40:41], v[40:41], v[44:45]
    v_pk_add_f32 v[42:43], v[42:43], v[46:47]
    v_pk_add_f32 v[48:49], v[48:49], v[52:53]
    v_pk_add_f32 v[50:51], v[50:51], v[54:55]
    v_pk_add_f32 v[56:57], v[56:57], v[60:61]
    v_pk_add_f32 v[58:59], v[58:59], v[62:63]
    v_pk_add_f32 v[32:33], v[32:33], v[40:41]
    v_pk_add_f32 v[34:35], v[34:35], v[42:43]
    v_pk_add_f32 v[48:49], v[48:49], v[56:57]
    v_pk_add_f32 v[50:51], v[50:51], v[58:59]
    v_pk_add_f32 v[12:13], v[32:33], v[48:49]
    v_pk_add_f32 v[14:15], v[34:35], v[50:51]
    v_pk_add_f32 v[4:5], v[12:13], v[14:15]
    v_cmp_u_f32 vcc, v4, v5
    s_cbranch_vccz L_a_ok
    s_mov_b32 s74, 0
L_a_spin:
    buffer_load_dwordx4 v[32:35], v30, s[56:59], s70 offen offset:0 sc1
    buffer_load_dwordx4 v[36:39], v30, s[56:59], s70 offen offset:1024 sc1
    buffer_load_dwordx4 v[40:43], v30, s[56:59], s70 offen offset:2048 sc1
    buffer_load_dwordx4 v[44:47], v30, s[56:59], s70 offen offset:3072 sc1
    buffer_load_dwordx4 v[48:51], v30, s[56:59], s71 offen offset:0 sc1
    buffer_load_dwordx4 v[52:55], v30, s[56:59], s71 offen offset:1024 sc1
    buffer_load_dwordx4 v[56:59], v30, s[56:59], s71 offen offset:2048 sc1
    buffer_load_dwordx4 v[60:63], v30, s[56:59], s71 offen offset:3072 sc1
    s_waitcnt vmcnt(0)
    v_pk_add_f32 v[32:33], v[32:33], v[36:37]
    v_pk_add_f32 v[34:35], v[34:35], v[38:39]
    v_pk_add_f32 v[40:41], v[40:41], v[44:45]
    v_pk_add_f32 v[42:43], v[42:43], v[46:47]
    v_pk_add_f32 v[48:49], v[48:49], v[52:53]
    v_pk_add_f32 v[50:51], v[50:51], v[54:55]
    v_pk_add_f32 v[56:57], v[56:57], v[60:61]
    v_pk_add_f32 v[58:59], v[58:59], v[62:63]
    v_pk_add_f32 v[32:33], v[32:33], v[40:41]
    v_pk_add_f32 v[34:35], v[34:35], v[42:43]
    v_pk_add_f32 v[48:49], v[48:49], v[56:57]
    v_pk_add_f32 v[50:51], v[50:51], v[58:59]
    v_pk_add_f32 v[12:13], v[32:33], v[48:49]
    v_pk_add_f32 v[14:15], v[34:35], v[50:51]
    v_pk_add_f32 v[4:5], v[12:13], v[14:15]
    v_cmp_u_f32 vcc, v4, v5
    s_cbranch_vccz L_a_ok
    s_add_u32 s74, s74, 1
    s_cmp_ge_u32 s74, s100
    s_cbranch_scc1 L_a_ok
    s_sleep 1
    s_branch L_a_spin
L_a_ok:
    v_cvt_pk_bf16_f32 v8, v12, v13
    v_cvt_pk_bf16_f32 v9, v14, v15
    s_mov_b32 exec_hi, 0xffff
    ds_write_b64 v28, v[8:9] offset:20096
    s_mov_b64 exec, -1
    ds_read_b128 v[180:183], v29 offset:19712
    ds_read_b128 v[184:187], v29 offset:19776
    ds_read_b128 v[188:191], v29 offset:19840
    ds_read_b128 v[192:195], v29 offset:19904
    ds_read_b128 v[196:199], v29 offset:19968
    ds_read_b128 v[200:203], v29 offset:20032
    s_waitcnt lgkmcnt(5)
    v_mfma_f32_16x16x32_bf16 v[12:15], v[128:131], v[180:183], 0
    v_mfma_f32_16x16x32_bf16 v[16:19], v[152:155], v[180:183], 0
    s_waitcnt lgkmcnt(4)
    v_mfma_f32_16x16x32_bf16 v[12:15], v[132:135], v[184:187], v[12:15]
    v_mfma_f32_16x16x32_bf16 v[16:19], v[156:159], v[184:187], v[16:19]
    s_waitcnt lgkmcnt(3)
    v_mfma_f32_16x16x32_bf16 v[12:15], v[136:139], v[188:191], v[12:15]
    v_mfma_f32_16x16x32_bf16 v[16:19], v[160:163], v[188:191], v[16:19]
    s_waitcnt lgkmcnt(2)
    v_mfma_f32_16x16x32_bf16 v[12:15], v[140:143], v[192:195], v[12:15]
    v_mfma_f32_16x16x32_bf16 v[16:19], v[164:167], v[192:195], v[16:19]
    s_waitcnt lgkmcnt(1)
    v_mfma_f32_16x16x32_bf16 v[12:15], v[144:147], v[196:199], v[12:15]
    v_mfma_f32_16x16x32_bf16 v[16:19], v[168:171], v[196:199], v[16:19]
    s_waitcnt lgkmcnt(0)
    v_mfma_f32_16x16x32_bf16 v[12:15], v[148:151], v[200:203], v[12:15]
    v_mfma_f32_16x16x32_bf16 v[16:19], v[172:175], v[200:203], v[16:19]
    s_mov_b32 exec_lo, 0x00030003
    s_mov_b32 exec_hi, 0x00030003
    s_nop 4
    ds_write_b128 v31, v[12:15] offset:22784
    ds_write_b128 v31, v[16:19] offset:22848
    s_mov_b64 exec, -1
    s_waitcnt lgkmcnt(0)
    s_barrier
    s_cmp_lg_u32 s60, 0
    s_cbranch_scc1 L_wo_exit
    v_lshlrev_b32 v4, 4, v26
    ds_read_b128 v[64:67], v4 offset:22784
    ds_read_b128 v[68:71], v4 offset:23040
    ds_read_b128 v[72:75], v4 offset:23296
    ds_read_b128 v[76:79], v4 offset:23552
    s_waitcnt lgkmcnt(0)
    v_pk_add_f32 v[64:65], v[64:65], v[68:69]
    v_pk_add_f32 v[72:73], v[72:73], v[76:77]
    v_pk_add_f32 v[66:67], v[66:67], v[70:71]
    v_pk_add_f32 v[74:75], v[74:75], v[78:79]
    v_pk_add_f32 v[64:65], v[64:65], v[72:73]
    v_pk_add_f32 v[66:67], v[66:67], v[74:75]
    buffer_store_dwordx4 v[64:67], v25, s[56:59], s27 offen sc1
    s_mov_b32 s70, 262144
    s_mov_b32 s74, 0
L_b_spin:
    buffer_load_dword v80, v100, s[56:59], s70 offen sc1
    s_waitcnt vmcnt(0)
    v_cmp_eq_u32 vcc, -1, v80
    s_cbranch_vccz L_b_done
    s_add_u32 s74, s74, 1
    s_cmp_ge_u32 s74, s100
    s_cbranch_scc1 L_b_done
    s_sleep 4
    s_branch L_b_spin
L_b_done:
    v_add_f32_dpp v80, v80, v80 quad_perm:[2,3,0,1] row_mask:0xf bank_mask:0xf
    v_mov_b32 v10, v80
    s_nop 1
    v_add_f32_dpp v80, v10, v10 row_shr:4 row_mask:0xf bank_mask:0xa
    s_nop 1
    v_add_f32_dpp v80, v10, v10 row_shl:4 row_mask:0xf bank_mask:0x5
    s_nop 1
    v_add_f32_dpp v80, v80, v80 row_ror:8 row_mask:0xf bank_mask:0xf
    v_cvt_pk_bf16_f32 v80, v80, v80
    v_lshlrev_b32 v80, 16, v80
    v_add_f32 v80, v99, v80
    v_cvt_pk_bf16_f32 v80, v80, v80
    v_lshlrev_b32 v80, 16, v80
    s_lshr_b32 s70, s68, 1
    s_mul_i32 s70, s70, 6144
    s_and_b32 s71, s68, 1
    s_lshl_b32 s71, s71, 5
    s_add_u32 s70, s70, s71
    s_add_u32 s70, s70, 458752
    s_add_u32 s71, s70, 4096
    v_lshrrev_b32 v12, 1, v1
    v_lshlrev_b32 v12, 6, v12
    v_and_b32 v13, 1, v1
    v_lshl_add_u32 v12, v13, 4, v12
    s_mov_b32 s74, 0
L_c_spin:
    buffer_load_dwordx4 v[32:35], v12, s[56:59], s70 offen offset:0 sc1
    buffer_load_dwordx4 v[36:39], v12, s[56:59], s70 offen offset:2048 sc1
    buffer_load_dwordx4 v[40:43], v12, s[56:59], s71 offen offset:0 sc1
    s_waitcnt vmcnt(0)
    v_pk_add_f32 v[84:85], v[32:33], v[36:37]
    v_pk_add_f32 v[84:85], v[84:85], v[40:41]
    v_pk_add_f32 v[86:87], v[34:35], v[38:39]
    v_pk_add_f32 v[86:87], v[86:87], v[42:43]
    v_pk_add_f32 v[4:5], v[84:85], v[86:87]
    v_cmp_u_f32 vcc, v4, v5
    s_cbranch_vccz L_c_ok
    s_add_u32 s74, s74, 1
    s_cmp_ge_u32 s74, s100
    s_cbranch_scc1 L_c_ok
    s_sleep 1
    s_branch L_c_spin
L_c_ok:
    v_permlane32_swap_b32 v84, v86
    v_permlane32_swap_b32 v85, v87
    v_add_f32 v84, v84, v86
    v_add_f32 v85, v85, v87
    s_nop 1
    v_permlane16_swap_b32 v84, v85
    v_add_f32 v84, v84, v85
    s_nop 1
    v_add_f32_dpp v84, v84, v84 row_ror:8 row_mask:0xf bank_mask:0xf
    s_nop 1
    v_add_f32_dpp v84, v84, v84 row_ror:4 row_mask:0xf bank_mask:0xf
    s_nop 1
    v_add_f32_dpp v84, v84, v84 row_ror:2 row_mask:0xf bank_mask:0xf
    v_cvt_pk_bf16_f32 v84, v84, v84
    v_lshlrev_b32 v84, 16, v84
    v_add_f32 v84, v84, v80
    v_cvt_pk_bf16_f32 v84, v84, v84
    buffer_store_short v84, v98, s[48:51], s27 offen
L_wo_exit:
    s_branch L_fin
L_mlp:
    v_mov_b32 v176, v4
    v_lshrrev_b32 v177, 1, v27
    v_lshlrev_b32 v177, 8, v177
    v_lshl_add_u32 v177, v26, 4, v177
    v_and_b32 v8, 1, v27
    v_lshl_add_u32 v177, v8, 3, v177
    v_add_u32 v177, s69, v177
    ds_read_b128 v[128:131], v176 offset:0
    ds_read_b128 v[132:135], v176 offset:1024
    ds_read_b128 v[136:139], v176 offset:2048
    ds_read_b128 v[140:143], v176 offset:3072
    ds_read_b128 v[144:147], v176 offset:4096
    ds_read_b64 v[152:153], v177 offset:6144
    ds_read_b64 v[154:155], v177 offset:6656
    ds_read_b64 v[156:157], v177 offset:7168
    ds_read_b64 v[158:159], v177 offset:7680
    ds_read_b64 v[160:161], v177 offset:8192
    ds_read_b64 v[162:163], v177 offset:8704
    ds_read_b64 v[164:165], v177 offset:9216
    ds_read_b64 v[166:167], v177 offset:9728
    ds_read_b64 v[168:169], v177 offset:10240
    ds_read_b64 v[170:171], v177 offset:10752
    s_mul_i32 s70, s60, 640
    v_add_u32 v28, s70, v24
    v_cmp_gt_u32 vcc, 40, v1
    v_mov_b32 v5, 4194304
    s_nop 0
    v_cndmask_b32 v28, v5, v28, vcc
    v_cmp_eq_u32 vcc, 40, v1
    s_nop 1
    v_cndmask_b32 v28, v28, v3, vcc
    v_lshrrev_b32 v5, 1, v28
    buffer_load_dwordx2 v[12:13], v5, s[28:31], 0 offen
    buffer_load_dwordx2 v[14:15], v5, s[28:31], 0 offen offset:1280
    s_mul_i32 s70, s60, 640
    s_add_u32 s70, s70, 24064
    v_lshlrev_b32 v29, 3, v1
    v_add_u32 v29, s70, v29
    v_and_b32 v8, 1, v26
    v_mul_u32_u24 v31, 320, v8
    v_lshl_add_u32 v31, v27, 4, v31
    v_add_u32 v31, s70, v31
    v_lshlrev_b32 v99, 6, v8
    v_lshl_add_u32 v99, v27, 4, v99
    s_lshl_b32 s70, s60, 7
    v_add_u32 v98, s70, v99
    v_mul_u32_u24 v96, 245760, v26
    v_lshl_add_u32 v96, v27, 4, v96
    s_mul_i32 s70, s60, 61440
    s_lshl_b32 s71, s75, 2
    s_add_u32 s70, s70, s71
    s_add_u32 s70, s70, 458752
    v_add_u32 v96, s70, v96
    v_cmp_lt_u32 vcc, 1, v26
    v_mov_b32 v8, 4194304
    s_nop 0
    v_cndmask_b32 v96, v96, v8, vcc
    v_lshlrev_b32 v97, 2, v27
    s_lshl_b32 s70, s60, 4
    v_add_u32 v97, s70, v97
    s_waitcnt vmcnt(0) lgkmcnt(0)
    v_lshlrev_b32 v100, 16, v12
    v_and_b32 v101, s67, v12
    v_lshlrev_b32 v102, 16, v13
    v_and_b32 v103, s67, v13
    v_lshlrev_b32 v104, 16, v14
    v_and_b32 v105, s67, v14
    v_lshlrev_b32 v106, 16, v15
    v_and_b32 v107, s67, v15
    s_mov_b32 s74, 0
L_mid2_spin:
    ds_read_b32 v4, v3 offset:48
    s_waitcnt lgkmcnt(0)
    v_cmp_eq_u32 vcc, -1, v4
    s_cbranch_vccz L_mid2_done
    s_add_u32 s74, s74, 1
    s_cmp_ge_u32 s74, s100
    s_cbranch_scc1 L_mid2_done
    s_sleep 32
    s_branch L_mid2_spin
L_mid2_done:
    s_mov_b32 s26, 0
    s_mov_b32 s27, 0
    s_mov_b32 s100, 1048576
    s_mov_b64 exec, -1
    s_waitcnt vmcnt(0) lgkmcnt(0)
    s_mov_b32 s74, 0
L_mlp_wait0:
    ds_read_b32 v4, v3 offset:12
    s_waitcnt lgkmcnt(0)
    v_cmp_eq_u32 vcc, 0, v4
    s_cbranch_vccz L_mlp_wait0_done
    s_add_u32 s74, s74, 1
    s_cmp_ge_u32 s74, s100
    s_cbranch_scc1 L_mlp_wait0_done
    s_sleep 2
    s_branch L_mlp_wait0
L_mlp_wait0_done:
L_mlp_tail:
    s_mov_b32 s74, 0
L_h_spin:
    s_mov_b32 s70, 262144
    buffer_load_dwordx4 v[32:35], v28, s[56:59], s70 offen offset:0 sc1
    buffer_load_dwordx4 v[36:39], v28, s[56:59], s70 offen offset:2560 sc1
    s_mov_b32 s70, 267264
    buffer_load_dwordx4 v[40:43], v28, s[56:59], s70 offen offset:0 sc1
    buffer_load_dwordx4 v[44:47], v28, s[56:59], s70 offen offset:2560 sc1
    s_mov_b32 s70, 272384
    buffer_load_dwordx4 v[48:51], v28, s[56:59], s70 offen offset:0 sc1
    buffer_load_dwordx4 v[52:55], v28, s[56:59], s70 offen offset:2560 sc1
    s_mov_b32 s70, 277504
    buffer_load_dwordx4 v[56:59], v28, s[56:59], s70 offen offset:0 sc1
    buffer_load_dwordx4 v[60:63], v28, s[56:59], s70 offen offset:2560 sc1
    s_mov_b32 s70, 282624
    buffer_load_dwordx4 v[64:67], v28, s[56:59], s70 offen offset:0 sc1
    buffer_load_dwordx4 v[68:71], v28, s[56:59], s70 offen offset:2560 sc1
    s_mov_b32 s70, 287744
    buffer_load_dwordx4 v[72:75], v28, s[56:59], s70 offen offset:0 sc1
    buffer_load_dwordx4 v[76:79], v28, s[56:59], s70 offen offset:2560 sc1
    s_mov_b32 s70, 292864
    buffer_load_dwordx4 v[80:83], v28, s[56:59], s70 offen offset:0 sc1
    buffer_load_dwordx4 v[84:87], v28, s[56:59], s70 offen offset:2560 sc1
    s_mov_b32 s70, 297984
    buffer_load_dwordx4 v[88:91], v28, s[56:59], s70 offen offset:0 sc1
    buffer_load_dwordx4 v[92:95], v28, s[56:59], s70 offen offset:2560 sc1
    s_waitcnt vmcnt(0)
    v_pk_add_f32 v[32:33], v[32:33], v[40:41]
    v_pk_add_f32 v[34:35], v[34:35], v[42:43]
    v_pk_add_f32 v[36:37], v[36:37], v[44:45]
    v_pk_add_f32 v[38:39], v[38:39], v[46:47]
    v_pk_add_f32 v[48:49], v[48:49], v[56:57]
    v_pk_add_f32 v[50:51], v[50:51], v[58:59]
    v_pk_add_f32 v[52:53], v[52:53], v[60:61]
    v_pk_add_f32 v[54:55], v[54:55], v[62:63]
    v_pk_add_f32 v[64:65], v[64:65], v[72:73]
    v_pk_add_f32 v[66:67], v[66:67], v[74:75]
    v_pk_add_f32 v[68:69], v[68:69], v[76:77]
    v_pk_add_f32 v[70:71], v[70:71], v[78:79]
    v_pk_add_f32 v[80:81], v[80:81], v[88:89]
    v_pk_add_f32 v[82:83], v[82:83], v[90:91]
    v_pk_add_f32 v[84:85], v[84:85], v[92:93]
    v_pk_add_f32 v[86:87], v[86:87], v[94:95]
    v_pk_add_f32 v[32:33], v[32:33], v[48:49]
    v_pk_add_f32 v[34:35], v[34:35], v[50:51]
    v_pk_add_f32 v[36:37], v[36:37], v[52:53]
    v_pk_add_f32 v[38:39], v[38:39], v[54:55]
    v_pk_add_f32 v[64:65], v[64:65], v[80:81]
    v_pk_add_f32 v[66:67], v[66:67], v[82:83]
    v_pk_add_f32 v[68:69], v[68:69], v[84:85]
    v_pk_add_f32 v[70:71], v[70:71], v[86:87]
    v_pk_add_f32 v[108:109], v[32:33], v[64:65]
    v_pk_add_f32 v[110:111], v[34:35], v[66:67]
    v_pk_add_f32 v[112:113], v[36:37], v[68:69]
    v_pk_add_f32 v[114:115], v[38:39], v[70:71]
    v_pk_add_f32 v[4:5], v[108:109], v[110:111]
    v_pk_add_f32 v[6:7], v[112:113], v[114:115]
    v_pk_add_f32 v[4:5], v[4:5], v[6:7]
    v_cmp_u_f32 vcc, v4, v5
    s_cbranch_vccz L_h_ok
    s_add_u32 s74, s74, 1
    s_cmp_ge_u32 s74, s100
    s_cbranch_scc1 L_h_ok
    s_sleep 1
    s_branch L_h_spin
L_h_ok:
    v_cvt_pk_bf16_f32 v109, v108, v109
    v_lshlrev_b32 v108, 16, v109
    v_and_b32 v109, s67, v109
    v_pk_add_f32 v[108:109], v[108:109], v[100:101]
    v_cvt_pk_bf16_f32 v109, v108, v109
    v_lshlrev_b32 v108, 16, v109
    v_and_b32 v109, s67, v109
    v_cvt_pk_bf16_f32 v111, v110, v111
    v_lshlrev_b32 v110, 16, v111
    v_and_b32 v111, s67, v111
    v_pk_add_f32 v[110:111], v[110:111], v[102:103]
    v_cvt_pk_bf16_f32 v111, v110, v111
    v_lshlrev_b32 v110, 16, v111
    v_and_b32 v111, s67, v111
    v_cvt_pk_bf16_f32 v113, v112, v113
    v_lshlrev_b32 v112, 16, v113
    v_and_b32 v113, s67, v113
    v_pk_add_f32 v[112:113], v[112:113], v[104:105]
    v_cvt_pk_bf16_f32 v113, v112, v113
    v_lshlrev_b32 v112, 16, v113
    v_and_b32 v113, s67, v113
    v_cvt_pk_bf16_f32 v115, v114, v115
    v_lshlrev_b32 v114, 16, v115
    v_and_b32 v115, s67, v115
    v_pk_add_f32 v[114:115], v[114:115], v[106:107]
    v_cvt_pk_bf16_f32 v115, v114, v115
    v_lshlrev_b32 v114, 16, v115
    v_and_b32 v115, s67, v115
    v_readlane_b32 s72, v108, 40
    v_readlane_b32 s73, v112, 40
    v_mov_b32 v8, 0
    v_mov_b32 v9, 0
    v_mov_b32 v10, 0
    v_mov_b32 v11, 0
    s_mov_b32 exec_lo, -1
    s_mov_b32 exec_hi, 0xff
    v_subrev_f32 v48, s72, v108
    v_subrev_f32 v49, s72, v109
    v_subrev_f32 v50, s72, v110
    v_subrev_f32 v51, s72, v111
    v_subrev_f32 v52, s73, v112
    v_subrev_f32 v53, s73, v113
    v_subrev_f32 v54, s73, v114
    v_subrev_f32 v55, s73, v115
    v_add_f32 v8, v48, v49
    v_mul_f32 v10, v48, v48
    v_add_f32 v9, v52, v53
    v_mul_f32 v11, v52, v52
    v_add_f32 v8, v8, v50
    v_fmac_f32 v10, v49, v49
    v_add_f32 v9, v9, v54
    v_fmac_f32 v11, v53, v53
    v_add_f32 v8, v8, v51
    v_fmac_f32 v10, v50, v50
    v_add_f32 v9, v9, v55
    v_fmac_f32 v11, v54, v54
    v_fmac_f32 v10, v51, v51
    v_fmac_f32 v11, v55, v55
    s_mov_b64 exec, -1
    v_permlane32_swap_b32 v8, v10
    v_permlane32_swap_b32 v9, v11
    v_add_f32 v8, v8, v10
    v_add_f32 v9, v9, v11
    s_nop 1
    v_permlane16_swap_b32 v8, v9
    v_add_f32 v8, v8, v9
    s_nop 1
    v_add_f32_dpp v8, v8, v8 quad_perm:[1,0,3,2] row_mask:0xf bank_mask:0xf
    s_nop 1
    v_add_f32_dpp v8, v8, v8 quad_perm:[2,3,0,1] row_mask:0xf bank_mask:0xf
    s_nop 1
    v_add_f32_dpp v8, v8, v8 row_half_mirror row_mask:0xf bank_mask:0xf
    s_nop 1
    v_add_f32_dpp v8, v8, v8 row_mirror row_mask:0xf bank_mask:0xf
    s_mov_b32 exec_lo, 0x00010001
    s_mov_b32 exec_hi, 0x00010001
    ds_write_b32 v97, v8 offset:23808
    s_mov_b64 exec, -1
    s_waitcnt lgkmcnt(0)
    s_barrier
    ds_read_b128 v[48:51], v3 offset:23808
    ds_read_b128 v[52:55], v3 offset:23824
    ds_read_b128 v[56:59], v3 offset:23840
    ds_read_b128 v[60:63], v3 offset:23856
    v_mov_b32 v12, s72
    v_mov_b32 v13, s73
    s_mov_b32 s70, 0x3acccccd
    v_mov_b32 v14, s70
    s_waitcnt lgkmcnt(0)
    v_pk_add_f32 v[48:49], v[48:49], v[52:53]
    v_pk_add_f32 v[56:57], v[56:57], v[60:61]
    v_pk_add_f32 v[50:51], v[50:51], v[54:55]
    v_pk_add_f32 v[58:59], v[58:59], v[62:63]
    v_pk_add_f32 v[48:49], v[48:49], v[56:57]
    v_pk_add_f32 v[50:51], v[50:51], v[58:59]
    v_pk_mul_f32 v[48:49], v[48:49], v[14:15] op_sel_hi:[1,0]
    v_pk_mul_f32 v[50:51], v[50:51], v[14:15] op_sel_hi:[1,0]
    v_pk_add_f32 v[4:5], v[48:49], v[12:13] neg_lo:[1,1] neg_hi:[1,1]
    v_pk_fma_f32 v[6:7], v[48:49], v[48:49], v[50:51] neg_lo:[1,0,0] neg_hi:[1,0,0]
    v_max_f32 v6, 0, v6
    v_max_f32 v7, 0, v7
    v_cvt_pk_bf16_f32 v7, v6, v7
    v_lshlrev_b32 v6, 16, v7
    v_and_b32 v7, s67, v7
    v_cvt_pk_bf16_f32 v5, v4, v5
    v_lshlrev_b32 v4, 16, v5
    v_and_b32 v5, s67, v5
    v_add_f32 v6, 0x3727c5ac, v6
    v_add_f32 v7, 0x3727c5ac, v7
    v_cvt_pk_bf16_f32 v7, v6, v7
    v_lshlrev_b32 v6, 16, v7
    v_and_b32 v7, s67, v7
    v_sqrt_f32 v6, v6
    v_sqrt_f32 v7, v7
    s_nop 0
    v_cvt_pk_bf16_f32 v7, v6, v7
    v_lshlrev_b32 v6, 16, v7
    v_and_b32 v7, s67, v7
    v_rcp_f32 v6, v6
    v_rcp_f32 v7, v7
    v_pk_add_f32 v[108:109], v[108:109], v[4:5] op_sel_hi:[1,0]
    v_cvt_pk_bf16_f32 v109, v108, v109
    v_lshlrev_b32 v108, 16, v109
    v_and_b32 v109, s67, v109
    v_pk_mul_f32 v[108:109], v[108:109], v[6:7] op_sel_hi:[1,0]
    v_cvt_pk_bf16_f32 v12, v108, v109
    v_pk_add_f32 v[110:111], v[110:111], v[4:5] op_sel_hi:[1,0]
    v_cvt_pk_bf16_f32 v111, v110, v111
    v_lshlrev_b32 v110, 16, v111
    v_and_b32 v111, s67, v111
    v_pk_mul_f32 v[110:111], v[110:111], v[6:7] op_sel_hi:[1,0]
    v_cvt_pk_bf16_f32 v13, v110, v111
    v_pk_add_f32 v[112:113], v[112:113], v[4:5] op_sel:[0,1] op_sel_hi:[1,1]
    v_cvt_pk_bf16_f32 v113, v112, v113
    v_lshlrev_b32 v112, 16, v113
    v_and_b32 v113, s67, v113
    v_pk_mul_f32 v[112:113], v[112:113], v[6:7] op_sel:[0,1] op_sel_hi:[1,1]
    v_cvt_pk_bf16_f32 v14, v112, v113
    v_pk_add_f32 v[114:115], v[114:115], v[4:5] op_sel:[0,1] op_sel_hi:[1,1]
    v_cvt_pk_bf16_f32 v115, v114, v115
    v_lshlrev_b32 v114, 16, v115
    v_and_b32 v115, s67, v115
    v_pk_mul_f32 v[114:115], v[114:115], v[6:7] op_sel:[0,1] op_sel_hi:[1,1]
    v_cvt_pk_bf16_f32 v15, v114, v115
    v_cmp_gt_u32 vcc, 40, v1
    s_nop 0
    s_mov_b64 exec, vcc
    ds_write_b64 v29, v[12:13]
    ds_write_b64 v29, v[14:15] offset:320
    s_mov_b64 exec, -1
    ds_read_b128 v[72:75], v31 offset:0
    ds_read_b128 v[76:79], v31 offset:64
    ds_read_b128 v[80:83], v31 offset:128
    ds_read_b128 v[84:87], v31 offset:192
    ds_read_b128 v[88:91], v31 offset:256
    s_waitcnt lgkmcnt(4)
    v_mfma_f32_16x16x32_bf16 v[12:15], v[128:131], v[72:75], 0
    s_waitcnt lgkmcnt(3)
    v_mfma_f32_16x16x32_bf16 v[12:15], v[132:135], v[76:79], v[12:15]
    s_waitcnt lgkmcnt(2)
    v_mfma_f32_16x16x32_bf16 v[12:15], v[136:139], v[80:83], v[12:15]
    s_waitcnt lgkmcnt(1)
    v_mfma_f32_16x16x32_bf16 v[12:15], v[140:143], v[84:87], v[12:15]
    s_waitcnt lgkmcnt(0)
    v_mfma_f32_16x16x32_bf16 v[12:15], v[144:147], v[88:91], v[12:15]
    s_mov_b32 exec_lo, 0x00030003
    s_mov_b32 exec_hi, 0x00030003
    s_nop 5
    ds_write_b128 v98, v[12:15] offset:26624
    s_mov_b64 exec, -1
    s_waitcnt lgkmcnt(0)
    s_barrier
    ds_read_b128 v[108:111], v99 offset:26624
    ds_read_b128 v[112:115], v99 offset:26752
    ds_read_b128 v[116:119], v99 offset:26880
    ds_read_b128 v[120:123], v99 offset:27008
    s_waitcnt lgkmcnt(0)
    v_pk_add_f32 v[108:109], v[108:109], v[112:113]
    v_pk_add_f32 v[116:117], v[116:117], v[120:121]
    v_pk_add_f32 v[110:111], v[110:111], v[114:115]
    v_pk_add_f32 v[118:119], v[118:119], v[122:123]
    v_pk_add_f32 v[108:109], v[108:109], v[116:117]
    v_pk_add_f32 v[110:111], v[110:111], v[118:119]
    v_cvt_pk_bf16_f32 v108, v108, v108
    v_lshlrev_b32 v108, 16, v108
    v_cvt_pk_bf16_f32 v109, v109, v109
    v_lshlrev_b32 v109, 16, v109
    v_cvt_pk_bf16_f32 v110, v110, v110
    v_lshlrev_b32 v110, 16, v110
    v_cvt_pk_bf16_f32 v111, v111, v111
    v_lshlrev_b32 v111, 16, v111
    v_mul_f32 v4, 0xbfb8aa3b, v108
    v_mul_f32 v5, 0xbfb8aa3b, v109
    v_mul_f32 v6, 0xbfb8aa3b, v110
    v_mul_f32 v7, 0xbfb8aa3b, v111
    v_exp_f32 v4, v4
    v_exp_f32 v5, v5
    v_exp_f32 v6, v6
    v_exp_f32 v7, v7
    v_add_f32 v4, 1.0, v4
    v_add_f32 v5, 1.0, v5
    v_add_f32 v6, 1.0, v6
    v_add_f32 v7, 1.0, v7
    v_rcp_f32 v4, v4
    v_rcp_f32 v5, v5
    v_rcp_f32 v6, v6
    v_rcp_f32 v7, v7
    v_mul_f32 v108, v108, v4
    v_mul_f32 v109, v109, v5
    v_mul_f32 v110, v110, v6
    v_mul_f32 v111, v111, v7
    v_cvt_pk_bf16_f32 v8, v108, v109
    v_cvt_pk_bf16_f32 v9, v110, v111
    s_nop 1
    v_mfma_f32_16x16x16_bf16 v[180:183], v[152:153], v[8:9], 0
    v_mfma_f32_16x16x16_bf16 v[184:187], v[154:155], v[8:9], 0
    v_mfma_f32_16x16x16_bf16 v[188:191], v[156:157], v[8:9], 0
    v_mfma_f32_16x16x16_bf16 v[192:195], v[158:159], v[8:9], 0
    v_mfma_f32_16x16x16_bf16 v[196:199], v[160:161], v[8:9], 0
    v_mfma_f32_16x16x16_bf16 v[200:203], v[162:163], v[8:9], 0
    v_mfma_f32_16x16x16_bf16 v[204:207], v[164:165], v[8:9], 0
    v_mfma_f32_16x16x16_bf16 v[208:211], v[166:167], v[8:9], 0
    v_mfma_f32_16x16x16_bf16 v[212:215], v[168:169], v[8:9], 0
    v_mfma_f32_16x16x16_bf16 v[216:219], v[170:171], v[8:9], 0
    s_mov_b32 exec_lo, 0x00030003
    s_mov_b32 exec_hi, 0x00030003
    s_add_u32 s70, s27, 0
    buffer_store_dwordx4 v[180:183], v96, s[56:59], s70 offen sc1
    s_add_u32 s70, s27, 6144
    buffer_store_dwordx4 v[184:187], v96, s[56:59], s70 offen sc1
    s_add_u32 s70, s27, 12288
    buffer_store_dwordx4 v[188:191], v96, s[56:59], s70 offen sc1
    s_add_u32 s70, s27, 18432
    buffer_store_dwordx4 v[192:195], v96, s[56:59], s70 offen sc1
    s_add_u32 s70, s27, 24576
    buffer_store_dwordx4 v[196:199], v96, s[56:59], s70 offen sc1
    s_add_u32 s70, s27, 30720
    buffer_store_dwordx4 v[200:203], v96, s[56:59], s70 offen sc1
    s_add_u32 s70, s27, 36864
    buffer_store_dwordx4 v[204:207], v96, s[56:59], s70 offen sc1
    s_add_u32 s70, s27, 43008
    buffer_store_dwordx4 v[208:211], v96, s[56:59], s70 offen sc1
    s_add_u32 s70, s27, 49152
    buffer_store_dwordx4 v[212:215], v96, s[56:59], s70 offen sc1
    s_add_u32 s70, s27, 55296
    buffer_store_dwordx4 v[216:219], v96, s[56:59], s70 offen sc1
L_fin:
L_end:
    s_endpgm
.section .rodata,"a"
.p2align 6
.amdhsa_kernel sequential_preLN__mha_block_cached__dense_activation_silu__decode_kernel
  .amdhsa_next_free_vgpr 256
  .amdhsa_next_free_sgpr 102
  .amdhsa_accum_offset 256
  .amdhsa_group_segment_fixed_size 0
  .amdhsa_kernarg_size 88
  .amdhsa_user_sgpr_count 2
  .amdhsa_user_sgpr_kernarg_segment_ptr 1
  .amdhsa_system_sgpr_workgroup_id_x 1
  .amdhsa_float_denorm_mode_32 3
.end_amdhsa_kernel
```
